```python
import torch

def _softmax(x, axis=-1):
    return torch.softmax(x, dim=axis)
def _gelu(x):
    return torch.nn.functional.gelu(x, approximate="tanh")
def _silu(x):
    return torch.nn.functional.silu(x)
def _sigmoid(x):
    return torch.sigmoid(x)
def _layernorm(x, axis=-1, eps=1e-5):
    m = x.mean(dim=axis, keepdim=True)
    v = x.var(dim=axis, keepdim=True, unbiased=False)
    return (x - m) / torch.sqrt(v + eps)
def _scatter_add(tgt, idx, src, axis=0):
    return tgt.clone().index_add_(axis, idx, src)
def _segment_sum(src, seg, n):
    out = torch.zeros((n,) + src.shape[1:], dtype=src.dtype)
    return out.index_add_(0, seg, src)
def _pad(x, pw):
    flat = tuple(v for pair in reversed(pw) for v in pair)
    return torch.nn.functional.pad(x, flat)

kernel_name = 'standalone__gqa_softmax__near_ridge'

def setup_inputs():

    _w = (lambda a: (lambda t: t.to(torch.bfloat16) if t.is_floating_point() else t)(torch.as_tensor(a)))
    B, Hq, Hkv, Sq, Sk, D = 8, 16, 8, 256, 512, 256
    return {
        "q": _w((lambda *s: torch.randn(*s, dtype=torch.bfloat16) * 0.8)(B, Hq, Sq, D)),
        "k": _w((lambda *s: torch.randn(*s, dtype=torch.bfloat16) * 0.8)(B, Hkv, Sk, D)),
        "v": _w((lambda *s: torch.randn(*s, dtype=torch.bfloat16) * 0.05)(B, Hkv, Sk, D)),
    }

def reference(q, k, v):
    B, Hq, Sq, D = q.shape
    Hkv = k.shape[1]
    rep = Hq // Hkv
    k = (lambda x, n, axis: torch.repeat_interleave(x, n, dim=axis))(k, rep, axis=1)
    v = (lambda x, n, axis: torch.repeat_interleave(x, n, dim=axis))(v, rep, axis=1)
    scale = D ** -0.5
    scores = torch.einsum("bhqd,bhkd->bhqk", q, k) * scale
    p = _softmax(scores, axis=-1)
    return torch.einsum("bhqk,bhkd->bhqd", p, v)
```

```asm
; @launch grid=(256,1,1) block=(512,1,1) lds=152128
.amdgcn_target "amdgcn-amd-amdhsa--gfx950"
.text
.globl standalone__gqa_softmax__near_ridge_kernel
.p2align 12
.p2align 8
.type standalone__gqa_softmax__near_ridge_kernel,@function
standalone__gqa_softmax__near_ridge_kernel:
L_code_start:
    s_load_dwordx8 s[4:11], s[0:1], 0
    s_cmp_ge_u32 s2, 256
    s_cbranch_scc1 L_end
    v_lshrrev_b32 v1, 6, v0
    v_and_b32 v0, 63, v0
    v_readfirstlane_b32 s28, v1
    s_and_b32 s36, s2, 7
    s_lshr_b32 s37, s2, 3
    s_lshl_b32 s36, s36, 3
    s_lshr_b32 s38, s37, 2
    s_add_u32 s36, s36, s38
    s_and_b32 s37, s37, 3
    s_and_b32 s34, s38, 3
    s_lshl_b32 s34, s34, 7
    s_lshl_b32 s38, s36, 18
    s_lshl_b32 s3, s37, 16
    s_add_u32 s39, s38, s3
    s_and_b32 s29, s28, 3
    s_cmp_ge_u32 s28, 4
    s_cbranch_scc1 L_compute
    v_lshrrev_b32 v11, 3, v0
    v_lshrrev_b32 v12, 4, v0
    v_and_b32 v13, 7, v0
    v_xor_b32 v12, v12, v13
    v_lshlrev_b32 v12, 4, v12
    v_lshl_add_u32 v2, v11, 9, v12
    s_lshl_b32 s92, s29, 14
    s_lshl_b32 s36, s29, 12
    s_lshr_b32 s99, s3, 2
    s_mov_b32 s98, s34
    s_xor_b32 s93, s92, s99
    v_xor_b32 v2, s98, v2
    v_xor_b32 v3, 64, v2
    s_waitcnt lgkmcnt(0)
    s_add_u32 s12, s4, s39
    s_addc_u32 s13, s5, 0
    s_mov_b32 s14, 0x10000
    s_mov_b32 s15, 0x20000
    s_add_u32 s16, s6, s38
    s_addc_u32 s17, s7, 0
    s_mov_b32 s18, 0x40000
    s_mov_b32 s19, 0x20000
L_restart_loader_fast:
    s_add_u32 m0, s36, 118272
    s_add_u32 s30, s92, 0
    buffer_load_dwordx4 v2, s[12:15], s30 offen nt lds
    s_add_u32 m0, s36, 119296
    s_add_u32 s30, s92, 4096
    buffer_load_dwordx4 v3, s[12:15], s30 offen nt lds
    s_add_u32 m0, s36, 120320
    s_add_u32 s30, s92, 8192
    buffer_load_dwordx4 v2, s[12:15], s30 offen nt lds
    s_add_u32 m0, s36, 121344
    s_add_u32 s30, s92, 12288
    buffer_load_dwordx4 v3, s[12:15], s30 offen nt lds
    s_add_u32 m0, s36, 135168
    s_add_u32 s30, s93, 0
    buffer_load_dwordx4 v2, s[16:19], s30 offen nt lds
    s_add_u32 m0, s36, 136192
    s_add_u32 s30, s93, 4096
    buffer_load_dwordx4 v3, s[16:19], s30 offen nt lds
    s_add_u32 m0, s36, 137216
    s_add_u32 s30, s93, 8192
    buffer_load_dwordx4 v2, s[16:19], s30 offen nt lds
    s_add_u32 m0, s36, 138240
    s_add_u32 s30, s93, 12288
    buffer_load_dwordx4 v3, s[16:19], s30 offen nt lds
    v_xor_b32 v16, 128, v2
    v_xor_b32 v17, 128, v3
    v_xor_b32 v18, 256, v2
    v_xor_b32 v19, 256, v3
    v_xor_b32 v20, 384, v2
    v_xor_b32 v21, 384, v3
    s_add_u32 m0, s36, 0
    s_add_u32 s30, s92, 0
    buffer_load_dwordx4 v16, s[12:15], s30 offen nt lds
    s_add_u32 m0, s36, 1024
    s_add_u32 s30, s92, 4096
    buffer_load_dwordx4 v17, s[12:15], s30 offen nt lds
    s_add_u32 m0, s36, 2048
    s_add_u32 s30, s92, 8192
    buffer_load_dwordx4 v16, s[12:15], s30 offen nt lds
    s_add_u32 m0, s36, 3072
    s_add_u32 s30, s92, 12288
    buffer_load_dwordx4 v17, s[12:15], s30 offen nt lds
    s_mul_i32 s37, s29, 4224
    s_add_u32 s20, s8, s38
    s_addc_u32 s21, s9, 0
    s_mov_b32 s22, 0x40000
    s_mov_b32 s23, 0x20000
    v_lshrrev_b32 v9, 5, v0
    v_and_b32 v10, 31, v0
    v_xor_b32 v10, v10, v9
    v_lshlrev_b32 v10, 4, v10
    v_lshl_add_u32 v4, v9, 9, v10
    v_xor_b32 v4, s98, v4
    s_or_b32 s94, s36, s99
    s_lshl_b32 s95, s29, 16
    s_or_b32 s95, s95, s99
    v_bfe_u32 v12, v0, 4, 2
    v_lshlrev_b32 v12, 1, v12
    v_xor_b32 v12, v12, v13
    v_lshlrev_b32 v12, 4, v12
    v_lshl_add_u32 v5, v11, 9, v12
    v_xor_b32 v5, s34, v5
    v_xor_b32 v24, 0, v5
    v_xor_b32 v25, 128, v5
    v_xor_b32 v26, 256, v5
    v_xor_b32 v27, 384, v5
    v_mov_b32 v8, 152064
    v_lshlrev_b32 v7, 9, v0
    v_lshlrev_b32 v9, 20, v9
    s_add_u32 s30, s3, s92
    v_add3_u32 v7, v7, v9, s30
    v_xor_b32 v7, s34, v7
    s_waitcnt vmcnt(8)
    s_barrier
    s_add_u32 m0, s36, 16896
    s_add_u32 s30, s93, 0
    buffer_load_dwordx4 v16, s[16:19], s30 offen nt lds
    s_add_u32 m0, s36, 17920
    s_add_u32 s30, s93, 4096
    buffer_load_dwordx4 v17, s[16:19], s30 offen nt lds
    s_add_u32 m0, s36, 18944
    s_add_u32 s30, s93, 8192
    buffer_load_dwordx4 v16, s[16:19], s30 offen nt lds
    s_add_u32 m0, s36, 19968
    s_add_u32 s30, s93, 12288
    buffer_load_dwordx4 v17, s[16:19], s30 offen nt lds
    s_waitcnt vmcnt(8)
    s_barrier
    s_add_u32 m0, s36, 33792
    s_add_u32 s30, s92, 0
    buffer_load_dwordx4 v18, s[12:15], s30 offen nt lds
    s_add_u32 m0, s36, 34816
    s_add_u32 s30, s92, 4096
    buffer_load_dwordx4 v19, s[12:15], s30 offen nt lds
    s_add_u32 m0, s36, 35840
    s_add_u32 s30, s92, 8192
    buffer_load_dwordx4 v18, s[12:15], s30 offen nt lds
    s_add_u32 m0, s36, 36864
    s_add_u32 s30, s92, 12288
    buffer_load_dwordx4 v19, s[12:15], s30 offen nt lds
    s_waitcnt vmcnt(8)
    s_barrier
    s_add_u32 m0, s36, 50688
    s_add_u32 s30, s93, 0
    buffer_load_dwordx4 v18, s[16:19], s30 offen nt lds
    s_add_u32 m0, s36, 51712
    s_add_u32 s30, s93, 4096
    buffer_load_dwordx4 v19, s[16:19], s30 offen nt lds
    s_add_u32 m0, s36, 52736
    s_add_u32 s30, s93, 8192
    buffer_load_dwordx4 v18, s[16:19], s30 offen nt lds
    s_add_u32 m0, s36, 53760
    s_add_u32 s30, s93, 12288
    buffer_load_dwordx4 v19, s[16:19], s30 offen nt lds
    s_waitcnt vmcnt(8)
    s_barrier
    s_add_u32 m0, s36, 67584
    s_add_u32 s30, s92, 0
    buffer_load_dwordx4 v20, s[12:15], s30 offen nt lds
    s_add_u32 m0, s36, 68608
    s_add_u32 s30, s92, 4096
    buffer_load_dwordx4 v21, s[12:15], s30 offen nt lds
    s_add_u32 m0, s36, 69632
    s_add_u32 s30, s92, 8192
    buffer_load_dwordx4 v20, s[12:15], s30 offen nt lds
    s_add_u32 m0, s36, 70656
    s_add_u32 s30, s92, 12288
    buffer_load_dwordx4 v21, s[12:15], s30 offen nt lds
    s_mov_b64 exec, 0
    s_branch L_pad0
L_back0:
    s_mov_b64 exec, -1
    s_waitcnt vmcnt(8)
    s_barrier
    s_add_u32 m0, s36, 84480
    s_add_u32 s30, s93, 0
    buffer_load_dwordx4 v20, s[16:19], s30 offen nt lds
    s_add_u32 m0, s36, 85504
    s_add_u32 s30, s93, 4096
    buffer_load_dwordx4 v21, s[16:19], s30 offen nt lds
    s_add_u32 m0, s36, 86528
    s_add_u32 s30, s93, 8192
    buffer_load_dwordx4 v20, s[16:19], s30 offen nt lds
    s_add_u32 m0, s36, 87552
    s_add_u32 s30, s93, 12288
    buffer_load_dwordx4 v21, s[16:19], s30 offen nt lds
    s_waitcnt vmcnt(8)
    s_barrier
    s_xor_b32 s30, s94, 65536
    s_add_u32 m0, s37, 101376
    s_nop 0
    buffer_load_dwordx4 v4, s[16:19], s30 offen offset:0  lds
    s_add_u32 m0, s37, 101408
    s_nop 0
    buffer_load_dwordx4 v4, s[16:19], s30 offen offset:1024  lds
    s_add_u32 m0, s37, 101440
    s_nop 0
    buffer_load_dwordx4 v4, s[16:19], s30 offen offset:2048  lds
    s_add_u32 m0, s37, 101472
    s_nop 0
    buffer_load_dwordx4 v4, s[16:19], s30 offen offset:3072  lds
    s_mov_b64 exec, 0
    s_branch L_pad1
L_back1:
    s_mov_b64 exec, -1
    s_waitcnt vmcnt(8)
    s_barrier
    s_xor_b32 s30, s94, 81920
    s_add_u32 m0, s37, 118272
    s_nop 0
    buffer_load_dwordx4 v4, s[16:19], s30 offen offset:0  lds
    s_add_u32 m0, s37, 118304
    s_nop 0
    buffer_load_dwordx4 v4, s[16:19], s30 offen offset:1024  lds
    s_add_u32 m0, s37, 118336
    s_nop 0
    buffer_load_dwordx4 v4, s[16:19], s30 offen offset:2048  lds
    s_add_u32 m0, s37, 118368
    s_nop 0
    buffer_load_dwordx4 v4, s[16:19], s30 offen offset:3072  lds
    s_waitcnt vmcnt(8)
    s_barrier
    s_xor_b32 s30, s94, 98304
    s_add_u32 m0, s37, 135168
    s_nop 0
    buffer_load_dwordx4 v4, s[16:19], s30 offen offset:0  lds
    s_add_u32 m0, s37, 135200
    s_nop 0
    buffer_load_dwordx4 v4, s[16:19], s30 offen offset:1024  lds
    s_add_u32 m0, s37, 135232
    s_nop 0
    buffer_load_dwordx4 v4, s[16:19], s30 offen offset:2048  lds
    s_add_u32 m0, s37, 135264
    s_nop 0
    buffer_load_dwordx4 v4, s[16:19], s30 offen offset:3072  lds
    s_mov_b64 exec, 0
    s_branch L_pad2
L_back2:
    s_mov_b64 exec, -1
    s_waitcnt vmcnt(8)
    s_barrier
    s_xor_b32 s30, s94, 114688
    s_add_u32 m0, s37, 0
    s_nop 0
    buffer_load_dwordx4 v4, s[16:19], s30 offen offset:0  lds
    s_add_u32 m0, s37, 32
    s_nop 0
    buffer_load_dwordx4 v4, s[16:19], s30 offen offset:1024  lds
    s_add_u32 m0, s37, 64
    s_nop 0
    buffer_load_dwordx4 v4, s[16:19], s30 offen offset:2048  lds
    s_add_u32 m0, s37, 96
    s_nop 0
    buffer_load_dwordx4 v4, s[16:19], s30 offen offset:3072  lds
    s_xor_b32 s30, s94, 131072
    s_add_u32 m0, s37, 16896
    s_nop 0
    buffer_load_dwordx4 v4, s[16:19], s30 offen offset:0  lds
    s_add_u32 m0, s37, 16928
    s_nop 0
    buffer_load_dwordx4 v4, s[16:19], s30 offen offset:1024  lds
    s_add_u32 m0, s37, 16960
    s_nop 0
    buffer_load_dwordx4 v4, s[16:19], s30 offen offset:2048  lds
    s_add_u32 m0, s37, 16992
    s_nop 0
    buffer_load_dwordx4 v4, s[16:19], s30 offen offset:3072  lds
    s_mov_b64 exec, 0
    s_branch L_pad3
L_back3:
    s_mov_b64 exec, -1
    s_waitcnt vmcnt(12)
    s_barrier
    s_xor_b32 s30, s94, 147456
    s_add_u32 m0, s37, 33792
    s_nop 0
    buffer_load_dwordx4 v4, s[16:19], s30 offen offset:0  lds
    s_add_u32 m0, s37, 33824
    s_nop 0
    buffer_load_dwordx4 v4, s[16:19], s30 offen offset:1024  lds
    s_add_u32 m0, s37, 33856
    s_nop 0
    buffer_load_dwordx4 v4, s[16:19], s30 offen offset:2048  lds
    s_add_u32 m0, s37, 33888
    s_nop 0
    buffer_load_dwordx4 v4, s[16:19], s30 offen offset:3072  lds
    s_mov_b64 exec, 0
    s_branch L_pad4
L_back4:
    s_mov_b64 exec, -1
    s_waitcnt vmcnt(12)
    s_barrier
    s_xor_b32 s30, s94, 163840
    s_add_u32 m0, s37, 50688
    s_nop 0
    buffer_load_dwordx4 v4, s[16:19], s30 offen offset:0  lds
    s_add_u32 m0, s37, 50720
    s_nop 0
    buffer_load_dwordx4 v4, s[16:19], s30 offen offset:1024  lds
    s_add_u32 m0, s37, 50752
    s_nop 0
    buffer_load_dwordx4 v4, s[16:19], s30 offen offset:2048  lds
    s_add_u32 m0, s37, 50784
    s_nop 0
    buffer_load_dwordx4 v4, s[16:19], s30 offen offset:3072  lds
    s_xor_b32 s30, s94, 180224
    s_add_u32 m0, s37, 67584
    s_nop 0
    buffer_load_dwordx4 v4, s[16:19], s30 offen offset:0  lds
    s_add_u32 m0, s37, 67616
    s_nop 0
    buffer_load_dwordx4 v4, s[16:19], s30 offen offset:1024  lds
    s_add_u32 m0, s37, 67648
    s_nop 0
    buffer_load_dwordx4 v4, s[16:19], s30 offen offset:2048  lds
    s_add_u32 m0, s37, 67680
    s_nop 0
    buffer_load_dwordx4 v4, s[16:19], s30 offen offset:3072  lds
    s_waitcnt vmcnt(16)
    s_barrier
    s_xor_b32 s30, s94, 196608
    s_add_u32 m0, s37, 84480
    s_nop 0
    buffer_load_dwordx4 v4, s[16:19], s30 offen offset:0  lds
    s_add_u32 m0, s37, 84512
    s_nop 0
    buffer_load_dwordx4 v4, s[16:19], s30 offen offset:1024  lds
    s_add_u32 m0, s37, 84544
    s_nop 0
    buffer_load_dwordx4 v4, s[16:19], s30 offen offset:2048  lds
    s_add_u32 m0, s37, 84576
    s_nop 0
    buffer_load_dwordx4 v4, s[16:19], s30 offen offset:3072  lds
    s_waitcnt vmcnt(16)
    s_barrier
    s_xor_b32 s30, s94, 212992
    s_add_u32 m0, s37, 101376
    s_nop 0
    buffer_load_dwordx4 v4, s[16:19], s30 offen offset:0  lds
    s_add_u32 m0, s37, 101408
    s_nop 0
    buffer_load_dwordx4 v4, s[16:19], s30 offen offset:1024  lds
    s_add_u32 m0, s37, 101440
    s_nop 0
    buffer_load_dwordx4 v4, s[16:19], s30 offen offset:2048  lds
    s_add_u32 m0, s37, 101472
    s_nop 0
    buffer_load_dwordx4 v4, s[16:19], s30 offen offset:3072  lds
    s_xor_b32 s30, s94, 229376
    s_add_u32 m0, s37, 118272
    s_nop 0
    buffer_load_dwordx4 v4, s[16:19], s30 offen offset:0  lds
    s_add_u32 m0, s37, 118304
    s_nop 0
    buffer_load_dwordx4 v4, s[16:19], s30 offen offset:1024  lds
    s_add_u32 m0, s37, 118336
    s_nop 0
    buffer_load_dwordx4 v4, s[16:19], s30 offen offset:2048  lds
    s_add_u32 m0, s37, 118368
    s_nop 0
    buffer_load_dwordx4 v4, s[16:19], s30 offen offset:3072  lds
    s_waitcnt vmcnt(20)
    s_barrier
    s_xor_b32 s30, s94, 245760
    s_add_u32 m0, s37, 135168
    s_nop 0
    buffer_load_dwordx4 v4, s[16:19], s30 offen offset:0  lds
    s_add_u32 m0, s37, 135200
    s_nop 0
    buffer_load_dwordx4 v4, s[16:19], s30 offen offset:1024  lds
    s_add_u32 m0, s37, 135232
    s_nop 0
    buffer_load_dwordx4 v4, s[16:19], s30 offen offset:2048  lds
    s_add_u32 m0, s37, 135264
    s_nop 0
    buffer_load_dwordx4 v4, s[16:19], s30 offen offset:3072  lds
    s_waitcnt vmcnt(20)
    s_barrier
    s_add_u32 m0, s36, 0
    s_xor_b32 s30, s95, 0
    buffer_load_dwordx4 v24, s[20:23], s30 offen  lds
    s_add_u32 m0, s36, 1024
    s_xor_b32 s30, s95, 4096
    buffer_load_dwordx4 v24, s[20:23], s30 offen  lds
    s_add_u32 m0, s36, 2048
    s_xor_b32 s30, s95, 8192
    buffer_load_dwordx4 v24, s[20:23], s30 offen  lds
    s_add_u32 m0, s36, 3072
    s_xor_b32 s30, s95, 12288
    buffer_load_dwordx4 v24, s[20:23], s30 offen  lds
    s_add_u32 m0, s36, 16896
    s_xor_b32 s30, s95, 16384
    buffer_load_dwordx4 v24, s[20:23], s30 offen  lds
    s_add_u32 m0, s36, 17920
    s_xor_b32 s30, s95, 20480
    buffer_load_dwordx4 v24, s[20:23], s30 offen  lds
    s_add_u32 m0, s36, 18944
    s_xor_b32 s30, s95, 24576
    buffer_load_dwordx4 v24, s[20:23], s30 offen  lds
    s_add_u32 m0, s36, 19968
    s_xor_b32 s30, s95, 28672
    buffer_load_dwordx4 v24, s[20:23], s30 offen  lds
    s_waitcnt vmcnt(20)
    s_barrier
    s_add_u32 m0, s36, 33792
    s_xor_b32 s30, s95, 32768
    buffer_load_dwordx4 v24, s[20:23], s30 offen  lds
    s_add_u32 m0, s36, 34816
    s_xor_b32 s30, s95, 36864
    buffer_load_dwordx4 v24, s[20:23], s30 offen  lds
    s_add_u32 m0, s36, 35840
    s_xor_b32 s30, s95, 40960
    buffer_load_dwordx4 v24, s[20:23], s30 offen  lds
    s_add_u32 m0, s36, 36864
    s_xor_b32 s30, s95, 45056
    buffer_load_dwordx4 v24, s[20:23], s30 offen  lds
    s_waitcnt vmcnt(16)
    s_barrier
    s_add_u32 m0, s36, 50688
    s_xor_b32 s30, s95, 49152
    buffer_load_dwordx4 v24, s[20:23], s30 offen  lds
    s_add_u32 m0, s36, 51712
    s_xor_b32 s30, s95, 53248
    buffer_load_dwordx4 v24, s[20:23], s30 offen  lds
    s_add_u32 m0, s36, 52736
    s_xor_b32 s30, s95, 57344
    buffer_load_dwordx4 v24, s[20:23], s30 offen  lds
    s_add_u32 m0, s36, 53760
    s_xor_b32 s30, s95, 61440
    buffer_load_dwordx4 v24, s[20:23], s30 offen  lds
    s_add_u32 m0, s36, 67584
    s_xor_b32 s30, s95, 0
    buffer_load_dwordx4 v25, s[20:23], s30 offen  lds
    s_add_u32 m0, s36, 68608
    s_xor_b32 s30, s95, 4096
    buffer_load_dwordx4 v25, s[20:23], s30 offen  lds
    s_add_u32 m0, s36, 69632
    s_xor_b32 s30, s95, 8192
    buffer_load_dwordx4 v25, s[20:23], s30 offen  lds
    s_add_u32 m0, s36, 70656
    s_xor_b32 s30, s95, 12288
    buffer_load_dwordx4 v25, s[20:23], s30 offen  lds
    s_waitcnt vmcnt(16)
    s_barrier
    s_add_u32 m0, s36, 84480
    s_xor_b32 s30, s95, 16384
    buffer_load_dwordx4 v25, s[20:23], s30 offen  lds
    s_add_u32 m0, s36, 85504
    s_xor_b32 s30, s95, 20480
    buffer_load_dwordx4 v25, s[20:23], s30 offen  lds
    s_add_u32 m0, s36, 86528
    s_xor_b32 s30, s95, 24576
    buffer_load_dwordx4 v25, s[20:23], s30 offen  lds
    s_add_u32 m0, s36, 87552
    s_xor_b32 s30, s95, 28672
    buffer_load_dwordx4 v25, s[20:23], s30 offen  lds
    s_add_u32 m0, s36, 101376
    s_xor_b32 s30, s95, 32768
    buffer_load_dwordx4 v25, s[20:23], s30 offen  lds
    s_add_u32 m0, s36, 102400
    s_xor_b32 s30, s95, 36864
    buffer_load_dwordx4 v25, s[20:23], s30 offen  lds
    s_add_u32 m0, s36, 103424
    s_xor_b32 s30, s95, 40960
    buffer_load_dwordx4 v25, s[20:23], s30 offen  lds
    s_add_u32 m0, s36, 104448
    s_xor_b32 s30, s95, 45056
    buffer_load_dwordx4 v25, s[20:23], s30 offen  lds
    v_xor_b32 v6, 384, v7
    s_mov_b64 exec, 0xffffffff
    buffer_load_dword v40, v6, s[20:23], 0 offen
    s_mov_b64 exec, -1
    s_waitcnt vmcnt(17)
    s_barrier
    s_add_u32 m0, s36, 118272
    s_xor_b32 s30, s95, 49152
    buffer_load_dwordx4 v25, s[20:23], s30 offen  lds
    s_add_u32 m0, s36, 119296
    s_xor_b32 s30, s95, 53248
    buffer_load_dwordx4 v25, s[20:23], s30 offen  lds
    s_add_u32 m0, s36, 120320
    s_xor_b32 s30, s95, 57344
    buffer_load_dwordx4 v25, s[20:23], s30 offen  lds
    s_add_u32 m0, s36, 121344
    s_xor_b32 s30, s95, 61440
    buffer_load_dwordx4 v25, s[20:23], s30 offen  lds
    s_add_u32 m0, s36, 135168
    s_xor_b32 s30, s95, 0
    buffer_load_dwordx4 v26, s[20:23], s30 offen  lds
    s_add_u32 m0, s36, 136192
    s_xor_b32 s30, s95, 4096
    buffer_load_dwordx4 v26, s[20:23], s30 offen  lds
    s_add_u32 m0, s36, 137216
    s_xor_b32 s30, s95, 8192
    buffer_load_dwordx4 v26, s[20:23], s30 offen  lds
    s_add_u32 m0, s36, 138240
    s_xor_b32 s30, s95, 12288
    buffer_load_dwordx4 v26, s[20:23], s30 offen  lds
    s_waitcnt vmcnt(17)
    s_barrier
    s_add_u32 m0, s36, 0
    s_xor_b32 s30, s95, 16384
    buffer_load_dwordx4 v26, s[20:23], s30 offen  lds
    s_add_u32 m0, s36, 1024
    s_xor_b32 s30, s95, 20480
    buffer_load_dwordx4 v26, s[20:23], s30 offen  lds
    s_add_u32 m0, s36, 2048
    s_xor_b32 s30, s95, 24576
    buffer_load_dwordx4 v26, s[20:23], s30 offen  lds
    s_add_u32 m0, s36, 3072
    s_xor_b32 s30, s95, 28672
    buffer_load_dwordx4 v26, s[20:23], s30 offen  lds
    s_add_u32 m0, s36, 16896
    s_xor_b32 s30, s95, 32768
    buffer_load_dwordx4 v26, s[20:23], s30 offen  lds
    s_add_u32 m0, s36, 17920
    s_xor_b32 s30, s95, 36864
    buffer_load_dwordx4 v26, s[20:23], s30 offen  lds
    s_add_u32 m0, s36, 18944
    s_xor_b32 s30, s95, 40960
    buffer_load_dwordx4 v26, s[20:23], s30 offen  lds
    s_add_u32 m0, s36, 19968
    s_xor_b32 s30, s95, 45056
    buffer_load_dwordx4 v26, s[20:23], s30 offen  lds
    s_waitcnt vmcnt(17)
    s_barrier
    ds_read_b128 v[32:35], v8
    s_waitcnt lgkmcnt(0)
    v_or3_b32 v32, v32, v33, v34
    v_or_b32 v32, v32, v35
    v_cmp_ne_u32 vcc, 0, v32
    s_cbranch_vccnz L_redo_loader_fast
    s_add_u32 m0, s36, 33792
    s_xor_b32 s30, s95, 49152
    buffer_load_dwordx4 v26, s[20:23], s30 offen  lds
    s_add_u32 m0, s36, 34816
    s_xor_b32 s30, s95, 53248
    buffer_load_dwordx4 v26, s[20:23], s30 offen  lds
    s_add_u32 m0, s36, 35840
    s_xor_b32 s30, s95, 57344
    buffer_load_dwordx4 v26, s[20:23], s30 offen  lds
    s_add_u32 m0, s36, 36864
    s_xor_b32 s30, s95, 61440
    buffer_load_dwordx4 v26, s[20:23], s30 offen  lds
    s_add_u32 m0, s36, 50688
    s_xor_b32 s30, s95, 0
    buffer_load_dwordx4 v27, s[20:23], s30 offen  lds
    s_add_u32 m0, s36, 51712
    s_xor_b32 s30, s95, 4096
    buffer_load_dwordx4 v27, s[20:23], s30 offen  lds
    s_add_u32 m0, s36, 52736
    s_xor_b32 s30, s95, 8192
    buffer_load_dwordx4 v27, s[20:23], s30 offen  lds
    s_add_u32 m0, s36, 53760
    s_xor_b32 s30, s95, 12288
    buffer_load_dwordx4 v27, s[20:23], s30 offen  lds
    s_waitcnt vmcnt(16)
    s_barrier
    s_add_u32 m0, s36, 67584
    s_xor_b32 s30, s95, 16384
    buffer_load_dwordx4 v27, s[20:23], s30 offen  lds
    s_add_u32 m0, s36, 68608
    s_xor_b32 s30, s95, 20480
    buffer_load_dwordx4 v27, s[20:23], s30 offen  lds
    s_add_u32 m0, s36, 69632
    s_xor_b32 s30, s95, 24576
    buffer_load_dwordx4 v27, s[20:23], s30 offen  lds
    s_add_u32 m0, s36, 70656
    s_xor_b32 s30, s95, 28672
    buffer_load_dwordx4 v27, s[20:23], s30 offen  lds
    s_add_u32 m0, s36, 84480
    s_xor_b32 s30, s95, 32768
    buffer_load_dwordx4 v27, s[20:23], s30 offen  lds
    s_add_u32 m0, s36, 85504
    s_xor_b32 s30, s95, 36864
    buffer_load_dwordx4 v27, s[20:23], s30 offen  lds
    s_add_u32 m0, s36, 86528
    s_xor_b32 s30, s95, 40960
    buffer_load_dwordx4 v27, s[20:23], s30 offen  lds
    s_add_u32 m0, s36, 87552
    s_xor_b32 s30, s95, 45056
    buffer_load_dwordx4 v27, s[20:23], s30 offen  lds
    s_waitcnt vmcnt(16)
    s_barrier
    s_add_u32 m0, s36, 101376
    s_xor_b32 s30, s95, 49152
    buffer_load_dwordx4 v27, s[20:23], s30 offen  lds
    s_add_u32 m0, s36, 102400
    s_xor_b32 s30, s95, 53248
    buffer_load_dwordx4 v27, s[20:23], s30 offen  lds
    s_add_u32 m0, s36, 103424
    s_xor_b32 s30, s95, 57344
    buffer_load_dwordx4 v27, s[20:23], s30 offen  lds
    s_add_u32 m0, s36, 104448
    s_xor_b32 s30, s95, 61440
    buffer_load_dwordx4 v27, s[20:23], s30 offen  lds
    s_waitcnt vmcnt(16)
    s_barrier
    s_waitcnt vmcnt(0)
    s_barrier
    s_endpgm
L_redo_loader_fast:
    s_waitcnt vmcnt(0) lgkmcnt(0)
    s_barrier
    s_branch L_restart_loader_safe
L_compute:
    s_setprio 2
    s_cmp_lg_u32 s29, 0
    s_cbranch_scc1 L_restart_compute_fast
    s_getpc_b64 s[16:17]
L_pc:
    s_sub_u32 s16, s16, L_pc-L_code_start
    s_subb_u32 s17, s17, 0
    s_mov_b32 s18, L_fast_end-L_code_start
    s_mov_b32 s19, 0x20000
    v_lshlrev_b32 v8, 7, v0
    s_lshr_b32 s36, s3, 3
    buffer_load_dword v12, v8, s[16:19], s36 offen
L_restart_compute_fast:
    v_lshrrev_b32 v9, 4, v0
    v_bfe_u32 v8, v0, 1, 3
    v_xor_b32 v10, v8, v9
    v_lshlrev_b32 v10, 4, v10
    v_and_b32 v6, 15, v0
    v_lshl_add_u32 v10, v6, 7, v10
    v_xor_b32 v11, 64, v10
    s_lshl_b32 s93, s29, 12
    v_mul_u32_u24 v1, 1056, v8
    v_and_b32 v8, 1, v0
    v_lshl_add_u32 v1, v8, 9, v1
    v_xor_b32 v8, v8, v9
    v_lshl_add_u32 v1, v8, 4, v1
    v_lshlrev_b32 v6, 9, v6
    v_bfe_u32 v8, v0, 4, 1
    v_lshl_add_u32 v6, v8, 5, v6
    v_lshrrev_b32 v8, 5, v0
    v_lshl_add_u32 v6, v8, 4, v6
    s_lshl_b32 s37, s29, 14
    v_add_u32 v6, s37, v6
    v_lshrrev_b32 v8, 2, v0
    v_lshlrev_b32 v2, 7, v8
    v_bfe_u32 v8, v0, 3, 2
    v_lshl_add_u32 v2, v8, 5, v2
    v_and_b32 v8, 3, v0
    v_lshl_add_u32 v2, v8, 3, v2
    v_xor_b32 v3, 32, v2
    v_xor_b32 v4, 64, v2
    v_xor_b32 v5, 96, v2
    s_lshl_b32 s36, s29, 2
    s_add_u32 s36, s36, 152064
    v_mov_b32 v7, s36
    s_mov_b32 s31, 0x3db8aa3b
    s_waitcnt lgkmcnt(0)
    s_add_u32 s24, s10, s39
    s_addc_u32 s25, s11, 0
    s_mov_b32 s26, 0x10000
    s_mov_b32 s27, 0x20000
    s_xor_b32 s16, s34, 0
    s_add_u32 s17, s16, 8192
    s_xor_b32 s18, s34, 128
    s_add_u32 s19, s18, 8192
    s_xor_b32 s20, s34, 256
    s_add_u32 s21, s20, 8192
    s_xor_b32 s22, s34, 384
    s_add_u32 s23, s22, 8192
    s_barrier
    s_add_u32 s36, s93, 118272
    v_add_u32 v8, s36, v10
    s_add_u32 s36, s93, 118272
    v_add_u32 v9, s36, v11
    ds_read_b128 v[40:43], v8 offset:0
    ds_read_b128 v[44:47], v8 offset:2048
    ds_read_b128 v[48:51], v9 offset:0
    ds_read_b128 v[52:55], v9 offset:2048
    s_waitcnt lgkmcnt(3)
    v_lshlrev_b32 v104, 16, v40
    v_and_b32 v105, 0xffff0000, v40
    v_mul_f32 v104, s31, v104
    v_mul_f32 v105, s31, v105
    v_cvt_pk_bf16_f32 v40, v104, v105
    v_lshlrev_b32 v106, 16, v41
    v_and_b32 v107, 0xffff0000, v41
    v_mul_f32 v106, s31, v106
    v_mul_f32 v107, s31, v107
    v_cvt_pk_bf16_f32 v41, v106, v107
    v_lshlrev_b32 v108, 16, v42
    v_and_b32 v109, 0xffff0000, v42
    v_mul_f32 v108, s31, v108
    v_mul_f32 v109, s31, v109
    v_cvt_pk_bf16_f32 v42, v108, v109
    v_lshlrev_b32 v110, 16, v43
    v_and_b32 v111, 0xffff0000, v43
    v_mul_f32 v110, s31, v110
    v_mul_f32 v111, s31, v111
    v_cvt_pk_bf16_f32 v43, v110, v111
    s_waitcnt lgkmcnt(2)
    v_lshlrev_b32 v104, 16, v44
    v_and_b32 v105, 0xffff0000, v44
    v_mul_f32 v104, s31, v104
    v_mul_f32 v105, s31, v105
    v_cvt_pk_bf16_f32 v44, v104, v105
    v_lshlrev_b32 v106, 16, v45
    v_and_b32 v107, 0xffff0000, v45
    v_mul_f32 v106, s31, v106
    v_mul_f32 v107, s31, v107
    v_cvt_pk_bf16_f32 v45, v106, v107
    v_lshlrev_b32 v108, 16, v46
    v_and_b32 v109, 0xffff0000, v46
    v_mul_f32 v108, s31, v108
    v_mul_f32 v109, s31, v109
    v_cvt_pk_bf16_f32 v46, v108, v109
    v_lshlrev_b32 v110, 16, v47
    v_and_b32 v111, 0xffff0000, v47
    v_mul_f32 v110, s31, v110
    v_mul_f32 v111, s31, v111
    v_cvt_pk_bf16_f32 v47, v110, v111
    s_waitcnt lgkmcnt(1)
    v_lshlrev_b32 v104, 16, v48
    v_and_b32 v105, 0xffff0000, v48
    v_mul_f32 v104, s31, v104
    v_mul_f32 v105, s31, v105
    v_cvt_pk_bf16_f32 v48, v104, v105
    v_lshlrev_b32 v106, 16, v49
    v_and_b32 v107, 0xffff0000, v49
    v_mul_f32 v106, s31, v106
    v_mul_f32 v107, s31, v107
    v_cvt_pk_bf16_f32 v49, v106, v107
    v_lshlrev_b32 v108, 16, v50
    v_and_b32 v109, 0xffff0000, v50
    v_mul_f32 v108, s31, v108
    v_mul_f32 v109, s31, v109
    v_cvt_pk_bf16_f32 v50, v108, v109
    v_lshlrev_b32 v110, 16, v51
    v_and_b32 v111, 0xffff0000, v51
    v_mul_f32 v110, s31, v110
    v_mul_f32 v111, s31, v111
    v_cvt_pk_bf16_f32 v51, v110, v111
    s_waitcnt lgkmcnt(0)
    v_lshlrev_b32 v104, 16, v52
    v_and_b32 v105, 0xffff0000, v52
    v_mul_f32 v104, s31, v104
    v_mul_f32 v105, s31, v105
    v_cvt_pk_bf16_f32 v52, v104, v105
    v_lshlrev_b32 v106, 16, v53
    v_and_b32 v107, 0xffff0000, v53
    v_mul_f32 v106, s31, v106
    v_mul_f32 v107, s31, v107
    v_cvt_pk_bf16_f32 v53, v106, v107
    v_lshlrev_b32 v108, 16, v54
    v_and_b32 v109, 0xffff0000, v54
    v_mul_f32 v108, s31, v108
    v_mul_f32 v109, s31, v109
    v_cvt_pk_bf16_f32 v54, v108, v109
    v_lshlrev_b32 v110, 16, v55
    v_and_b32 v111, 0xffff0000, v55
    v_mul_f32 v110, s31, v110
    v_mul_f32 v111, s31, v111
    v_cvt_pk_bf16_f32 v55, v110, v111
    s_barrier
    v_add_u32 v10, 135168, v10
    ds_read_b128 v[16:19], v10 offset:0
    v_add_u32 v11, 135168, v11
    ds_read_b128 v[20:23], v11 offset:0
    ds_read_b128 v[24:27], v10 offset:2048
    ds_read_b128 v[28:31], v11 offset:2048
    ds_read_b128 v[32:35], v10 offset:4096
    s_waitcnt lgkmcnt(3)
    v_mfma_f32_16x16x32_bf16 v[240:243], v[16:19], v[40:43], 0
    ds_read_b128 v[36:39], v11 offset:4096
    v_mfma_f32_16x16x32_bf16 v[240:243], v[20:23], v[48:51], v[240:243]
    v_mfma_f32_16x16x32_bf16 v[248:251], v[16:19], v[44:47], 0
    v_mfma_f32_16x16x32_bf16 v[248:251], v[20:23], v[52:55], v[248:251]
    ds_read_b128 v[16:19], v10 offset:6144
    s_waitcnt lgkmcnt(3)
    v_mfma_f32_16x16x32_bf16 v[244:247], v[24:27], v[40:43], 0
    ds_read_b128 v[20:23], v11 offset:6144
    v_mfma_f32_16x16x32_bf16 v[244:247], v[28:31], v[48:51], v[244:247]
    v_mfma_f32_16x16x32_bf16 v[252:255], v[24:27], v[44:47], 0
    v_mfma_f32_16x16x32_bf16 v[252:255], v[28:31], v[52:55], v[252:255]
    ds_read_b128 v[24:27], v10 offset:8192
    s_waitcnt lgkmcnt(3)
    v_mfma_f32_16x16x32_bf16 v[224:227], v[32:35], v[40:43], 0
    ds_read_b128 v[28:31], v11 offset:8192
    v_mfma_f32_16x16x32_bf16 v[224:227], v[36:39], v[48:51], v[224:227]
    v_mfma_f32_16x16x32_bf16 v[232:235], v[32:35], v[44:47], 0
    v_mfma_f32_16x16x32_bf16 v[232:235], v[36:39], v[52:55], v[232:235]
    s_barrier
    s_add_u32 s36, s93, 4294832128
    v_add_u32 v8, s36, v10
    s_add_u32 s36, s93, 4294832128
    v_add_u32 v9, s36, v11
    ds_read_b128 v[56:59], v8 offset:0
    ds_read_b128 v[60:63], v8 offset:2048
    ds_read_b128 v[64:67], v9 offset:0
    ds_read_b128 v[68:71], v9 offset:2048
    ds_read_b128 v[32:35], v10 offset:10240
    s_waitcnt lgkmcnt(7)
    v_mfma_f32_16x16x32_bf16 v[228:231], v[16:19], v[40:43], 0
    ds_read_b128 v[36:39], v11 offset:10240
    v_mfma_f32_16x16x32_bf16 v[228:231], v[20:23], v[48:51], v[228:231]
    v_mfma_f32_16x16x32_bf16 v[236:239], v[16:19], v[44:47], 0
    v_mfma_f32_16x16x32_bf16 v[236:239], v[20:23], v[52:55], v[236:239]
    ds_read_b128 v[16:19], v10 offset:12288
    s_waitcnt lgkmcnt(7)
    v_mfma_f32_16x16x32_bf16 v[208:211], v[24:27], v[40:43], 0
    ds_read_b128 v[20:23], v11 offset:12288
    v_mfma_f32_16x16x32_bf16 v[208:211], v[28:31], v[48:51], v[208:211]
    v_mfma_f32_16x16x32_bf16 v[216:219], v[24:27], v[44:47], 0
    v_mfma_f32_16x16x32_bf16 v[216:219], v[28:31], v[52:55], v[216:219]
    ds_read_b128 v[24:27], v10 offset:14336
    s_waitcnt lgkmcnt(3)
    v_mfma_f32_16x16x32_bf16 v[212:215], v[32:35], v[40:43], 0
    ds_read_b128 v[28:31], v11 offset:14336
    v_lshlrev_b32 v104, 16, v56
    v_mfma_f32_16x16x32_bf16 v[212:215], v[36:39], v[48:51], v[212:215]
    v_and_b32 v105, 0xffff0000, v56
    v_mul_f32 v104, s31, v104
    v_mfma_f32_16x16x32_bf16 v[220:223], v[32:35], v[44:47], 0
    v_mul_f32 v105, s31, v105
    v_cvt_pk_bf16_f32 v56, v104, v105
    v_mfma_f32_16x16x32_bf16 v[220:223], v[36:39], v[52:55], v[220:223]
    v_lshlrev_b32 v106, 16, v57
    v_and_b32 v107, 0xffff0000, v57
    v_mul_f32 v106, s31, v106
    v_mul_f32 v107, s31, v107
    v_cvt_pk_bf16_f32 v57, v106, v107
    v_lshlrev_b32 v108, 16, v58
    v_and_b32 v109, 0xffff0000, v58
    v_mul_f32 v108, s31, v108
    v_mul_f32 v109, s31, v109
    v_cvt_pk_bf16_f32 v58, v108, v109
    v_lshlrev_b32 v110, 16, v59
    v_and_b32 v111, 0xffff0000, v59
    v_mul_f32 v110, s31, v110
    v_mul_f32 v111, s31, v111
    v_cvt_pk_bf16_f32 v59, v110, v111
    v_lshlrev_b32 v104, 16, v60
    v_and_b32 v105, 0xffff0000, v60
    v_mul_f32 v104, s31, v104
    v_mul_f32 v105, s31, v105
    v_cvt_pk_bf16_f32 v60, v104, v105
    v_lshlrev_b32 v106, 16, v61
    v_and_b32 v107, 0xffff0000, v61
    v_mul_f32 v106, s31, v106
    v_mul_f32 v107, s31, v107
    v_cvt_pk_bf16_f32 v61, v106, v107
    v_lshlrev_b32 v108, 16, v62
    v_and_b32 v109, 0xffff0000, v62
    v_mul_f32 v108, s31, v108
    v_mul_f32 v109, s31, v109
    v_cvt_pk_bf16_f32 v62, v108, v109
    v_lshlrev_b32 v110, 16, v63
    v_and_b32 v111, 0xffff0000, v63
    v_mul_f32 v110, s31, v110
    v_mul_f32 v111, s31, v111
    v_cvt_pk_bf16_f32 v63, v110, v111
    v_lshlrev_b32 v104, 16, v64
    v_and_b32 v105, 0xffff0000, v64
    v_mul_f32 v104, s31, v104
    v_mul_f32 v105, s31, v105
    v_cvt_pk_bf16_f32 v64, v104, v105
    v_lshlrev_b32 v106, 16, v65
    v_and_b32 v107, 0xffff0000, v65
    v_mul_f32 v106, s31, v106
    v_mul_f32 v107, s31, v107
    v_cvt_pk_bf16_f32 v65, v106, v107
    v_lshlrev_b32 v108, 16, v66
    v_and_b32 v109, 0xffff0000, v66
    v_mul_f32 v108, s31, v108
    v_mul_f32 v109, s31, v109
    v_cvt_pk_bf16_f32 v66, v108, v109
    v_lshlrev_b32 v110, 16, v67
    v_and_b32 v111, 0xffff0000, v67
    v_mul_f32 v110, s31, v110
    v_mul_f32 v111, s31, v111
    v_cvt_pk_bf16_f32 v67, v110, v111
    v_lshlrev_b32 v104, 16, v68
    v_and_b32 v105, 0xffff0000, v68
    v_mul_f32 v104, s31, v104
    v_mul_f32 v105, s31, v105
    v_cvt_pk_bf16_f32 v68, v104, v105
    v_lshlrev_b32 v106, 16, v69
    v_and_b32 v107, 0xffff0000, v69
    v_mul_f32 v106, s31, v106
    v_mul_f32 v107, s31, v107
    v_cvt_pk_bf16_f32 v69, v106, v107
    v_lshlrev_b32 v108, 16, v70
    v_and_b32 v109, 0xffff0000, v70
    v_mul_f32 v108, s31, v108
    v_mul_f32 v109, s31, v109
    v_cvt_pk_bf16_f32 v70, v108, v109
    v_lshlrev_b32 v110, 16, v71
    v_and_b32 v111, 0xffff0000, v71
    v_mul_f32 v110, s31, v110
    v_mul_f32 v111, s31, v111
    v_cvt_pk_bf16_f32 v71, v110, v111
    s_barrier
    v_subrev_u32 v10, 118272, v10
    ds_read_b128 v[32:35], v10 offset:0
    s_waitcnt lgkmcnt(3)
    v_mfma_f32_16x16x32_bf16 v[192:195], v[16:19], v[40:43], 0
    v_subrev_u32 v11, 118272, v11
    ds_read_b128 v[36:39], v11 offset:0
    v_mfma_f32_16x16x32_bf16 v[192:195], v[20:23], v[48:51], v[192:195]
    v_mfma_f32_16x16x32_bf16 v[200:203], v[16:19], v[44:47], 0
    v_mfma_f32_16x16x32_bf16 v[200:203], v[20:23], v[52:55], v[200:203]
    ds_read_b128 v[16:19], v10 offset:2048
    s_waitcnt lgkmcnt(3)
    v_mfma_f32_16x16x32_bf16 v[196:199], v[24:27], v[40:43], 0
    ds_read_b128 v[20:23], v11 offset:2048
    v_mfma_f32_16x16x32_bf16 v[196:199], v[28:31], v[48:51], v[196:199]
    v_mfma_f32_16x16x32_bf16 v[204:207], v[24:27], v[44:47], 0
    v_mfma_f32_16x16x32_bf16 v[204:207], v[28:31], v[52:55], v[204:207]
    ds_read_b128 v[24:27], v10 offset:4096
    s_waitcnt lgkmcnt(3)
    v_mfma_f32_16x16x32_bf16 v[240:243], v[32:35], v[56:59], v[240:243]
    ds_read_b128 v[28:31], v11 offset:4096
    v_mfma_f32_16x16x32_bf16 v[240:243], v[36:39], v[64:67], v[240:243]
    v_mfma_f32_16x16x32_bf16 v[248:251], v[32:35], v[60:63], v[248:251]
    v_mfma_f32_16x16x32_bf16 v[248:251], v[36:39], v[68:71], v[248:251]
    ds_read_b128 v[32:35], v10 offset:6144
    s_waitcnt lgkmcnt(3)
    v_mfma_f32_16x16x32_bf16 v[244:247], v[16:19], v[56:59], v[244:247]
    ds_read_b128 v[36:39], v11 offset:6144
    v_mfma_f32_16x16x32_bf16 v[244:247], v[20:23], v[64:67], v[244:247]
    v_mfma_f32_16x16x32_bf16 v[252:255], v[16:19], v[60:63], v[252:255]
    v_mfma_f32_16x16x32_bf16 v[252:255], v[20:23], v[68:71], v[252:255]
    ds_read_b128 v[16:19], v10 offset:8192
    s_waitcnt lgkmcnt(3)
    v_mfma_f32_16x16x32_bf16 v[224:227], v[24:27], v[56:59], v[224:227]
    ds_read_b128 v[20:23], v11 offset:8192
    v_mfma_f32_16x16x32_bf16 v[224:227], v[28:31], v[64:67], v[224:227]
    v_mfma_f32_16x16x32_bf16 v[232:235], v[24:27], v[60:63], v[232:235]
    v_mfma_f32_16x16x32_bf16 v[232:235], v[28:31], v[68:71], v[232:235]
    s_barrier
    s_add_u32 s36, s93, 16896
    v_add_u32 v8, s36, v10
    s_add_u32 s36, s93, 16896
    v_add_u32 v9, s36, v11
    ds_read_b128 v[72:75], v8 offset:0
    ds_read_b128 v[76:79], v8 offset:2048
    ds_read_b128 v[80:83], v9 offset:0
    ds_read_b128 v[84:87], v9 offset:2048
    ds_read_b128 v[24:27], v10 offset:10240
    s_waitcnt lgkmcnt(7)
    v_mfma_f32_16x16x32_bf16 v[228:231], v[32:35], v[56:59], v[228:231]
    ds_read_b128 v[28:31], v11 offset:10240
    v_mfma_f32_16x16x32_bf16 v[228:231], v[36:39], v[64:67], v[228:231]
    v_mfma_f32_16x16x32_bf16 v[236:239], v[32:35], v[60:63], v[236:239]
    v_mfma_f32_16x16x32_bf16 v[236:239], v[36:39], v[68:71], v[236:239]
    ds_read_b128 v[32:35], v10 offset:12288
    s_waitcnt lgkmcnt(7)
    v_mfma_f32_16x16x32_bf16 v[208:211], v[16:19], v[56:59], v[208:211]
    ds_read_b128 v[36:39], v11 offset:12288
    v_mfma_f32_16x16x32_bf16 v[208:211], v[20:23], v[64:67], v[208:211]
    v_mfma_f32_16x16x32_bf16 v[216:219], v[16:19], v[60:63], v[216:219]
    v_mfma_f32_16x16x32_bf16 v[216:219], v[20:23], v[68:71], v[216:219]
    ds_read_b128 v[16:19], v10 offset:14336
    s_waitcnt lgkmcnt(3)
    v_mfma_f32_16x16x32_bf16 v[212:215], v[24:27], v[56:59], v[212:215]
    ds_read_b128 v[20:23], v11 offset:14336
    v_lshlrev_b32 v104, 16, v72
    v_mfma_f32_16x16x32_bf16 v[212:215], v[28:31], v[64:67], v[212:215]
    v_and_b32 v105, 0xffff0000, v72
    v_mul_f32 v104, s31, v104
    v_mfma_f32_16x16x32_bf16 v[220:223], v[24:27], v[60:63], v[220:223]
    v_mul_f32 v105, s31, v105
    v_cvt_pk_bf16_f32 v72, v104, v105
    v_mfma_f32_16x16x32_bf16 v[220:223], v[28:31], v[68:71], v[220:223]
    v_lshlrev_b32 v106, 16, v73
    v_and_b32 v107, 0xffff0000, v73
    v_mul_f32 v106, s31, v106
    v_mul_f32 v107, s31, v107
    v_cvt_pk_bf16_f32 v73, v106, v107
    v_lshlrev_b32 v108, 16, v74
    v_and_b32 v109, 0xffff0000, v74
    v_mul_f32 v108, s31, v108
    v_mul_f32 v109, s31, v109
    v_cvt_pk_bf16_f32 v74, v108, v109
    v_lshlrev_b32 v110, 16, v75
    v_and_b32 v111, 0xffff0000, v75
    v_mul_f32 v110, s31, v110
    v_mul_f32 v111, s31, v111
    v_cvt_pk_bf16_f32 v75, v110, v111
    v_lshlrev_b32 v104, 16, v76
    v_and_b32 v105, 0xffff0000, v76
    v_mul_f32 v104, s31, v104
    v_mul_f32 v105, s31, v105
    v_cvt_pk_bf16_f32 v76, v104, v105
    v_lshlrev_b32 v106, 16, v77
    v_and_b32 v107, 0xffff0000, v77
    v_mul_f32 v106, s31, v106
    v_mul_f32 v107, s31, v107
    v_cvt_pk_bf16_f32 v77, v106, v107
    v_lshlrev_b32 v108, 16, v78
    v_and_b32 v109, 0xffff0000, v78
    v_mul_f32 v108, s31, v108
    v_mul_f32 v109, s31, v109
    v_cvt_pk_bf16_f32 v78, v108, v109
    v_lshlrev_b32 v110, 16, v79
    v_and_b32 v111, 0xffff0000, v79
    v_mul_f32 v110, s31, v110
    v_mul_f32 v111, s31, v111
    v_cvt_pk_bf16_f32 v79, v110, v111
    v_lshlrev_b32 v104, 16, v80
    v_and_b32 v105, 0xffff0000, v80
    v_mul_f32 v104, s31, v104
    v_mul_f32 v105, s31, v105
    v_cvt_pk_bf16_f32 v80, v104, v105
    v_lshlrev_b32 v106, 16, v81
    v_and_b32 v107, 0xffff0000, v81
    v_mul_f32 v106, s31, v106
    v_mul_f32 v107, s31, v107
    v_cvt_pk_bf16_f32 v81, v106, v107
    v_lshlrev_b32 v108, 16, v82
    v_and_b32 v109, 0xffff0000, v82
    v_mul_f32 v108, s31, v108
    v_mul_f32 v109, s31, v109
    v_cvt_pk_bf16_f32 v82, v108, v109
    v_lshlrev_b32 v110, 16, v83
    v_and_b32 v111, 0xffff0000, v83
    v_mul_f32 v110, s31, v110
    v_mul_f32 v111, s31, v111
    v_cvt_pk_bf16_f32 v83, v110, v111
    v_lshlrev_b32 v104, 16, v84
    v_and_b32 v105, 0xffff0000, v84
    v_mul_f32 v104, s31, v104
    v_mul_f32 v105, s31, v105
    v_cvt_pk_bf16_f32 v84, v104, v105
    v_lshlrev_b32 v106, 16, v85
    v_and_b32 v107, 0xffff0000, v85
    v_mul_f32 v106, s31, v106
    v_mul_f32 v107, s31, v107
    v_cvt_pk_bf16_f32 v85, v106, v107
    v_lshlrev_b32 v108, 16, v86
    v_and_b32 v109, 0xffff0000, v86
    v_mul_f32 v108, s31, v108
    v_mul_f32 v109, s31, v109
    v_cvt_pk_bf16_f32 v86, v108, v109
    v_lshlrev_b32 v110, 16, v87
    v_and_b32 v111, 0xffff0000, v87
    v_mul_f32 v110, s31, v110
    v_mul_f32 v111, s31, v111
    v_cvt_pk_bf16_f32 v87, v110, v111
    s_barrier
    ds_read_b128 v[24:27], v10 offset:33792
    s_waitcnt lgkmcnt(3)
    v_mfma_f32_16x16x32_bf16 v[192:195], v[32:35], v[56:59], v[192:195]
    ds_read_b128 v[28:31], v11 offset:33792
    v_mfma_f32_16x16x32_bf16 v[192:195], v[36:39], v[64:67], v[192:195]
    v_mfma_f32_16x16x32_bf16 v[200:203], v[32:35], v[60:63], v[200:203]
    v_mfma_f32_16x16x32_bf16 v[200:203], v[36:39], v[68:71], v[200:203]
    ds_read_b128 v[32:35], v10 offset:35840
    s_waitcnt lgkmcnt(3)
    v_mfma_f32_16x16x32_bf16 v[196:199], v[16:19], v[56:59], v[196:199]
    ds_read_b128 v[36:39], v11 offset:35840
    v_mfma_f32_16x16x32_bf16 v[196:199], v[20:23], v[64:67], v[196:199]
    v_mfma_f32_16x16x32_bf16 v[204:207], v[16:19], v[60:63], v[204:207]
    v_mfma_f32_16x16x32_bf16 v[204:207], v[20:23], v[68:71], v[204:207]
    ds_read_b128 v[16:19], v10 offset:37888
    s_waitcnt lgkmcnt(3)
    v_mfma_f32_16x16x32_bf16 v[240:243], v[24:27], v[72:75], v[240:243]
    ds_read_b128 v[20:23], v11 offset:37888
    v_mfma_f32_16x16x32_bf16 v[240:243], v[28:31], v[80:83], v[240:243]
    v_mfma_f32_16x16x32_bf16 v[248:251], v[24:27], v[76:79], v[248:251]
    v_mfma_f32_16x16x32_bf16 v[248:251], v[28:31], v[84:87], v[248:251]
    ds_read_b128 v[24:27], v10 offset:39936
    s_waitcnt lgkmcnt(3)
    v_mfma_f32_16x16x32_bf16 v[244:247], v[32:35], v[72:75], v[244:247]
    ds_read_b128 v[28:31], v11 offset:39936
    v_mfma_f32_16x16x32_bf16 v[244:247], v[36:39], v[80:83], v[244:247]
    v_mfma_f32_16x16x32_bf16 v[252:255], v[32:35], v[76:79], v[252:255]
    v_mfma_f32_16x16x32_bf16 v[252:255], v[36:39], v[84:87], v[252:255]
    ds_read_b128 v[32:35], v10 offset:41984
    s_waitcnt lgkmcnt(3)
    v_mfma_f32_16x16x32_bf16 v[224:227], v[16:19], v[72:75], v[224:227]
    ds_read_b128 v[36:39], v11 offset:41984
    v_mfma_f32_16x16x32_bf16 v[224:227], v[20:23], v[80:83], v[224:227]
    v_mfma_f32_16x16x32_bf16 v[232:235], v[16:19], v[76:79], v[232:235]
    v_mfma_f32_16x16x32_bf16 v[232:235], v[20:23], v[84:87], v[232:235]
    s_barrier
    s_add_u32 s36, s93, 50688
    v_add_u32 v8, s36, v10
    s_add_u32 s36, s93, 50688
    v_add_u32 v9, s36, v11
    ds_read_b128 v[88:91], v8 offset:0
    ds_read_b128 v[92:95], v8 offset:2048
    ds_read_b128 v[96:99], v9 offset:0
    ds_read_b128 v[100:103], v9 offset:2048
    ds_read_b128 v[16:19], v10 offset:44032
    s_waitcnt lgkmcnt(7)
    v_mfma_f32_16x16x32_bf16 v[228:231], v[24:27], v[72:75], v[228:231]
    ds_read_b128 v[20:23], v11 offset:44032
    v_mfma_f32_16x16x32_bf16 v[228:231], v[28:31], v[80:83], v[228:231]
    v_mfma_f32_16x16x32_bf16 v[236:239], v[24:27], v[76:79], v[236:239]
    v_mfma_f32_16x16x32_bf16 v[236:239], v[28:31], v[84:87], v[236:239]
    ds_read_b128 v[24:27], v10 offset:46080
    s_waitcnt lgkmcnt(7)
    v_mfma_f32_16x16x32_bf16 v[208:211], v[32:35], v[72:75], v[208:211]
    ds_read_b128 v[28:31], v11 offset:46080
    v_mfma_f32_16x16x32_bf16 v[208:211], v[36:39], v[80:83], v[208:211]
    v_mfma_f32_16x16x32_bf16 v[216:219], v[32:35], v[76:79], v[216:219]
    v_mfma_f32_16x16x32_bf16 v[216:219], v[36:39], v[84:87], v[216:219]
    ds_read_b128 v[32:35], v10 offset:48128
    s_waitcnt lgkmcnt(3)
    v_mfma_f32_16x16x32_bf16 v[212:215], v[16:19], v[72:75], v[212:215]
    ds_read_b128 v[36:39], v11 offset:48128
    v_lshlrev_b32 v104, 16, v88
    v_mfma_f32_16x16x32_bf16 v[212:215], v[20:23], v[80:83], v[212:215]
    v_and_b32 v105, 0xffff0000, v88
    v_mul_f32 v104, s31, v104
    v_mfma_f32_16x16x32_bf16 v[220:223], v[16:19], v[76:79], v[220:223]
    v_mul_f32 v105, s31, v105
    v_cvt_pk_bf16_f32 v88, v104, v105
    v_mfma_f32_16x16x32_bf16 v[220:223], v[20:23], v[84:87], v[220:223]
    v_lshlrev_b32 v106, 16, v89
    v_and_b32 v107, 0xffff0000, v89
    v_mul_f32 v106, s31, v106
    v_mul_f32 v107, s31, v107
    v_cvt_pk_bf16_f32 v89, v106, v107
    v_lshlrev_b32 v108, 16, v90
    v_and_b32 v109, 0xffff0000, v90
    v_mul_f32 v108, s31, v108
    v_mul_f32 v109, s31, v109
    v_cvt_pk_bf16_f32 v90, v108, v109
    v_lshlrev_b32 v110, 16, v91
    v_and_b32 v111, 0xffff0000, v91
    v_mul_f32 v110, s31, v110
    v_mul_f32 v111, s31, v111
    v_cvt_pk_bf16_f32 v91, v110, v111
    v_lshlrev_b32 v104, 16, v92
    v_and_b32 v105, 0xffff0000, v92
    v_mul_f32 v104, s31, v104
    v_mul_f32 v105, s31, v105
    v_cvt_pk_bf16_f32 v92, v104, v105
    v_lshlrev_b32 v106, 16, v93
    v_and_b32 v107, 0xffff0000, v93
    v_mul_f32 v106, s31, v106
    v_mul_f32 v107, s31, v107
    v_cvt_pk_bf16_f32 v93, v106, v107
    v_lshlrev_b32 v108, 16, v94
    v_and_b32 v109, 0xffff0000, v94
    v_mul_f32 v108, s31, v108
    v_mul_f32 v109, s31, v109
    v_cvt_pk_bf16_f32 v94, v108, v109
    v_lshlrev_b32 v110, 16, v95
    v_and_b32 v111, 0xffff0000, v95
    v_mul_f32 v110, s31, v110
    v_mul_f32 v111, s31, v111
    v_cvt_pk_bf16_f32 v95, v110, v111
    v_lshlrev_b32 v104, 16, v96
    v_and_b32 v105, 0xffff0000, v96
    v_mul_f32 v104, s31, v104
    v_mul_f32 v105, s31, v105
    v_cvt_pk_bf16_f32 v96, v104, v105
    v_lshlrev_b32 v106, 16, v97
    v_and_b32 v107, 0xffff0000, v97
    v_mul_f32 v106, s31, v106
    v_mul_f32 v107, s31, v107
    v_cvt_pk_bf16_f32 v97, v106, v107
    v_lshlrev_b32 v108, 16, v98
    v_and_b32 v109, 0xffff0000, v98
    v_mul_f32 v108, s31, v108
    v_mul_f32 v109, s31, v109
    v_cvt_pk_bf16_f32 v98, v108, v109
    v_lshlrev_b32 v110, 16, v99
    v_and_b32 v111, 0xffff0000, v99
    v_mul_f32 v110, s31, v110
    v_mul_f32 v111, s31, v111
    v_cvt_pk_bf16_f32 v99, v110, v111
    v_lshlrev_b32 v104, 16, v100
    v_and_b32 v105, 0xffff0000, v100
    v_mul_f32 v104, s31, v104
    v_mul_f32 v105, s31, v105
    v_cvt_pk_bf16_f32 v100, v104, v105
    v_lshlrev_b32 v106, 16, v101
    v_and_b32 v107, 0xffff0000, v101
    v_mul_f32 v106, s31, v106
    v_mul_f32 v107, s31, v107
    v_cvt_pk_bf16_f32 v101, v106, v107
    v_lshlrev_b32 v108, 16, v102
    v_and_b32 v109, 0xffff0000, v102
    v_mul_f32 v108, s31, v108
    v_mul_f32 v109, s31, v109
    v_cvt_pk_bf16_f32 v102, v108, v109
    v_lshlrev_b32 v110, 16, v103
    v_and_b32 v111, 0xffff0000, v103
    v_mul_f32 v110, s31, v110
    v_mul_f32 v111, s31, v111
    v_cvt_pk_bf16_f32 v103, v110, v111
    s_barrier
    v_add_u32 v10, 67584, v10
    ds_read_b128 v[16:19], v10 offset:0
    s_waitcnt lgkmcnt(3)
    v_mfma_f32_16x16x32_bf16 v[192:195], v[24:27], v[72:75], v[192:195]
    v_add_u32 v11, 67584, v11
    ds_read_b128 v[20:23], v11 offset:0
    v_mfma_f32_16x16x32_bf16 v[192:195], v[28:31], v[80:83], v[192:195]
    v_mfma_f32_16x16x32_bf16 v[200:203], v[24:27], v[76:79], v[200:203]
    v_mfma_f32_16x16x32_bf16 v[200:203], v[28:31], v[84:87], v[200:203]
    ds_read_b128 v[24:27], v10 offset:2048
    s_waitcnt lgkmcnt(3)
    v_mfma_f32_16x16x32_bf16 v[196:199], v[32:35], v[72:75], v[196:199]
    ds_read_b128 v[28:31], v11 offset:2048
    v_mfma_f32_16x16x32_bf16 v[196:199], v[36:39], v[80:83], v[196:199]
    v_mfma_f32_16x16x32_bf16 v[204:207], v[32:35], v[76:79], v[204:207]
    v_mfma_f32_16x16x32_bf16 v[204:207], v[36:39], v[84:87], v[204:207]
    ds_read_b128 v[32:35], v10 offset:4096
    s_waitcnt lgkmcnt(3)
    v_mfma_f32_16x16x32_bf16 v[240:243], v[16:19], v[88:91], v[240:243]
    ds_read_b128 v[36:39], v11 offset:4096
    v_mfma_f32_16x16x32_bf16 v[240:243], v[20:23], v[96:99], v[240:243]
    v_mfma_f32_16x16x32_bf16 v[248:251], v[16:19], v[92:95], v[248:251]
    v_mfma_f32_16x16x32_bf16 v[248:251], v[20:23], v[100:103], v[248:251]
    ds_read_b128 v[16:19], v10 offset:6144
    s_waitcnt lgkmcnt(3)
    v_mfma_f32_16x16x32_bf16 v[244:247], v[24:27], v[88:91], v[244:247]
    ds_read_b128 v[20:23], v11 offset:6144
    v_mfma_f32_16x16x32_bf16 v[244:247], v[28:31], v[96:99], v[244:247]
    v_mfma_f32_16x16x32_bf16 v[252:255], v[24:27], v[92:95], v[252:255]
    v_mfma_f32_16x16x32_bf16 v[252:255], v[28:31], v[100:103], v[252:255]
    ds_read_b128 v[24:27], v10 offset:8192
    s_waitcnt lgkmcnt(3)
    v_mfma_f32_16x16x32_bf16 v[224:227], v[32:35], v[88:91], v[224:227]
    ds_read_b128 v[28:31], v11 offset:8192
    v_mfma_f32_16x16x32_bf16 v[224:227], v[36:39], v[96:99], v[224:227]
    v_exp_f32 v240, v240
    v_mfma_f32_16x16x32_bf16 v[232:235], v[32:35], v[92:95], v[232:235]
    v_exp_f32 v241, v241
    v_mfma_f32_16x16x32_bf16 v[232:235], v[36:39], v[100:103], v[232:235]
    ds_read_b128 v[32:35], v10 offset:10240
    s_waitcnt lgkmcnt(3)
    v_mfma_f32_16x16x32_bf16 v[228:231], v[16:19], v[88:91], v[228:231]
    ds_read_b128 v[36:39], v11 offset:10240
    v_cvt_pk_bf16_f32 v104, v240, v241
    v_mfma_f32_16x16x32_bf16 v[228:231], v[20:23], v[96:99], v[228:231]
    v_exp_f32 v242, v242
    v_mfma_f32_16x16x32_bf16 v[236:239], v[16:19], v[92:95], v[236:239]
    v_exp_f32 v243, v243
    v_mfma_f32_16x16x32_bf16 v[236:239], v[20:23], v[100:103], v[236:239]
    ds_read_b128 v[16:19], v10 offset:12288
    s_waitcnt lgkmcnt(3)
    v_mfma_f32_16x16x32_bf16 v[208:211], v[24:27], v[88:91], v[208:211]
    ds_read_b128 v[20:23], v11 offset:12288
    v_cvt_pk_bf16_f32 v105, v242, v243
    v_mfma_f32_16x16x32_bf16 v[208:211], v[28:31], v[96:99], v[208:211]
    v_exp_f32 v244, v244
    v_mfma_f32_16x16x32_bf16 v[216:219], v[24:27], v[92:95], v[216:219]
    v_exp_f32 v245, v245
    v_mfma_f32_16x16x32_bf16 v[216:219], v[28:31], v[100:103], v[216:219]
    ds_read_b128 v[24:27], v10 offset:14336
    s_waitcnt lgkmcnt(3)
    v_mfma_f32_16x16x32_bf16 v[212:215], v[32:35], v[88:91], v[212:215]
    ds_read_b128 v[28:31], v11 offset:14336
    v_cvt_pk_bf16_f32 v106, v244, v245
    v_mfma_f32_16x16x32_bf16 v[212:215], v[36:39], v[96:99], v[212:215]
    v_exp_f32 v246, v246
    v_mfma_f32_16x16x32_bf16 v[220:223], v[32:35], v[92:95], v[220:223]
    v_exp_f32 v247, v247
    v_mfma_f32_16x16x32_bf16 v[220:223], v[36:39], v[100:103], v[220:223]
    s_barrier
    v_add_u32 v1, 101376, v1
    ds_read_b128 v[32:35], v1 offset:0
    s_waitcnt lgkmcnt(3)
    v_mfma_f32_16x16x32_bf16 v[192:195], v[16:19], v[88:91], v[192:195]
    ds_read_b128 v[36:39], v1 offset:64
    v_cvt_pk_bf16_f32 v107, v246, v247
    v_mfma_f32_16x16x32_bf16 v[192:195], v[20:23], v[96:99], v[192:195]
    v_exp_f32 v248, v248
    v_mfma_f32_16x16x32_bf16 v[200:203], v[16:19], v[92:95], v[200:203]
L_pad0:
    s_cbranch_execz L_back0
    v_exp_f32 v249, v249
    v_mfma_f32_16x16x32_bf16 v[200:203], v[20:23], v[100:103], v[200:203]
    ds_read_b128 v[16:19], v1 offset:128
    s_waitcnt lgkmcnt(3)
    v_mfma_f32_16x16x32_bf16 v[196:199], v[24:27], v[88:91], v[196:199]
    ds_read_b128 v[20:23], v1 offset:192
    v_cvt_pk_bf16_f32 v108, v248, v249
    v_mfma_f32_16x16x32_bf16 v[196:199], v[28:31], v[96:99], v[196:199]
    v_exp_f32 v250, v250
    v_mfma_f32_16x16x32_bf16 v[204:207], v[24:27], v[92:95], v[204:207]
    v_exp_f32 v251, v251
    v_mfma_f32_16x16x32_bf16 v[204:207], v[28:31], v[100:103], v[204:207]
    ds_read_b128 v[24:27], v1 offset:256
    s_waitcnt lgkmcnt(3)
    v_mfma_f32_16x16x32_bf16 v[176:179], v[32:35], v[40:43], 0
    ds_read_b128 v[28:31], v1 offset:320
    v_cvt_pk_bf16_f32 v109, v250, v251
    v_mfma_f32_16x16x32_bf16 v[176:179], v[36:39], v[48:51], v[176:179]
    v_exp_f32 v252, v252
    v_mfma_f32_16x16x32_bf16 v[184:187], v[32:35], v[44:47], 0
    v_exp_f32 v253, v253
    v_mfma_f32_16x16x32_bf16 v[184:187], v[36:39], v[52:55], v[184:187]
    ds_read_b128 v[32:35], v1 offset:384
    s_waitcnt lgkmcnt(3)
    v_mfma_f32_16x16x32_bf16 v[184:187], v[16:19], v[60:63], v[184:187]
    ds_read_b128 v[36:39], v1 offset:448
    v_cvt_pk_bf16_f32 v110, v252, v253
    v_mfma_f32_16x16x32_bf16 v[184:187], v[20:23], v[68:71], v[184:187]
    v_exp_f32 v254, v254
    v_mfma_f32_16x16x32_bf16 v[176:179], v[16:19], v[56:59], v[176:179]
    v_exp_f32 v255, v255
    v_mfma_f32_16x16x32_bf16 v[176:179], v[20:23], v[64:67], v[176:179]
    ds_read_b128 v[16:19], v1 offset:8448
    s_waitcnt lgkmcnt(3)
    v_mfma_f32_16x16x32_bf16 v[176:179], v[24:27], v[72:75], v[176:179]
    ds_read_b128 v[20:23], v1 offset:8512
    v_cvt_pk_bf16_f32 v111, v254, v255
    v_mfma_f32_16x16x32_bf16 v[176:179], v[28:31], v[80:83], v[176:179]
    v_exp_f32 v224, v224
    v_mfma_f32_16x16x32_bf16 v[184:187], v[24:27], v[76:79], v[184:187]
    v_exp_f32 v225, v225
    v_mfma_f32_16x16x32_bf16 v[184:187], v[28:31], v[84:87], v[184:187]
    ds_read_b128 v[24:27], v1 offset:8576
    s_waitcnt lgkmcnt(3)
    v_mfma_f32_16x16x32_bf16 v[184:187], v[32:35], v[92:95], v[184:187]
    ds_read_b128 v[28:31], v1 offset:8640
    v_cvt_pk_bf16_f32 v112, v224, v225
    v_mfma_f32_16x16x32_bf16 v[184:187], v[36:39], v[100:103], v[184:187]
    v_exp_f32 v226, v226
    v_mfma_f32_16x16x32_bf16 v[176:179], v[32:35], v[88:91], v[176:179]
    v_exp_f32 v227, v227
    v_mfma_f32_16x16x32_bf16 v[176:179], v[36:39], v[96:99], v[176:179]
    ds_read_b128 v[32:35], v1 offset:8704
    s_waitcnt lgkmcnt(3)
    v_mfma_f32_16x16x32_bf16 v[180:183], v[16:19], v[40:43], 0
    ds_read_b128 v[36:39], v1 offset:8768
    v_cvt_pk_bf16_f32 v113, v226, v227
    v_mfma_f32_16x16x32_bf16 v[180:183], v[20:23], v[48:51], v[180:183]
    v_exp_f32 v228, v228
    v_mfma_f32_16x16x32_bf16 v[188:191], v[16:19], v[44:47], 0
    v_exp_f32 v229, v229
    v_mfma_f32_16x16x32_bf16 v[188:191], v[20:23], v[52:55], v[188:191]
    ds_read_b128 v[16:19], v1 offset:8832
    s_waitcnt lgkmcnt(3)
    v_mfma_f32_16x16x32_bf16 v[188:191], v[24:27], v[60:63], v[188:191]
    ds_read_b128 v[20:23], v1 offset:8896
    v_cvt_pk_bf16_f32 v114, v228, v229
    v_mfma_f32_16x16x32_bf16 v[188:191], v[28:31], v[68:71], v[188:191]
    v_exp_f32 v230, v230
    v_mfma_f32_16x16x32_bf16 v[180:183], v[24:27], v[56:59], v[180:183]
    v_exp_f32 v231, v231
    v_mfma_f32_16x16x32_bf16 v[180:183], v[28:31], v[64:67], v[180:183]
    s_barrier
    ds_read_b128 v[24:27], v1 offset:16896
    s_waitcnt lgkmcnt(3)
    v_mfma_f32_16x16x32_bf16 v[180:183], v[32:35], v[72:75], v[180:183]
    ds_read_b128 v[28:31], v1 offset:16960
    v_cvt_pk_bf16_f32 v115, v230, v231
    v_mfma_f32_16x16x32_bf16 v[180:183], v[36:39], v[80:83], v[180:183]
    v_exp_f32 v232, v232
    v_mfma_f32_16x16x32_bf16 v[188:191], v[32:35], v[76:79], v[188:191]
    v_exp_f32 v233, v233
    v_mfma_f32_16x16x32_bf16 v[188:191], v[36:39], v[84:87], v[188:191]
    ds_read_b128 v[32:35], v1 offset:17024
    s_waitcnt lgkmcnt(3)
    v_mfma_f32_16x16x32_bf16 v[188:191], v[16:19], v[92:95], v[188:191]
    ds_read_b128 v[36:39], v1 offset:17088
    v_cvt_pk_bf16_f32 v116, v232, v233
    v_mfma_f32_16x16x32_bf16 v[188:191], v[20:23], v[100:103], v[188:191]
    v_exp_f32 v234, v234
    v_mfma_f32_16x16x32_bf16 v[180:183], v[16:19], v[88:91], v[180:183]
    v_exp_f32 v235, v235
    v_mfma_f32_16x16x32_bf16 v[180:183], v[20:23], v[96:99], v[180:183]
    ds_read_b128 v[16:19], v1 offset:17152
    s_waitcnt lgkmcnt(3)
    v_mfma_f32_16x16x32_bf16 v[240:243], v[24:27], v[40:43], 0
    ds_read_b128 v[20:23], v1 offset:17216
    v_cvt_pk_bf16_f32 v117, v234, v235
    v_mfma_f32_16x16x32_bf16 v[240:243], v[28:31], v[48:51], v[240:243]
    v_exp_f32 v236, v236
    v_mfma_f32_16x16x32_bf16 v[248:251], v[24:27], v[44:47], 0
    v_exp_f32 v237, v237
    v_mfma_f32_16x16x32_bf16 v[248:251], v[28:31], v[52:55], v[248:251]
    ds_read_b128 v[24:27], v1 offset:17280
    s_waitcnt lgkmcnt(3)
    v_mfma_f32_16x16x32_bf16 v[248:251], v[32:35], v[60:63], v[248:251]
    ds_read_b128 v[28:31], v1 offset:17344
    v_cvt_pk_bf16_f32 v118, v236, v237
    v_mfma_f32_16x16x32_bf16 v[248:251], v[36:39], v[68:71], v[248:251]
    v_exp_f32 v238, v238
    v_mfma_f32_16x16x32_bf16 v[240:243], v[32:35], v[56:59], v[240:243]
    v_exp_f32 v239, v239
    v_mfma_f32_16x16x32_bf16 v[240:243], v[36:39], v[64:67], v[240:243]
    ds_read_b128 v[32:35], v1 offset:25344
    s_waitcnt lgkmcnt(3)
    v_mfma_f32_16x16x32_bf16 v[240:243], v[16:19], v[72:75], v[240:243]
    ds_read_b128 v[36:39], v1 offset:25408
    v_cvt_pk_bf16_f32 v119, v238, v239
    v_mfma_f32_16x16x32_bf16 v[240:243], v[20:23], v[80:83], v[240:243]
    v_exp_f32 v208, v208
    v_mfma_f32_16x16x32_bf16 v[248:251], v[16:19], v[76:79], v[248:251]
    v_exp_f32 v209, v209
    v_mfma_f32_16x16x32_bf16 v[248:251], v[20:23], v[84:87], v[248:251]
    ds_read_b128 v[16:19], v1 offset:25472
    s_waitcnt lgkmcnt(3)
    v_mfma_f32_16x16x32_bf16 v[248:251], v[24:27], v[92:95], v[248:251]
    ds_read_b128 v[20:23], v1 offset:25536
    v_cvt_pk_bf16_f32 v120, v208, v209
    v_mfma_f32_16x16x32_bf16 v[248:251], v[28:31], v[100:103], v[248:251]
    v_exp_f32 v210, v210
    v_mfma_f32_16x16x32_bf16 v[240:243], v[24:27], v[88:91], v[240:243]
    v_exp_f32 v211, v211
    v_mfma_f32_16x16x32_bf16 v[240:243], v[28:31], v[96:99], v[240:243]
    ds_read_b128 v[24:27], v1 offset:25600
    s_waitcnt lgkmcnt(3)
    v_mfma_f32_16x16x32_bf16 v[244:247], v[32:35], v[40:43], 0
    ds_read_b128 v[28:31], v1 offset:25664
    v_cvt_pk_bf16_f32 v121, v210, v211
    v_mfma_f32_16x16x32_bf16 v[244:247], v[36:39], v[48:51], v[244:247]
    v_exp_f32 v212, v212
    v_mfma_f32_16x16x32_bf16 v[252:255], v[32:35], v[44:47], 0
    v_exp_f32 v213, v213
    v_mfma_f32_16x16x32_bf16 v[252:255], v[36:39], v[52:55], v[252:255]
    ds_read_b128 v[32:35], v1 offset:25728
    s_waitcnt lgkmcnt(3)
    v_mfma_f32_16x16x32_bf16 v[252:255], v[16:19], v[60:63], v[252:255]
    ds_read_b128 v[36:39], v1 offset:25792
    v_cvt_pk_bf16_f32 v122, v212, v213
    v_mfma_f32_16x16x32_bf16 v[252:255], v[20:23], v[68:71], v[252:255]
    v_exp_f32 v214, v214
    v_mfma_f32_16x16x32_bf16 v[244:247], v[16:19], v[56:59], v[244:247]
    v_exp_f32 v215, v215
    v_mfma_f32_16x16x32_bf16 v[244:247], v[20:23], v[64:67], v[244:247]
    s_barrier
    ds_read_b128 v[16:19], v1 offset:33792
    s_waitcnt lgkmcnt(3)
    v_mfma_f32_16x16x32_bf16 v[244:247], v[24:27], v[72:75], v[244:247]
    ds_read_b128 v[20:23], v1 offset:33856
    v_cvt_pk_bf16_f32 v123, v214, v215
    v_mfma_f32_16x16x32_bf16 v[244:247], v[28:31], v[80:83], v[244:247]
    v_exp_f32 v216, v216
    v_mfma_f32_16x16x32_bf16 v[252:255], v[24:27], v[76:79], v[252:255]
    v_exp_f32 v217, v217
    v_mfma_f32_16x16x32_bf16 v[252:255], v[28:31], v[84:87], v[252:255]
    ds_read_b128 v[24:27], v1 offset:33920
    s_waitcnt lgkmcnt(3)
    v_mfma_f32_16x16x32_bf16 v[252:255], v[32:35], v[92:95], v[252:255]
    ds_read_b128 v[28:31], v1 offset:33984
    v_cvt_pk_bf16_f32 v124, v216, v217
    v_mfma_f32_16x16x32_bf16 v[252:255], v[36:39], v[100:103], v[252:255]
    v_exp_f32 v218, v218
    v_mfma_f32_16x16x32_bf16 v[244:247], v[32:35], v[88:91], v[244:247]
    v_exp_f32 v219, v219
    v_mfma_f32_16x16x32_bf16 v[244:247], v[36:39], v[96:99], v[244:247]
    ds_read_b128 v[32:35], v1 offset:34048
    s_waitcnt lgkmcnt(3)
    v_mfma_f32_16x16x32_bf16 v[224:227], v[16:19], v[40:43], 0
    ds_read_b128 v[36:39], v1 offset:34112
    v_cvt_pk_bf16_f32 v125, v218, v219
    v_mfma_f32_16x16x32_bf16 v[224:227], v[20:23], v[48:51], v[224:227]
    v_exp_f32 v220, v220
    v_mfma_f32_16x16x32_bf16 v[232:235], v[16:19], v[44:47], 0
    v_exp_f32 v221, v221
    v_mfma_f32_16x16x32_bf16 v[232:235], v[20:23], v[52:55], v[232:235]
    ds_read_b128 v[16:19], v1 offset:34176
    s_waitcnt lgkmcnt(3)
    v_mfma_f32_16x16x32_bf16 v[232:235], v[24:27], v[60:63], v[232:235]
    ds_read_b128 v[20:23], v1 offset:34240
    v_cvt_pk_bf16_f32 v126, v220, v221
    v_mfma_f32_16x16x32_bf16 v[232:235], v[28:31], v[68:71], v[232:235]
    v_exp_f32 v222, v222
    v_mfma_f32_16x16x32_bf16 v[224:227], v[24:27], v[56:59], v[224:227]
    v_exp_f32 v223, v223
    v_mfma_f32_16x16x32_bf16 v[224:227], v[28:31], v[64:67], v[224:227]
    ds_read_b128 v[24:27], v1 offset:42240
    s_waitcnt lgkmcnt(3)
    v_mfma_f32_16x16x32_bf16 v[224:227], v[32:35], v[72:75], v[224:227]
    ds_read_b128 v[28:31], v1 offset:42304
    v_cvt_pk_bf16_f32 v127, v222, v223
    v_mfma_f32_16x16x32_bf16 v[224:227], v[36:39], v[80:83], v[224:227]
    v_exp_f32 v192, v192
    v_mfma_f32_16x16x32_bf16 v[232:235], v[32:35], v[76:79], v[232:235]
    v_exp_f32 v193, v193
    v_mfma_f32_16x16x32_bf16 v[232:235], v[36:39], v[84:87], v[232:235]
    ds_read_b128 v[32:35], v1 offset:42368
    s_waitcnt lgkmcnt(3)
    v_mfma_f32_16x16x32_bf16 v[232:235], v[16:19], v[92:95], v[232:235]
    ds_read_b128 v[36:39], v1 offset:42432
    v_cvt_pk_bf16_f32 v128, v192, v193
    v_mfma_f32_16x16x32_bf16 v[232:235], v[20:23], v[100:103], v[232:235]
    v_exp_f32 v194, v194
    v_mfma_f32_16x16x32_bf16 v[224:227], v[16:19], v[88:91], v[224:227]
    v_exp_f32 v195, v195
    v_mfma_f32_16x16x32_bf16 v[224:227], v[20:23], v[96:99], v[224:227]
    ds_read_b128 v[16:19], v1 offset:42496
    s_waitcnt lgkmcnt(3)
    v_mfma_f32_16x16x32_bf16 v[228:231], v[24:27], v[40:43], 0
    ds_read_b128 v[20:23], v1 offset:42560
    v_cvt_pk_bf16_f32 v129, v194, v195
    v_mfma_f32_16x16x32_bf16 v[228:231], v[28:31], v[48:51], v[228:231]
    v_exp_f32 v196, v196
    v_mfma_f32_16x16x32_bf16 v[236:239], v[24:27], v[44:47], 0
    v_exp_f32 v197, v197
    v_mfma_f32_16x16x32_bf16 v[236:239], v[28:31], v[52:55], v[236:239]
    ds_read_b128 v[24:27], v1 offset:42624
    s_waitcnt lgkmcnt(3)
    v_mfma_f32_16x16x32_bf16 v[236:239], v[32:35], v[60:63], v[236:239]
    ds_read_b128 v[28:31], v1 offset:42688
    v_cvt_pk_bf16_f32 v130, v196, v197
    v_mfma_f32_16x16x32_bf16 v[236:239], v[36:39], v[68:71], v[236:239]
    v_exp_f32 v198, v198
    v_mfma_f32_16x16x32_bf16 v[228:231], v[32:35], v[56:59], v[228:231]
    v_exp_f32 v199, v199
    v_mfma_f32_16x16x32_bf16 v[228:231], v[36:39], v[64:67], v[228:231]
    s_barrier
    v_subrev_u32 v1, 101376, v1
    ds_read_b128 v[32:35], v1 offset:0
    s_waitcnt lgkmcnt(3)
    v_mfma_f32_16x16x32_bf16 v[228:231], v[16:19], v[72:75], v[228:231]
    ds_read_b128 v[36:39], v1 offset:64
    v_cvt_pk_bf16_f32 v131, v198, v199
    v_mfma_f32_16x16x32_bf16 v[228:231], v[20:23], v[80:83], v[228:231]
    v_exp_f32 v200, v200
    v_mfma_f32_16x16x32_bf16 v[236:239], v[16:19], v[76:79], v[236:239]
    v_exp_f32 v201, v201
    v_mfma_f32_16x16x32_bf16 v[236:239], v[20:23], v[84:87], v[236:239]
    ds_read_b128 v[16:19], v1 offset:128
    s_waitcnt lgkmcnt(3)
    v_mfma_f32_16x16x32_bf16 v[236:239], v[24:27], v[92:95], v[236:239]
    ds_read_b128 v[20:23], v1 offset:192
    v_cvt_pk_bf16_f32 v132, v200, v201
    v_mfma_f32_16x16x32_bf16 v[236:239], v[28:31], v[100:103], v[236:239]
    v_exp_f32 v202, v202
    v_mfma_f32_16x16x32_bf16 v[228:231], v[24:27], v[88:91], v[228:231]
    v_exp_f32 v203, v203
    v_mfma_f32_16x16x32_bf16 v[228:231], v[28:31], v[96:99], v[228:231]
    ds_read_b128 v[24:27], v1 offset:256
    s_waitcnt lgkmcnt(3)
    v_mfma_f32_16x16x32_bf16 v[208:211], v[32:35], v[40:43], 0
    ds_read_b128 v[28:31], v1 offset:320
    v_cvt_pk_bf16_f32 v133, v202, v203
    v_mfma_f32_16x16x32_bf16 v[208:211], v[36:39], v[48:51], v[208:211]
    v_exp_f32 v204, v204
    v_mfma_f32_16x16x32_bf16 v[216:219], v[32:35], v[44:47], 0
    v_exp_f32 v205, v205
    v_mfma_f32_16x16x32_bf16 v[216:219], v[36:39], v[52:55], v[216:219]
    ds_read_b128 v[32:35], v1 offset:384
    s_waitcnt lgkmcnt(3)
    v_mfma_f32_16x16x32_bf16 v[216:219], v[16:19], v[60:63], v[216:219]
    ds_read_b128 v[36:39], v1 offset:448
    v_cvt_pk_bf16_f32 v134, v204, v205
    v_mfma_f32_16x16x32_bf16 v[216:219], v[20:23], v[68:71], v[216:219]
    v_exp_f32 v206, v206
    v_mfma_f32_16x16x32_bf16 v[208:211], v[16:19], v[56:59], v[208:211]
    v_exp_f32 v207, v207
    v_mfma_f32_16x16x32_bf16 v[208:211], v[20:23], v[64:67], v[208:211]
    ds_read_b128 v[16:19], v1 offset:8448
    s_waitcnt lgkmcnt(3)
    v_mfma_f32_16x16x32_bf16 v[208:211], v[24:27], v[72:75], v[208:211]
    ds_read_b128 v[20:23], v1 offset:8512
    v_cvt_pk_bf16_f32 v135, v206, v207
    v_mfma_f32_16x16x32_bf16 v[208:211], v[28:31], v[80:83], v[208:211]
    v_exp_f32 v176, v176
    v_mfma_f32_16x16x32_bf16 v[216:219], v[24:27], v[76:79], v[216:219]
    v_exp_f32 v177, v177
    v_mfma_f32_16x16x32_bf16 v[216:219], v[28:31], v[84:87], v[216:219]
    ds_read_b128 v[24:27], v1 offset:8576
    s_waitcnt lgkmcnt(3)
    v_mfma_f32_16x16x32_bf16 v[216:219], v[32:35], v[92:95], v[216:219]
    ds_read_b128 v[28:31], v1 offset:8640
    v_cvt_pk_bf16_f32 v136, v176, v177
    v_mfma_f32_16x16x32_bf16 v[216:219], v[36:39], v[100:103], v[216:219]
    v_exp_f32 v178, v178
    v_mfma_f32_16x16x32_bf16 v[208:211], v[32:35], v[88:91], v[208:211]
    v_exp_f32 v179, v179
    v_mfma_f32_16x16x32_bf16 v[208:211], v[36:39], v[96:99], v[208:211]
    ds_read_b128 v[32:35], v1 offset:8704
    s_waitcnt lgkmcnt(3)
    v_mfma_f32_16x16x32_bf16 v[212:215], v[16:19], v[40:43], 0
    ds_read_b128 v[36:39], v1 offset:8768
    v_cvt_pk_bf16_f32 v137, v178, v179
    v_mfma_f32_16x16x32_bf16 v[212:215], v[20:23], v[48:51], v[212:215]
    v_exp_f32 v180, v180
    v_mfma_f32_16x16x32_bf16 v[220:223], v[16:19], v[44:47], 0
    v_exp_f32 v181, v181
    v_mfma_f32_16x16x32_bf16 v[220:223], v[20:23], v[52:55], v[220:223]
    ds_read_b128 v[16:19], v1 offset:8832
    s_waitcnt lgkmcnt(3)
    v_mfma_f32_16x16x32_bf16 v[220:223], v[24:27], v[60:63], v[220:223]
    ds_read_b128 v[20:23], v1 offset:8896
    v_cvt_pk_bf16_f32 v138, v180, v181
    v_mfma_f32_16x16x32_bf16 v[220:223], v[28:31], v[68:71], v[220:223]
    v_exp_f32 v182, v182
    v_mfma_f32_16x16x32_bf16 v[212:215], v[24:27], v[56:59], v[212:215]
    v_exp_f32 v183, v183
    v_mfma_f32_16x16x32_bf16 v[212:215], v[28:31], v[64:67], v[212:215]
    s_barrier
    ds_read_b128 v[24:27], v1 offset:16896
    s_waitcnt lgkmcnt(3)
    v_mfma_f32_16x16x32_bf16 v[212:215], v[32:35], v[72:75], v[212:215]
    ds_read_b128 v[28:31], v1 offset:16960
    v_cvt_pk_bf16_f32 v139, v182, v183
    v_mfma_f32_16x16x32_bf16 v[212:215], v[36:39], v[80:83], v[212:215]
    v_exp_f32 v184, v184
    v_mfma_f32_16x16x32_bf16 v[220:223], v[32:35], v[76:79], v[220:223]
    v_exp_f32 v185, v185
    v_mfma_f32_16x16x32_bf16 v[220:223], v[36:39], v[84:87], v[220:223]
    ds_read_b128 v[32:35], v1 offset:17024
    s_waitcnt lgkmcnt(3)
    v_mfma_f32_16x16x32_bf16 v[220:223], v[16:19], v[92:95], v[220:223]
    ds_read_b128 v[36:39], v1 offset:17088
    v_cvt_pk_bf16_f32 v140, v184, v185
    v_mfma_f32_16x16x32_bf16 v[220:223], v[20:23], v[100:103], v[220:223]
    v_exp_f32 v186, v186
    v_mfma_f32_16x16x32_bf16 v[212:215], v[16:19], v[88:91], v[212:215]
    v_exp_f32 v187, v187
    v_mfma_f32_16x16x32_bf16 v[212:215], v[20:23], v[96:99], v[212:215]
    ds_read_b128 v[16:19], v1 offset:17152
    s_waitcnt lgkmcnt(3)
    v_mfma_f32_16x16x32_bf16 v[192:195], v[24:27], v[40:43], 0
    ds_read_b128 v[20:23], v1 offset:17216
    v_cvt_pk_bf16_f32 v141, v186, v187
    v_mfma_f32_16x16x32_bf16 v[192:195], v[28:31], v[48:51], v[192:195]
    v_exp_f32 v188, v188
    v_mfma_f32_16x16x32_bf16 v[200:203], v[24:27], v[44:47], 0
    v_exp_f32 v189, v189
    v_mfma_f32_16x16x32_bf16 v[200:203], v[28:31], v[52:55], v[200:203]
    ds_read_b128 v[24:27], v1 offset:17280
    s_waitcnt lgkmcnt(3)
    v_mfma_f32_16x16x32_bf16 v[200:203], v[32:35], v[60:63], v[200:203]
    ds_read_b128 v[28:31], v1 offset:17344
    v_cvt_pk_bf16_f32 v142, v188, v189
    v_mfma_f32_16x16x32_bf16 v[200:203], v[36:39], v[68:71], v[200:203]
    v_exp_f32 v190, v190
    v_mfma_f32_16x16x32_bf16 v[192:195], v[32:35], v[56:59], v[192:195]
    v_exp_f32 v191, v191
    v_mfma_f32_16x16x32_bf16 v[192:195], v[36:39], v[64:67], v[192:195]
    ds_read_b128 v[32:35], v1 offset:25344
    s_waitcnt lgkmcnt(3)
    v_mfma_f32_16x16x32_bf16 v[192:195], v[16:19], v[72:75], v[192:195]
    ds_read_b128 v[36:39], v1 offset:25408
    v_cvt_pk_bf16_f32 v143, v190, v191
    v_mfma_f32_16x16x32_bf16 v[192:195], v[20:23], v[80:83], v[192:195]
    v_exp_f32 v240, v240
    v_mfma_f32_16x16x32_bf16 v[200:203], v[16:19], v[76:79], v[200:203]
    v_exp_f32 v241, v241
    v_mfma_f32_16x16x32_bf16 v[200:203], v[20:23], v[84:87], v[200:203]
    ds_read_b128 v[16:19], v1 offset:25472
    s_waitcnt lgkmcnt(3)
    v_mfma_f32_16x16x32_bf16 v[200:203], v[24:27], v[92:95], v[200:203]
    ds_read_b128 v[20:23], v1 offset:25536
    v_cvt_pk_bf16_f32 v144, v240, v241
    v_mfma_f32_16x16x32_bf16 v[200:203], v[28:31], v[100:103], v[200:203]
    v_exp_f32 v242, v242
    v_mfma_f32_16x16x32_bf16 v[192:195], v[24:27], v[88:91], v[192:195]
    v_exp_f32 v243, v243
    v_mfma_f32_16x16x32_bf16 v[192:195], v[28:31], v[96:99], v[192:195]
    ds_read_b128 v[24:27], v1 offset:25600
    s_waitcnt lgkmcnt(3)
    v_mfma_f32_16x16x32_bf16 v[196:199], v[32:35], v[40:43], 0
    ds_read_b128 v[28:31], v1 offset:25664
    v_cvt_pk_bf16_f32 v145, v242, v243
    v_mfma_f32_16x16x32_bf16 v[196:199], v[36:39], v[48:51], v[196:199]
    v_exp_f32 v244, v244
    v_mfma_f32_16x16x32_bf16 v[204:207], v[32:35], v[44:47], 0
    v_exp_f32 v245, v245
    v_mfma_f32_16x16x32_bf16 v[204:207], v[36:39], v[52:55], v[204:207]
    ds_read_b128 v[32:35], v1 offset:25728
    s_waitcnt lgkmcnt(3)
    v_mfma_f32_16x16x32_bf16 v[204:207], v[16:19], v[60:63], v[204:207]
    ds_read_b128 v[36:39], v1 offset:25792
    v_cvt_pk_bf16_f32 v146, v244, v245
    v_mfma_f32_16x16x32_bf16 v[204:207], v[20:23], v[68:71], v[204:207]
    v_exp_f32 v246, v246
    v_mfma_f32_16x16x32_bf16 v[196:199], v[16:19], v[56:59], v[196:199]
    v_exp_f32 v247, v247
    v_mfma_f32_16x16x32_bf16 v[196:199], v[20:23], v[64:67], v[196:199]
    s_barrier
    ds_read_b128 v[16:19], v1 offset:33792
    s_waitcnt lgkmcnt(3)
    v_mfma_f32_16x16x32_bf16 v[196:199], v[24:27], v[72:75], v[196:199]
    ds_read_b128 v[20:23], v1 offset:33856
    v_cvt_pk_bf16_f32 v147, v246, v247
    v_mfma_f32_16x16x32_bf16 v[196:199], v[28:31], v[80:83], v[196:199]
    v_exp_f32 v248, v248
    v_mfma_f32_16x16x32_bf16 v[204:207], v[24:27], v[76:79], v[204:207]
    v_exp_f32 v249, v249
    v_mfma_f32_16x16x32_bf16 v[204:207], v[28:31], v[84:87], v[204:207]
    ds_read_b128 v[24:27], v1 offset:33920
    s_waitcnt lgkmcnt(3)
    v_mfma_f32_16x16x32_bf16 v[204:207], v[32:35], v[92:95], v[204:207]
    ds_read_b128 v[28:31], v1 offset:33984
    v_cvt_pk_bf16_f32 v148, v248, v249
    v_mfma_f32_16x16x32_bf16 v[204:207], v[36:39], v[100:103], v[204:207]
    v_exp_f32 v250, v250
    v_mfma_f32_16x16x32_bf16 v[196:199], v[32:35], v[88:91], v[196:199]
    v_exp_f32 v251, v251
    v_mfma_f32_16x16x32_bf16 v[196:199], v[36:39], v[96:99], v[196:199]
    ds_read_b128 v[32:35], v1 offset:34048
    s_waitcnt lgkmcnt(3)
    v_mfma_f32_16x16x32_bf16 v[176:179], v[16:19], v[40:43], 0
    ds_read_b128 v[36:39], v1 offset:34112
    v_cvt_pk_bf16_f32 v149, v250, v251
    v_mfma_f32_16x16x32_bf16 v[176:179], v[20:23], v[48:51], v[176:179]
    v_exp_f32 v252, v252
    v_mfma_f32_16x16x32_bf16 v[184:187], v[16:19], v[44:47], 0
    v_exp_f32 v253, v253
    v_mfma_f32_16x16x32_bf16 v[184:187], v[20:23], v[52:55], v[184:187]
    ds_read_b128 v[16:19], v1 offset:34176
    s_waitcnt lgkmcnt(3)
    v_mfma_f32_16x16x32_bf16 v[184:187], v[24:27], v[60:63], v[184:187]
    ds_read_b128 v[20:23], v1 offset:34240
    v_cvt_pk_bf16_f32 v150, v252, v253
    v_mfma_f32_16x16x32_bf16 v[184:187], v[28:31], v[68:71], v[184:187]
    v_exp_f32 v254, v254
    v_mfma_f32_16x16x32_bf16 v[176:179], v[24:27], v[56:59], v[176:179]
    v_exp_f32 v255, v255
    v_mfma_f32_16x16x32_bf16 v[176:179], v[28:31], v[64:67], v[176:179]
    ds_read_b128 v[24:27], v1 offset:42240
    s_waitcnt lgkmcnt(3)
    v_mfma_f32_16x16x32_bf16 v[176:179], v[32:35], v[72:75], v[176:179]
    ds_read_b128 v[28:31], v1 offset:42304
    v_cvt_pk_bf16_f32 v151, v254, v255
    v_mfma_f32_16x16x32_bf16 v[176:179], v[36:39], v[80:83], v[176:179]
    v_exp_f32 v224, v224
    v_mfma_f32_16x16x32_bf16 v[184:187], v[32:35], v[76:79], v[184:187]
    v_exp_f32 v225, v225
    v_mfma_f32_16x16x32_bf16 v[184:187], v[36:39], v[84:87], v[184:187]
    ds_read_b128 v[32:35], v1 offset:42368
    s_waitcnt lgkmcnt(3)
    v_mfma_f32_16x16x32_bf16 v[184:187], v[16:19], v[92:95], v[184:187]
    ds_read_b128 v[36:39], v1 offset:42432
    v_cvt_pk_bf16_f32 v152, v224, v225
    v_mfma_f32_16x16x32_bf16 v[184:187], v[20:23], v[100:103], v[184:187]
    v_exp_f32 v226, v226
    v_mfma_f32_16x16x32_bf16 v[176:179], v[16:19], v[88:91], v[176:179]
    v_exp_f32 v227, v227
    v_mfma_f32_16x16x32_bf16 v[176:179], v[20:23], v[96:99], v[176:179]
    ds_read_b128 v[16:19], v1 offset:42496
    s_waitcnt lgkmcnt(3)
    v_mfma_f32_16x16x32_bf16 v[180:183], v[24:27], v[40:43], 0
    ds_read_b128 v[20:23], v1 offset:42560
    v_cvt_pk_bf16_f32 v153, v226, v227
    v_mfma_f32_16x16x32_bf16 v[180:183], v[28:31], v[48:51], v[180:183]
    v_exp_f32 v228, v228
    v_mfma_f32_16x16x32_bf16 v[188:191], v[24:27], v[44:47], 0
    v_exp_f32 v229, v229
    v_mfma_f32_16x16x32_bf16 v[188:191], v[28:31], v[52:55], v[188:191]
    ds_read_b128 v[24:27], v1 offset:42624
    s_waitcnt lgkmcnt(3)
    v_mfma_f32_16x16x32_bf16 v[188:191], v[32:35], v[60:63], v[188:191]
    ds_read_b128 v[28:31], v1 offset:42688
    v_cvt_pk_bf16_f32 v154, v228, v229
    v_mfma_f32_16x16x32_bf16 v[188:191], v[36:39], v[68:71], v[188:191]
    v_exp_f32 v230, v230
    v_mfma_f32_16x16x32_bf16 v[180:183], v[32:35], v[56:59], v[180:183]
    v_exp_f32 v231, v231
    v_mfma_f32_16x16x32_bf16 v[180:183], v[36:39], v[64:67], v[180:183]
    s_barrier
    ds_read_b128 v[32:35], v1 offset:50688
    s_waitcnt lgkmcnt(3)
    v_mfma_f32_16x16x32_bf16 v[180:183], v[16:19], v[72:75], v[180:183]
    ds_read_b128 v[36:39], v1 offset:50752
    v_cvt_pk_bf16_f32 v155, v230, v231
    v_mfma_f32_16x16x32_bf16 v[180:183], v[20:23], v[80:83], v[180:183]
    v_exp_f32 v232, v232
    v_mfma_f32_16x16x32_bf16 v[188:191], v[16:19], v[76:79], v[188:191]
    v_exp_f32 v233, v233
    v_mfma_f32_16x16x32_bf16 v[188:191], v[20:23], v[84:87], v[188:191]
    ds_read_b128 v[16:19], v1 offset:50816
    s_waitcnt lgkmcnt(3)
    v_mfma_f32_16x16x32_bf16 v[188:191], v[24:27], v[92:95], v[188:191]
    ds_read_b128 v[20:23], v1 offset:50880
    v_cvt_pk_bf16_f32 v156, v232, v233
    v_mfma_f32_16x16x32_bf16 v[188:191], v[28:31], v[100:103], v[188:191]
    v_exp_f32 v234, v234
    v_mfma_f32_16x16x32_bf16 v[180:183], v[24:27], v[88:91], v[180:183]
    v_exp_f32 v235, v235
    v_mfma_f32_16x16x32_bf16 v[180:183], v[28:31], v[96:99], v[180:183]
    ds_read_b128 v[24:27], v1 offset:50944
    s_waitcnt lgkmcnt(3)
    v_mfma_f32_16x16x32_bf16 v[240:243], v[32:35], v[40:43], 0
    ds_read_b128 v[28:31], v1 offset:51008
    v_cvt_pk_bf16_f32 v157, v234, v235
    v_mfma_f32_16x16x32_bf16 v[240:243], v[36:39], v[48:51], v[240:243]
    v_exp_f32 v236, v236
    v_mfma_f32_16x16x32_bf16 v[248:251], v[32:35], v[44:47], 0
    v_exp_f32 v237, v237
    v_mfma_f32_16x16x32_bf16 v[248:251], v[36:39], v[52:55], v[248:251]
    ds_read_b128 v[32:35], v1 offset:51072
    s_waitcnt lgkmcnt(3)
    v_mfma_f32_16x16x32_bf16 v[248:251], v[16:19], v[60:63], v[248:251]
    ds_read_b128 v[36:39], v1 offset:51136
    v_cvt_pk_bf16_f32 v158, v236, v237
    v_mfma_f32_16x16x32_bf16 v[248:251], v[20:23], v[68:71], v[248:251]
    v_exp_f32 v238, v238
    v_mfma_f32_16x16x32_bf16 v[240:243], v[16:19], v[56:59], v[240:243]
    v_exp_f32 v239, v239
    v_mfma_f32_16x16x32_bf16 v[240:243], v[20:23], v[64:67], v[240:243]
    ds_read_b128 v[16:19], v1 offset:59136
    s_waitcnt lgkmcnt(3)
    v_mfma_f32_16x16x32_bf16 v[240:243], v[24:27], v[72:75], v[240:243]
    ds_read_b128 v[20:23], v1 offset:59200
    v_cvt_pk_bf16_f32 v159, v238, v239
    v_mfma_f32_16x16x32_bf16 v[240:243], v[28:31], v[80:83], v[240:243]
    v_exp_f32 v208, v208
    v_mfma_f32_16x16x32_bf16 v[248:251], v[24:27], v[76:79], v[248:251]
    v_exp_f32 v209, v209
    v_mfma_f32_16x16x32_bf16 v[248:251], v[28:31], v[84:87], v[248:251]
    ds_read_b128 v[24:27], v1 offset:59264
    s_waitcnt lgkmcnt(3)
    v_mfma_f32_16x16x32_bf16 v[248:251], v[32:35], v[92:95], v[248:251]
    ds_read_b128 v[28:31], v1 offset:59328
    v_cvt_pk_bf16_f32 v160, v208, v209
    v_mfma_f32_16x16x32_bf16 v[248:251], v[36:39], v[100:103], v[248:251]
    v_exp_f32 v210, v210
    v_mfma_f32_16x16x32_bf16 v[240:243], v[32:35], v[88:91], v[240:243]
    v_exp_f32 v211, v211
    v_mfma_f32_16x16x32_bf16 v[240:243], v[36:39], v[96:99], v[240:243]
    ds_read_b128 v[32:35], v1 offset:59392
    s_waitcnt lgkmcnt(3)
    v_mfma_f32_16x16x32_bf16 v[244:247], v[16:19], v[40:43], 0
    ds_read_b128 v[36:39], v1 offset:59456
    v_cvt_pk_bf16_f32 v161, v210, v211
    v_mfma_f32_16x16x32_bf16 v[244:247], v[20:23], v[48:51], v[244:247]
    v_exp_f32 v212, v212
    v_mfma_f32_16x16x32_bf16 v[252:255], v[16:19], v[44:47], 0
    v_exp_f32 v213, v213
    v_mfma_f32_16x16x32_bf16 v[252:255], v[20:23], v[52:55], v[252:255]
    ds_read_b128 v[16:19], v1 offset:59520
    s_waitcnt lgkmcnt(3)
    v_mfma_f32_16x16x32_bf16 v[252:255], v[24:27], v[60:63], v[252:255]
    ds_read_b128 v[20:23], v1 offset:59584
    v_cvt_pk_bf16_f32 v162, v212, v213
    v_mfma_f32_16x16x32_bf16 v[252:255], v[28:31], v[68:71], v[252:255]
    v_exp_f32 v214, v214
    v_mfma_f32_16x16x32_bf16 v[244:247], v[24:27], v[56:59], v[244:247]
    v_exp_f32 v215, v215
    v_mfma_f32_16x16x32_bf16 v[244:247], v[28:31], v[64:67], v[244:247]
    s_barrier
    v_add_u32 v1, 67584, v1
    ds_read_b128 v[24:27], v1 offset:0
    s_waitcnt lgkmcnt(3)
    v_mfma_f32_16x16x32_bf16 v[244:247], v[32:35], v[72:75], v[244:247]
    ds_read_b128 v[28:31], v1 offset:64
    v_cvt_pk_bf16_f32 v163, v214, v215
    v_mfma_f32_16x16x32_bf16 v[244:247], v[36:39], v[80:83], v[244:247]
    v_exp_f32 v216, v216
    v_mfma_f32_16x16x32_bf16 v[252:255], v[32:35], v[76:79], v[252:255]
    v_exp_f32 v217, v217
    v_mfma_f32_16x16x32_bf16 v[252:255], v[36:39], v[84:87], v[252:255]
    ds_read_b128 v[32:35], v1 offset:128
    s_waitcnt lgkmcnt(3)
    v_mfma_f32_16x16x32_bf16 v[252:255], v[16:19], v[92:95], v[252:255]
    ds_read_b128 v[36:39], v1 offset:192
    v_cvt_pk_bf16_f32 v164, v216, v217
    v_mfma_f32_16x16x32_bf16 v[252:255], v[20:23], v[100:103], v[252:255]
    v_exp_f32 v218, v218
    v_mfma_f32_16x16x32_bf16 v[244:247], v[16:19], v[88:91], v[244:247]
    v_exp_f32 v219, v219
    v_mfma_f32_16x16x32_bf16 v[244:247], v[20:23], v[96:99], v[244:247]
    ds_read_b128 v[16:19], v1 offset:256
    s_waitcnt lgkmcnt(3)
    v_mfma_f32_16x16x32_bf16 v[224:227], v[24:27], v[40:43], 0
    ds_read_b128 v[20:23], v1 offset:320
    v_cvt_pk_bf16_f32 v165, v218, v219
    v_mfma_f32_16x16x32_bf16 v[224:227], v[28:31], v[48:51], v[224:227]
    v_exp_f32 v220, v220
    v_mfma_f32_16x16x32_bf16 v[232:235], v[24:27], v[44:47], 0
    v_exp_f32 v221, v221
    v_mfma_f32_16x16x32_bf16 v[232:235], v[28:31], v[52:55], v[232:235]
    ds_read_b128 v[24:27], v1 offset:384
    s_waitcnt lgkmcnt(3)
    v_mfma_f32_16x16x32_bf16 v[232:235], v[32:35], v[60:63], v[232:235]
    ds_read_b128 v[28:31], v1 offset:448
    v_cvt_pk_bf16_f32 v166, v220, v221
    v_mfma_f32_16x16x32_bf16 v[232:235], v[36:39], v[68:71], v[232:235]
    v_exp_f32 v222, v222
    v_mfma_f32_16x16x32_bf16 v[224:227], v[32:35], v[56:59], v[224:227]
    v_exp_f32 v223, v223
    v_mfma_f32_16x16x32_bf16 v[224:227], v[36:39], v[64:67], v[224:227]
    ds_read_b128 v[32:35], v1 offset:8448
    s_waitcnt lgkmcnt(3)
    v_mfma_f32_16x16x32_bf16 v[224:227], v[16:19], v[72:75], v[224:227]
L_pad1:
    s_cbranch_execz L_back1
    ds_read_b128 v[36:39], v1 offset:8512
    v_cvt_pk_bf16_f32 v167, v222, v223
    v_mfma_f32_16x16x32_bf16 v[224:227], v[20:23], v[80:83], v[224:227]
    v_exp_f32 v192, v192
    v_mfma_f32_16x16x32_bf16 v[232:235], v[16:19], v[76:79], v[232:235]
    v_exp_f32 v193, v193
    v_mfma_f32_16x16x32_bf16 v[232:235], v[20:23], v[84:87], v[232:235]
    ds_read_b128 v[16:19], v1 offset:8576
    s_waitcnt lgkmcnt(3)
    v_mfma_f32_16x16x32_bf16 v[232:235], v[24:27], v[92:95], v[232:235]
    ds_read_b128 v[20:23], v1 offset:8640
    v_cvt_pk_bf16_f32 v168, v192, v193
    v_mfma_f32_16x16x32_bf16 v[232:235], v[28:31], v[100:103], v[232:235]
    v_exp_f32 v194, v194
    v_mfma_f32_16x16x32_bf16 v[224:227], v[24:27], v[88:91], v[224:227]
    v_exp_f32 v195, v195
    v_mfma_f32_16x16x32_bf16 v[224:227], v[28:31], v[96:99], v[224:227]
    ds_read_b128 v[24:27], v1 offset:8704
    s_waitcnt lgkmcnt(3)
    v_mfma_f32_16x16x32_bf16 v[228:231], v[32:35], v[40:43], 0
    ds_read_b128 v[28:31], v1 offset:8768
    v_cvt_pk_bf16_f32 v169, v194, v195
    v_mfma_f32_16x16x32_bf16 v[228:231], v[36:39], v[48:51], v[228:231]
    v_exp_f32 v196, v196
    v_mfma_f32_16x16x32_bf16 v[236:239], v[32:35], v[44:47], 0
    v_exp_f32 v197, v197
    v_mfma_f32_16x16x32_bf16 v[236:239], v[36:39], v[52:55], v[236:239]
    ds_read_b128 v[32:35], v1 offset:8832
    s_waitcnt lgkmcnt(3)
    v_mfma_f32_16x16x32_bf16 v[236:239], v[16:19], v[60:63], v[236:239]
    ds_read_b128 v[36:39], v1 offset:8896
    v_cvt_pk_bf16_f32 v170, v196, v197
    v_mfma_f32_16x16x32_bf16 v[236:239], v[20:23], v[68:71], v[236:239]
    v_exp_f32 v198, v198
    v_mfma_f32_16x16x32_bf16 v[228:231], v[16:19], v[56:59], v[228:231]
    v_exp_f32 v199, v199
    v_mfma_f32_16x16x32_bf16 v[228:231], v[20:23], v[64:67], v[228:231]
    ds_read_b128 v[16:19], v1 offset:16896
    s_waitcnt lgkmcnt(3)
    v_mfma_f32_16x16x32_bf16 v[228:231], v[24:27], v[72:75], v[228:231]
    ds_read_b128 v[20:23], v1 offset:16960
    v_cvt_pk_bf16_f32 v171, v198, v199
    v_mfma_f32_16x16x32_bf16 v[228:231], v[28:31], v[80:83], v[228:231]
    v_exp_f32 v200, v200
    v_mfma_f32_16x16x32_bf16 v[236:239], v[24:27], v[76:79], v[236:239]
    v_exp_f32 v201, v201
    v_mfma_f32_16x16x32_bf16 v[236:239], v[28:31], v[84:87], v[236:239]
    ds_read_b128 v[24:27], v1 offset:17024
    s_waitcnt lgkmcnt(3)
    v_mfma_f32_16x16x32_bf16 v[236:239], v[32:35], v[92:95], v[236:239]
    ds_read_b128 v[28:31], v1 offset:17088
    v_cvt_pk_bf16_f32 v172, v200, v201
    v_mfma_f32_16x16x32_bf16 v[236:239], v[36:39], v[100:103], v[236:239]
    v_exp_f32 v202, v202
    v_mfma_f32_16x16x32_bf16 v[228:231], v[32:35], v[88:91], v[228:231]
    v_exp_f32 v203, v203
    v_mfma_f32_16x16x32_bf16 v[228:231], v[36:39], v[96:99], v[228:231]
    ds_read_b128 v[32:35], v1 offset:17152
    s_waitcnt lgkmcnt(3)
    v_mfma_f32_16x16x32_bf16 v[208:211], v[16:19], v[40:43], 0
    ds_read_b128 v[36:39], v1 offset:17216
    v_cvt_pk_bf16_f32 v173, v202, v203
    v_mfma_f32_16x16x32_bf16 v[208:211], v[20:23], v[48:51], v[208:211]
    v_exp_f32 v204, v204
    v_mfma_f32_16x16x32_bf16 v[216:219], v[16:19], v[44:47], 0
    v_exp_f32 v205, v205
    v_mfma_f32_16x16x32_bf16 v[216:219], v[20:23], v[52:55], v[216:219]
    ds_read_b128 v[16:19], v1 offset:17280
    s_waitcnt lgkmcnt(3)
    v_mfma_f32_16x16x32_bf16 v[216:219], v[24:27], v[60:63], v[216:219]
    ds_read_b128 v[20:23], v1 offset:17344
    v_cvt_pk_bf16_f32 v174, v204, v205
    v_mfma_f32_16x16x32_bf16 v[216:219], v[28:31], v[68:71], v[216:219]
    v_exp_f32 v206, v206
    v_mfma_f32_16x16x32_bf16 v[208:211], v[24:27], v[56:59], v[208:211]
    v_exp_f32 v207, v207
    v_mfma_f32_16x16x32_bf16 v[208:211], v[28:31], v[64:67], v[208:211]
    ds_read_b128 v[24:27], v1 offset:25344
    s_waitcnt lgkmcnt(3)
    v_mfma_f32_16x16x32_bf16 v[208:211], v[32:35], v[72:75], v[208:211]
    ds_read_b128 v[28:31], v1 offset:25408
    v_cvt_pk_bf16_f32 v175, v206, v207
    v_mfma_f32_16x16x32_bf16 v[208:211], v[36:39], v[80:83], v[208:211]
    v_exp_f32 v176, v176
    v_mfma_f32_16x16x32_bf16 v[216:219], v[32:35], v[76:79], v[216:219]
    v_exp_f32 v177, v177
    v_mfma_f32_16x16x32_bf16 v[216:219], v[36:39], v[84:87], v[216:219]
    ds_read_b128 v[32:35], v1 offset:25472
    s_waitcnt lgkmcnt(3)
    v_mfma_f32_16x16x32_bf16 v[216:219], v[16:19], v[92:95], v[216:219]
    ds_read_b128 v[36:39], v1 offset:25536
    v_cvt_pk_bf16_f32 v176, v176, v177
    v_mfma_f32_16x16x32_bf16 v[216:219], v[20:23], v[100:103], v[216:219]
    v_exp_f32 v178, v178
    v_mfma_f32_16x16x32_bf16 v[208:211], v[16:19], v[88:91], v[208:211]
    v_exp_f32 v179, v179
    v_mfma_f32_16x16x32_bf16 v[208:211], v[20:23], v[96:99], v[208:211]
    ds_read_b128 v[16:19], v1 offset:25600
    s_waitcnt lgkmcnt(3)
    v_mfma_f32_16x16x32_bf16 v[212:215], v[24:27], v[40:43], 0
    ds_read_b128 v[20:23], v1 offset:25664
    v_cvt_pk_bf16_f32 v177, v178, v179
    v_mfma_f32_16x16x32_bf16 v[212:215], v[28:31], v[48:51], v[212:215]
    v_exp_f32 v180, v180
    v_mfma_f32_16x16x32_bf16 v[220:223], v[24:27], v[44:47], 0
    v_exp_f32 v181, v181
    v_mfma_f32_16x16x32_bf16 v[220:223], v[28:31], v[52:55], v[220:223]
    ds_read_b128 v[24:27], v1 offset:25728
    s_waitcnt lgkmcnt(3)
    v_mfma_f32_16x16x32_bf16 v[220:223], v[32:35], v[60:63], v[220:223]
    ds_read_b128 v[28:31], v1 offset:25792
    v_cvt_pk_bf16_f32 v178, v180, v181
    v_mfma_f32_16x16x32_bf16 v[220:223], v[36:39], v[68:71], v[220:223]
    v_exp_f32 v182, v182
    v_mfma_f32_16x16x32_bf16 v[212:215], v[32:35], v[56:59], v[212:215]
    v_exp_f32 v183, v183
    v_mfma_f32_16x16x32_bf16 v[212:215], v[36:39], v[64:67], v[212:215]
    s_barrier
    ds_read_b128 v[32:35], v1 offset:33792
    s_waitcnt lgkmcnt(3)
    v_mfma_f32_16x16x32_bf16 v[212:215], v[16:19], v[72:75], v[212:215]
    ds_read_b128 v[36:39], v1 offset:33856
    v_cvt_pk_bf16_f32 v179, v182, v183
    v_mfma_f32_16x16x32_bf16 v[212:215], v[20:23], v[80:83], v[212:215]
    v_exp_f32 v184, v184
    v_mfma_f32_16x16x32_bf16 v[220:223], v[16:19], v[76:79], v[220:223]
    v_exp_f32 v185, v185
    v_mfma_f32_16x16x32_bf16 v[220:223], v[20:23], v[84:87], v[220:223]
    ds_read_b128 v[16:19], v1 offset:33920
    s_waitcnt lgkmcnt(3)
    v_mfma_f32_16x16x32_bf16 v[220:223], v[24:27], v[92:95], v[220:223]
    ds_read_b128 v[20:23], v1 offset:33984
    v_cvt_pk_bf16_f32 v180, v184, v185
    v_mfma_f32_16x16x32_bf16 v[220:223], v[28:31], v[100:103], v[220:223]
    v_exp_f32 v186, v186
    v_mfma_f32_16x16x32_bf16 v[212:215], v[24:27], v[88:91], v[212:215]
    v_exp_f32 v187, v187
    v_mfma_f32_16x16x32_bf16 v[212:215], v[28:31], v[96:99], v[212:215]
    ds_read_b128 v[24:27], v1 offset:34048
    s_waitcnt lgkmcnt(3)
    v_mfma_f32_16x16x32_bf16 v[192:195], v[32:35], v[40:43], 0
    ds_read_b128 v[28:31], v1 offset:34112
    v_cvt_pk_bf16_f32 v181, v186, v187
    v_mfma_f32_16x16x32_bf16 v[192:195], v[36:39], v[48:51], v[192:195]
    v_exp_f32 v188, v188
    v_mfma_f32_16x16x32_bf16 v[200:203], v[32:35], v[44:47], 0
    v_exp_f32 v189, v189
    v_mfma_f32_16x16x32_bf16 v[200:203], v[36:39], v[52:55], v[200:203]
    ds_read_b128 v[32:35], v1 offset:34176
    s_waitcnt lgkmcnt(3)
    v_mfma_f32_16x16x32_bf16 v[200:203], v[16:19], v[60:63], v[200:203]
    ds_read_b128 v[36:39], v1 offset:34240
    v_cvt_pk_bf16_f32 v182, v188, v189
    v_mfma_f32_16x16x32_bf16 v[200:203], v[20:23], v[68:71], v[200:203]
    v_exp_f32 v190, v190
    v_mfma_f32_16x16x32_bf16 v[192:195], v[16:19], v[56:59], v[192:195]
    v_exp_f32 v191, v191
    v_mfma_f32_16x16x32_bf16 v[192:195], v[20:23], v[64:67], v[192:195]
    ds_read_b128 v[16:19], v1 offset:42240
    s_waitcnt lgkmcnt(3)
    v_mfma_f32_16x16x32_bf16 v[192:195], v[24:27], v[72:75], v[192:195]
    ds_read_b128 v[20:23], v1 offset:42304
    v_cvt_pk_bf16_f32 v183, v190, v191
    v_mfma_f32_16x16x32_bf16 v[192:195], v[28:31], v[80:83], v[192:195]
    v_exp_f32 v240, v240
    v_mfma_f32_16x16x32_bf16 v[200:203], v[24:27], v[76:79], v[200:203]
    v_exp_f32 v241, v241
    v_mfma_f32_16x16x32_bf16 v[200:203], v[28:31], v[84:87], v[200:203]
    ds_read_b128 v[24:27], v1 offset:42368
    s_waitcnt lgkmcnt(3)
    v_mfma_f32_16x16x32_bf16 v[200:203], v[32:35], v[92:95], v[200:203]
    ds_read_b128 v[28:31], v1 offset:42432
    v_cvt_pk_bf16_f32 v240, v240, v241
    v_mfma_f32_16x16x32_bf16 v[200:203], v[36:39], v[100:103], v[200:203]
    v_exp_f32 v242, v242
    v_mfma_f32_16x16x32_bf16 v[192:195], v[32:35], v[88:91], v[192:195]
    v_exp_f32 v243, v243
    v_mfma_f32_16x16x32_bf16 v[192:195], v[36:39], v[96:99], v[192:195]
    ds_read_b128 v[32:35], v1 offset:42496
    s_waitcnt lgkmcnt(3)
    v_mfma_f32_16x16x32_bf16 v[196:199], v[16:19], v[40:43], 0
    ds_read_b128 v[36:39], v1 offset:42560
    v_cvt_pk_bf16_f32 v241, v242, v243
    v_mfma_f32_16x16x32_bf16 v[196:199], v[20:23], v[48:51], v[196:199]
    v_exp_f32 v244, v244
    v_mfma_f32_16x16x32_bf16 v[204:207], v[16:19], v[44:47], 0
    v_exp_f32 v245, v245
    v_mfma_f32_16x16x32_bf16 v[204:207], v[20:23], v[52:55], v[204:207]
    ds_read_b128 v[16:19], v1 offset:42624
    s_waitcnt lgkmcnt(3)
    v_mfma_f32_16x16x32_bf16 v[204:207], v[24:27], v[60:63], v[204:207]
    ds_read_b128 v[20:23], v1 offset:42688
    v_cvt_pk_bf16_f32 v242, v244, v245
    v_mfma_f32_16x16x32_bf16 v[204:207], v[28:31], v[68:71], v[204:207]
    v_exp_f32 v246, v246
    v_mfma_f32_16x16x32_bf16 v[196:199], v[24:27], v[56:59], v[196:199]
    v_exp_f32 v247, v247
    v_mfma_f32_16x16x32_bf16 v[196:199], v[28:31], v[64:67], v[196:199]
    ds_read_b128 v[24:27], v1 offset:50688
    s_waitcnt lgkmcnt(3)
    v_mfma_f32_16x16x32_bf16 v[196:199], v[32:35], v[72:75], v[196:199]
    ds_read_b128 v[28:31], v1 offset:50752
    v_cvt_pk_bf16_f32 v243, v246, v247
    v_mfma_f32_16x16x32_bf16 v[196:199], v[36:39], v[80:83], v[196:199]
    v_exp_f32 v248, v248
    v_mfma_f32_16x16x32_bf16 v[204:207], v[32:35], v[76:79], v[204:207]
    v_exp_f32 v249, v249
    v_mfma_f32_16x16x32_bf16 v[204:207], v[36:39], v[84:87], v[204:207]
    ds_read_b128 v[32:35], v1 offset:50816
    s_waitcnt lgkmcnt(3)
    v_mfma_f32_16x16x32_bf16 v[204:207], v[16:19], v[92:95], v[204:207]
    ds_read_b128 v[36:39], v1 offset:50880
    v_cvt_pk_bf16_f32 v244, v248, v249
    v_mfma_f32_16x16x32_bf16 v[204:207], v[20:23], v[100:103], v[204:207]
    v_exp_f32 v250, v250
    v_mfma_f32_16x16x32_bf16 v[196:199], v[16:19], v[88:91], v[196:199]
    v_exp_f32 v251, v251
    v_mfma_f32_16x16x32_bf16 v[196:199], v[20:23], v[96:99], v[196:199]
    ds_read_b128 v[16:19], v1 offset:50944
    v_exp_f32 v252, v252
    v_exp_f32 v253, v253
    v_cvt_pk_bf16_f32 v245, v250, v251
    v_exp_f32 v254, v254
    v_exp_f32 v255, v255
    v_cvt_pk_bf16_f32 v246, v252, v253
    v_cvt_pk_bf16_f32 v247, v254, v255
    v_exp_f32 v224, v224
    v_exp_f32 v225, v225
    v_exp_f32 v226, v226
    v_exp_f32 v227, v227
    v_cvt_pk_bf16_f32 v184, v224, v225
    v_exp_f32 v228, v228
    v_exp_f32 v229, v229
    v_cvt_pk_bf16_f32 v185, v226, v227
    v_exp_f32 v230, v230
    v_exp_f32 v231, v231
    v_cvt_pk_bf16_f32 v186, v228, v229
    v_exp_f32 v232, v232
    v_exp_f32 v233, v233
    v_cvt_pk_bf16_f32 v187, v230, v231
    v_exp_f32 v234, v234
    v_exp_f32 v235, v235
    v_cvt_pk_bf16_f32 v188, v232, v233
    v_exp_f32 v236, v236
    v_exp_f32 v237, v237
    v_cvt_pk_bf16_f32 v189, v234, v235
    v_exp_f32 v238, v238
    v_exp_f32 v239, v239
    v_cvt_pk_bf16_f32 v190, v236, v237
    v_cvt_pk_bf16_f32 v191, v238, v239
    s_waitcnt lgkmcnt(3)
    v_mfma_f32_16x16x32_bf16 v[224:227], v[24:27], v[40:43], 0
    ds_read_b128 v[20:23], v1 offset:51008
    v_mfma_f32_16x16x32_bf16 v[224:227], v[28:31], v[48:51], v[224:227]
    v_exp_f32 v208, v208
    v_mfma_f32_16x16x32_bf16 v[232:235], v[24:27], v[44:47], 0
    v_exp_f32 v209, v209
    v_mfma_f32_16x16x32_bf16 v[232:235], v[28:31], v[52:55], v[232:235]
    ds_read_b128 v[24:27], v1 offset:51072
    s_waitcnt lgkmcnt(3)
    v_mfma_f32_16x16x32_bf16 v[232:235], v[32:35], v[60:63], v[232:235]
    ds_read_b128 v[28:31], v1 offset:51136
    v_cvt_pk_bf16_f32 v248, v208, v209
    v_mfma_f32_16x16x32_bf16 v[232:235], v[36:39], v[68:71], v[232:235]
    v_exp_f32 v210, v210
    v_mfma_f32_16x16x32_bf16 v[224:227], v[32:35], v[56:59], v[224:227]
    v_exp_f32 v211, v211
    v_mfma_f32_16x16x32_bf16 v[224:227], v[36:39], v[64:67], v[224:227]
    ds_read_b128 v[32:35], v1 offset:59136
    s_waitcnt lgkmcnt(3)
    v_mfma_f32_16x16x32_bf16 v[224:227], v[16:19], v[72:75], v[224:227]
    ds_read_b128 v[36:39], v1 offset:59200
    v_cvt_pk_bf16_f32 v249, v210, v211
    v_mfma_f32_16x16x32_bf16 v[224:227], v[20:23], v[80:83], v[224:227]
    v_exp_f32 v212, v212
    v_mfma_f32_16x16x32_bf16 v[232:235], v[16:19], v[76:79], v[232:235]
    v_exp_f32 v213, v213
    v_mfma_f32_16x16x32_bf16 v[232:235], v[20:23], v[84:87], v[232:235]
    ds_read_b128 v[16:19], v1 offset:59264
    s_waitcnt lgkmcnt(3)
    v_mfma_f32_16x16x32_bf16 v[232:235], v[24:27], v[92:95], v[232:235]
    ds_read_b128 v[20:23], v1 offset:59328
    v_cvt_pk_bf16_f32 v250, v212, v213
    v_mfma_f32_16x16x32_bf16 v[232:235], v[28:31], v[100:103], v[232:235]
    v_exp_f32 v214, v214
    v_mfma_f32_16x16x32_bf16 v[224:227], v[24:27], v[88:91], v[224:227]
    v_exp_f32 v215, v215
    v_mfma_f32_16x16x32_bf16 v[224:227], v[28:31], v[96:99], v[224:227]
    ds_read_b128 v[24:27], v1 offset:59392
    s_waitcnt lgkmcnt(3)
    v_mfma_f32_16x16x32_bf16 v[228:231], v[32:35], v[40:43], 0
    ds_read_b128 v[28:31], v1 offset:59456
    v_cvt_pk_bf16_f32 v251, v214, v215
    v_mfma_f32_16x16x32_bf16 v[228:231], v[36:39], v[48:51], v[228:231]
    v_exp_f32 v216, v216
    v_mfma_f32_16x16x32_bf16 v[236:239], v[32:35], v[44:47], 0
    v_exp_f32 v217, v217
    v_mfma_f32_16x16x32_bf16 v[236:239], v[36:39], v[52:55], v[236:239]
    ds_read_b128 v[32:35], v1 offset:59520
    s_waitcnt lgkmcnt(3)
    v_mfma_f32_16x16x32_bf16 v[236:239], v[16:19], v[60:63], v[236:239]
    ds_read_b128 v[36:39], v1 offset:59584
    v_cvt_pk_bf16_f32 v252, v216, v217
    v_mfma_f32_16x16x32_bf16 v[236:239], v[20:23], v[68:71], v[236:239]
    v_exp_f32 v218, v218
    v_mfma_f32_16x16x32_bf16 v[228:231], v[16:19], v[56:59], v[228:231]
    v_exp_f32 v219, v219
    v_mfma_f32_16x16x32_bf16 v[228:231], v[20:23], v[64:67], v[228:231]
    s_barrier
    v_add_u32 v1, 67584, v1
    ds_read_b128 v[16:19], v1 offset:0
    s_waitcnt lgkmcnt(3)
    v_mfma_f32_16x16x32_bf16 v[228:231], v[24:27], v[72:75], v[228:231]
    ds_read_b128 v[20:23], v1 offset:64
    v_cvt_pk_bf16_f32 v253, v218, v219
    v_mfma_f32_16x16x32_bf16 v[228:231], v[28:31], v[80:83], v[228:231]
    v_exp_f32 v220, v220
    v_mfma_f32_16x16x32_bf16 v[236:239], v[24:27], v[76:79], v[236:239]
    v_exp_f32 v221, v221
    v_mfma_f32_16x16x32_bf16 v[236:239], v[28:31], v[84:87], v[236:239]
    ds_read_b128 v[24:27], v1 offset:128
    s_waitcnt lgkmcnt(3)
    v_mfma_f32_16x16x32_bf16 v[236:239], v[32:35], v[92:95], v[236:239]
    ds_read_b128 v[28:31], v1 offset:192
    v_cvt_pk_bf16_f32 v254, v220, v221
    v_mfma_f32_16x16x32_bf16 v[236:239], v[36:39], v[100:103], v[236:239]
    v_exp_f32 v222, v222
    v_mfma_f32_16x16x32_bf16 v[228:231], v[32:35], v[88:91], v[228:231]
    v_exp_f32 v223, v223
    v_mfma_f32_16x16x32_bf16 v[228:231], v[36:39], v[96:99], v[228:231]
    ds_read_b128 v[32:35], v1 offset:256
    v_cvt_pk_bf16_f32 v255, v222, v223
    s_waitcnt lgkmcnt(3)
    v_mfma_f32_16x16x32_bf16 v[208:211], v[16:19], v[40:43], 0
    ds_read_b128 v[36:39], v1 offset:320
    v_mfma_f32_16x16x32_bf16 v[208:211], v[20:23], v[48:51], v[208:211]
    v_exp_f32 v192, v192
    v_mfma_f32_16x16x32_bf16 v[216:219], v[16:19], v[44:47], 0
    v_exp_f32 v193, v193
    v_mfma_f32_16x16x32_bf16 v[216:219], v[20:23], v[52:55], v[216:219]
    ds_read_b128 v[16:19], v1 offset:384
    s_waitcnt lgkmcnt(3)
    v_mfma_f32_16x16x32_bf16 v[216:219], v[24:27], v[60:63], v[216:219]
    ds_read_b128 v[20:23], v1 offset:448
    v_cvt_pk_bf16_f32 v192, v192, v193
    v_mfma_f32_16x16x32_bf16 v[216:219], v[28:31], v[68:71], v[216:219]
    v_exp_f32 v194, v194
    v_mfma_f32_16x16x32_bf16 v[208:211], v[24:27], v[56:59], v[208:211]
    v_exp_f32 v195, v195
    v_mfma_f32_16x16x32_bf16 v[208:211], v[28:31], v[64:67], v[208:211]
    ds_read_b128 v[24:27], v1 offset:8448
    s_waitcnt lgkmcnt(3)
    v_mfma_f32_16x16x32_bf16 v[208:211], v[32:35], v[72:75], v[208:211]
    ds_read_b128 v[28:31], v1 offset:8512
    v_cvt_pk_bf16_f32 v193, v194, v195
    v_mfma_f32_16x16x32_bf16 v[208:211], v[36:39], v[80:83], v[208:211]
    v_exp_f32 v196, v196
    v_mfma_f32_16x16x32_bf16 v[216:219], v[32:35], v[76:79], v[216:219]
    v_exp_f32 v197, v197
    v_mfma_f32_16x16x32_bf16 v[216:219], v[36:39], v[84:87], v[216:219]
    ds_read_b128 v[32:35], v1 offset:8576
    s_waitcnt lgkmcnt(3)
    v_mfma_f32_16x16x32_bf16 v[216:219], v[16:19], v[92:95], v[216:219]
    ds_read_b128 v[36:39], v1 offset:8640
    v_cvt_pk_bf16_f32 v194, v196, v197
    v_mfma_f32_16x16x32_bf16 v[216:219], v[20:23], v[100:103], v[216:219]
    v_exp_f32 v198, v198
    v_mfma_f32_16x16x32_bf16 v[208:211], v[16:19], v[88:91], v[208:211]
    v_exp_f32 v199, v199
    v_mfma_f32_16x16x32_bf16 v[208:211], v[20:23], v[96:99], v[208:211]
    ds_read_b128 v[16:19], v1 offset:8704
    s_waitcnt lgkmcnt(3)
    v_mfma_f32_16x16x32_bf16 v[212:215], v[24:27], v[40:43], 0
    ds_read_b128 v[20:23], v1 offset:8768
    v_cvt_pk_bf16_f32 v195, v198, v199
    v_mfma_f32_16x16x32_bf16 v[212:215], v[28:31], v[48:51], v[212:215]
    v_exp_f32 v200, v200
    v_mfma_f32_16x16x32_bf16 v[220:223], v[24:27], v[44:47], 0
    v_exp_f32 v201, v201
    v_mfma_f32_16x16x32_bf16 v[220:223], v[28:31], v[52:55], v[220:223]
    ds_read_b128 v[24:27], v1 offset:8832
    s_waitcnt lgkmcnt(3)
    v_mfma_f32_16x16x32_bf16 v[220:223], v[32:35], v[60:63], v[220:223]
    ds_read_b128 v[28:31], v1 offset:8896
    v_cvt_pk_bf16_f32 v196, v200, v201
    v_mfma_f32_16x16x32_bf16 v[220:223], v[36:39], v[68:71], v[220:223]
    v_exp_f32 v202, v202
    v_mfma_f32_16x16x32_bf16 v[212:215], v[32:35], v[56:59], v[212:215]
    ds_read_b64_tr_b16 v[32:33], v2 offset:0
    v_mfma_f32_16x16x32_bf16 v[212:215], v[36:39], v[64:67], v[212:215]
    ds_read_b64_tr_b16 v[34:35], v2 offset:2048
    s_waitcnt lgkmcnt(4)
    v_mfma_f32_16x16x32_bf16 v[212:215], v[16:19], v[72:75], v[212:215]
    ds_read_b64_tr_b16 v[36:37], v2 offset:4096
    v_mfma_f32_16x16x32_bf16 v[212:215], v[20:23], v[80:83], v[212:215]
    ds_read_b64_tr_b16 v[38:39], v2 offset:6144
    v_mfma_f32_16x16x32_bf16 v[220:223], v[16:19], v[76:79], v[220:223]
    ds_read_b64_tr_b16 v[16:17], v3 offset:0
    v_mfma_f32_16x16x32_bf16 v[220:223], v[20:23], v[84:87], v[220:223]
    ds_read_b64_tr_b16 v[18:19], v3 offset:2048
    s_waitcnt lgkmcnt(6)
    v_mfma_f32_16x16x32_bf16 v[220:223], v[24:27], v[92:95], v[220:223]
    ds_read_b64_tr_b16 v[20:21], v3 offset:4096
    v_mfma_f32_16x16x32_bf16 v[220:223], v[28:31], v[100:103], v[220:223]
    ds_read_b64_tr_b16 v[22:23], v3 offset:6144
    v_mfma_f32_16x16x32_bf16 v[212:215], v[24:27], v[88:91], v[212:215]
    ds_read_b64_tr_b16 v[24:25], v4 offset:0
    v_mfma_f32_16x16x32_bf16 v[212:215], v[28:31], v[96:99], v[212:215]
    ds_read_b64_tr_b16 v[26:27], v4 offset:2048
    s_waitcnt lgkmcnt(6)
    v_mfma_f32_16x16x32_bf16 v[40:43], v[32:35], v[104:107], 0
    ds_read_b64_tr_b16 v[28:29], v4 offset:4096
    v_mov_b32 v88, 0x3f803f80
    v_mov_b32 v89, 0x3f803f80
    v_mfma_f32_16x16x32_bf16 v[40:43], v[36:39], v[136:139], v[40:43]
    ds_read_b64_tr_b16 v[30:31], v4 offset:6144
    v_mov_b32 v90, 0x3f803f80
    v_mov_b32 v91, 0x3f803f80
    v_mfma_f32_16x16x32_bf16 v[48:51], v[32:35], v[108:111], 0
    ds_read_b64_tr_b16 v[32:33], v5 offset:0
    v_exp_f32 v203, v203
    v_mfma_f32_16x16x32_bf16 v[48:51], v[36:39], v[140:143], v[48:51]
    ds_read_b64_tr_b16 v[34:35], v5 offset:2048
    v_exp_f32 v204, v204
    v_mfma_f32_16x16x32_bf16 v[92:95], v[88:91], v[104:107], 0
    v_exp_f32 v205, v205
    v_cvt_pk_bf16_f32 v197, v202, v203
    v_mfma_f32_16x16x32_bf16 v[92:95], v[88:91], v[136:139], v[92:95]
    v_exp_f32 v206, v206
    s_waitcnt lgkmcnt(6)
    v_mfma_f32_16x16x32_bf16 v[44:47], v[16:19], v[104:107], 0
    ds_read_b64_tr_b16 v[36:37], v5 offset:4096
    v_exp_f32 v207, v207
    v_mfma_f32_16x16x32_bf16 v[44:47], v[20:23], v[136:139], v[44:47]
    ds_read_b64_tr_b16 v[38:39], v5 offset:6144
    v_cvt_pk_bf16_f32 v198, v204, v205
    v_cvt_pk_bf16_f32 v199, v206, v207
    v_mfma_f32_16x16x32_bf16 v[52:55], v[16:19], v[108:111], 0
    ds_read_b64_tr_b16 v[16:17], v2 offset:8192
    v_exp_f32 v224, v224
    v_mfma_f32_16x16x32_bf16 v[52:55], v[20:23], v[140:143], v[52:55]
    ds_read_b64_tr_b16 v[18:19], v2 offset:10240
    v_exp_f32 v225, v225
    v_mfma_f32_16x16x32_bf16 v[100:103], v[88:91], v[108:111], 0
    v_exp_f32 v226, v226
    v_cvt_pk_bf16_f32 v224, v224, v225
    v_mfma_f32_16x16x32_bf16 v[100:103], v[88:91], v[140:143], v[100:103]
    v_exp_f32 v227, v227
    s_waitcnt lgkmcnt(6)
    v_mfma_f32_16x16x32_bf16 v[56:59], v[24:27], v[104:107], 0
    ds_read_b64_tr_b16 v[20:21], v2 offset:12288
    v_exp_f32 v228, v228
    v_mfma_f32_16x16x32_bf16 v[56:59], v[28:31], v[136:139], v[56:59]
    ds_read_b64_tr_b16 v[22:23], v2 offset:14336
    v_exp_f32 v229, v229
    v_mfma_f32_16x16x32_bf16 v[64:67], v[24:27], v[108:111], 0
    ds_read_b64_tr_b16 v[24:25], v3 offset:8192
    v_cvt_pk_bf16_f32 v225, v226, v227
    v_cvt_pk_bf16_f32 v226, v228, v229
    v_mfma_f32_16x16x32_bf16 v[64:67], v[28:31], v[140:143], v[64:67]
    ds_read_b64_tr_b16 v[26:27], v3 offset:10240
    s_waitcnt lgkmcnt(6)
    v_mfma_f32_16x16x32_bf16 v[60:63], v[32:35], v[104:107], 0
    ds_read_b64_tr_b16 v[28:29], v3 offset:12288
    v_exp_f32 v230, v230
    v_mfma_f32_16x16x32_bf16 v[60:63], v[36:39], v[136:139], v[60:63]
    ds_read_b64_tr_b16 v[30:31], v3 offset:14336
    v_exp_f32 v231, v231
    v_mfma_f32_16x16x32_bf16 v[68:71], v[32:35], v[108:111], 0
    ds_read_b64_tr_b16 v[32:33], v4 offset:8192
    v_exp_f32 v232, v232
    v_mfma_f32_16x16x32_bf16 v[68:71], v[36:39], v[140:143], v[68:71]
    ds_read_b64_tr_b16 v[34:35], v4 offset:10240
    v_cvt_pk_bf16_f32 v227, v230, v231
    s_waitcnt lgkmcnt(6)
    v_mfma_f32_16x16x32_bf16 v[40:43], v[16:19], v[168:171], v[40:43]
    ds_read_b64_tr_b16 v[36:37], v4 offset:12288
    v_exp_f32 v233, v233
    v_mfma_f32_16x16x32_bf16 v[40:43], v[20:23], v[248:251], v[40:43]
    ds_read_b64_tr_b16 v[38:39], v4 offset:14336
    v_exp_f32 v234, v234
    v_mfma_f32_16x16x32_bf16 v[48:51], v[16:19], v[172:175], v[48:51]
    ds_read_b64_tr_b16 v[16:17], v5 offset:8192
    v_exp_f32 v235, v235
    v_mfma_f32_16x16x32_bf16 v[48:51], v[20:23], v[252:255], v[48:51]
    ds_read_b64_tr_b16 v[18:19], v5 offset:10240
    v_cvt_pk_bf16_f32 v228, v232, v233
    v_cvt_pk_bf16_f32 v229, v234, v235
    v_mfma_f32_16x16x32_bf16 v[92:95], v[88:91], v[168:171], v[92:95]
    v_exp_f32 v236, v236
    v_mfma_f32_16x16x32_bf16 v[92:95], v[88:91], v[248:251], v[92:95]
    v_exp_f32 v237, v237
    s_waitcnt lgkmcnt(6)
    v_mfma_f32_16x16x32_bf16 v[44:47], v[24:27], v[168:171], v[44:47]
    ds_read_b64_tr_b16 v[20:21], v5 offset:12288
    v_exp_f32 v238, v238
    v_mfma_f32_16x16x32_bf16 v[44:47], v[28:31], v[248:251], v[44:47]
    ds_read_b64_tr_b16 v[22:23], v5 offset:14336
    v_exp_f32 v239, v239
    v_mfma_f32_16x16x32_bf16 v[52:55], v[24:27], v[172:175], v[52:55]
    s_barrier
    ds_read_b64_tr_b16 v[24:25], v2 offset:16896
    v_cvt_pk_bf16_f32 v230, v236, v237
    v_mfma_f32_16x16x32_bf16 v[52:55], v[28:31], v[252:255], v[52:55]
    ds_read_b64_tr_b16 v[26:27], v2 offset:18944
    v_cvt_pk_bf16_f32 v231, v238, v239
    v_mfma_f32_16x16x32_bf16 v[100:103], v[88:91], v[172:175], v[100:103]
    v_exp_f32 v208, v208
    v_mfma_f32_16x16x32_bf16 v[100:103], v[88:91], v[252:255], v[100:103]
    v_exp_f32 v209, v209
    s_waitcnt lgkmcnt(6)
    v_mfma_f32_16x16x32_bf16 v[56:59], v[32:35], v[168:171], v[56:59]
    ds_read_b64_tr_b16 v[28:29], v2 offset:20992
    v_exp_f32 v210, v210
    v_mfma_f32_16x16x32_bf16 v[56:59], v[36:39], v[248:251], v[56:59]
    ds_read_b64_tr_b16 v[30:31], v2 offset:23040
    v_exp_f32 v211, v211
    v_mfma_f32_16x16x32_bf16 v[64:67], v[32:35], v[172:175], v[64:67]
    ds_read_b64_tr_b16 v[32:33], v3 offset:16896
    v_cvt_pk_bf16_f32 v200, v208, v209
    v_cvt_pk_bf16_f32 v201, v210, v211
    v_mfma_f32_16x16x32_bf16 v[64:67], v[36:39], v[252:255], v[64:67]
    ds_read_b64_tr_b16 v[34:35], v3 offset:18944
    s_waitcnt lgkmcnt(6)
    v_mfma_f32_16x16x32_bf16 v[60:63], v[16:19], v[168:171], v[60:63]
    ds_read_b64_tr_b16 v[36:37], v3 offset:20992
    v_exp_f32 v212, v212
    v_mfma_f32_16x16x32_bf16 v[60:63], v[20:23], v[248:251], v[60:63]
    ds_read_b64_tr_b16 v[38:39], v3 offset:23040
    v_exp_f32 v213, v213
    v_mfma_f32_16x16x32_bf16 v[68:71], v[16:19], v[172:175], v[68:71]
    ds_read_b64_tr_b16 v[16:17], v4 offset:16896
    v_exp_f32 v214, v214
    v_mfma_f32_16x16x32_bf16 v[68:71], v[20:23], v[252:255], v[68:71]
    ds_read_b64_tr_b16 v[18:19], v4 offset:18944
    v_cvt_pk_bf16_f32 v202, v212, v213
    s_waitcnt lgkmcnt(6)
    v_mfma_f32_16x16x32_bf16 v[40:43], v[24:27], v[112:115], v[40:43]
    ds_read_b64_tr_b16 v[20:21], v4 offset:20992
    v_exp_f32 v215, v215
    v_mfma_f32_16x16x32_bf16 v[40:43], v[28:31], v[144:147], v[40:43]
    ds_read_b64_tr_b16 v[22:23], v4 offset:23040
    v_exp_f32 v216, v216
    v_mfma_f32_16x16x32_bf16 v[48:51], v[24:27], v[116:119], v[48:51]
    ds_read_b64_tr_b16 v[24:25], v5 offset:16896
    v_exp_f32 v217, v217
    v_mfma_f32_16x16x32_bf16 v[48:51], v[28:31], v[148:151], v[48:51]
    ds_read_b64_tr_b16 v[26:27], v5 offset:18944
    v_cvt_pk_bf16_f32 v203, v214, v215
    v_cvt_pk_bf16_f32 v204, v216, v217
    v_mfma_f32_16x16x32_bf16 v[92:95], v[88:91], v[112:115], v[92:95]
    v_exp_f32 v218, v218
    v_mfma_f32_16x16x32_bf16 v[92:95], v[88:91], v[144:147], v[92:95]
    v_exp_f32 v219, v219
    s_waitcnt lgkmcnt(6)
    v_mfma_f32_16x16x32_bf16 v[44:47], v[32:35], v[112:115], v[44:47]
    ds_read_b64_tr_b16 v[28:29], v5 offset:20992
    v_exp_f32 v220, v220
    v_mfma_f32_16x16x32_bf16 v[44:47], v[36:39], v[144:147], v[44:47]
    ds_read_b64_tr_b16 v[30:31], v5 offset:23040
    v_exp_f32 v221, v221
    v_mfma_f32_16x16x32_bf16 v[52:55], v[32:35], v[116:119], v[52:55]
    ds_read_b64_tr_b16 v[32:33], v2 offset:25088
    v_cvt_pk_bf16_f32 v205, v218, v219
    v_cvt_pk_bf16_f32 v206, v220, v221
    v_mfma_f32_16x16x32_bf16 v[52:55], v[36:39], v[148:151], v[52:55]
    ds_read_b64_tr_b16 v[34:35], v2 offset:27136
    v_exp_f32 v222, v222
    v_mfma_f32_16x16x32_bf16 v[100:103], v[88:91], v[116:119], v[100:103]
    v_exp_f32 v223, v223
    v_mfma_f32_16x16x32_bf16 v[100:103], v[88:91], v[148:151], v[100:103]
    v_cvt_pk_bf16_f32 v207, v222, v223
    s_waitcnt lgkmcnt(6)
    v_mfma_f32_16x16x32_bf16 v[56:59], v[16:19], v[112:115], v[56:59]
    ds_read_b64_tr_b16 v[36:37], v2 offset:29184
    v_mfma_f32_16x16x32_bf16 v[56:59], v[20:23], v[144:147], v[56:59]
    ds_read_b64_tr_b16 v[38:39], v2 offset:31232
    v_mfma_f32_16x16x32_bf16 v[64:67], v[16:19], v[116:119], v[64:67]
    ds_read_b64_tr_b16 v[16:17], v3 offset:25088
    v_mfma_f32_16x16x32_bf16 v[64:67], v[20:23], v[148:151], v[64:67]
    ds_read_b64_tr_b16 v[18:19], v3 offset:27136
    s_waitcnt lgkmcnt(6)
    v_mfma_f32_16x16x32_bf16 v[60:63], v[24:27], v[112:115], v[60:63]
    ds_read_b64_tr_b16 v[20:21], v3 offset:29184
    v_mfma_f32_16x16x32_bf16 v[60:63], v[28:31], v[144:147], v[60:63]
    ds_read_b64_tr_b16 v[22:23], v3 offset:31232
    v_mfma_f32_16x16x32_bf16 v[68:71], v[24:27], v[116:119], v[68:71]
    ds_read_b64_tr_b16 v[24:25], v4 offset:25088
    v_mfma_f32_16x16x32_bf16 v[68:71], v[28:31], v[148:151], v[68:71]
    ds_read_b64_tr_b16 v[26:27], v4 offset:27136
    s_waitcnt lgkmcnt(6)
    v_mfma_f32_16x16x32_bf16 v[40:43], v[32:35], v[176:179], v[40:43]
    ds_read_b64_tr_b16 v[28:29], v4 offset:29184
    v_mfma_f32_16x16x32_bf16 v[40:43], v[36:39], v[192:195], v[40:43]
    ds_read_b64_tr_b16 v[30:31], v4 offset:31232
    v_mfma_f32_16x16x32_bf16 v[48:51], v[32:35], v[180:183], v[48:51]
    ds_read_b64_tr_b16 v[32:33], v5 offset:25088
    v_mfma_f32_16x16x32_bf16 v[48:51], v[36:39], v[196:199], v[48:51]
    ds_read_b64_tr_b16 v[34:35], v5 offset:27136
    v_mfma_f32_16x16x32_bf16 v[92:95], v[88:91], v[176:179], v[92:95]
    v_mfma_f32_16x16x32_bf16 v[92:95], v[88:91], v[192:195], v[92:95]
    s_waitcnt lgkmcnt(6)
    v_mfma_f32_16x16x32_bf16 v[44:47], v[16:19], v[176:179], v[44:47]
L_pad2:
    s_cbranch_execz L_back2
    ds_read_b64_tr_b16 v[36:37], v5 offset:29184
    v_mfma_f32_16x16x32_bf16 v[44:47], v[20:23], v[192:195], v[44:47]
    ds_read_b64_tr_b16 v[38:39], v5 offset:31232
    v_mfma_f32_16x16x32_bf16 v[52:55], v[16:19], v[180:183], v[52:55]
    ds_read_b64_tr_b16 v[16:17], v2 offset:33792
    v_mfma_f32_16x16x32_bf16 v[52:55], v[20:23], v[196:199], v[52:55]
    ds_read_b64_tr_b16 v[18:19], v2 offset:35840
    v_mfma_f32_16x16x32_bf16 v[100:103], v[88:91], v[180:183], v[100:103]
    v_mfma_f32_16x16x32_bf16 v[100:103], v[88:91], v[196:199], v[100:103]
    s_waitcnt lgkmcnt(6)
    v_mfma_f32_16x16x32_bf16 v[56:59], v[24:27], v[176:179], v[56:59]
    ds_read_b64_tr_b16 v[20:21], v2 offset:37888
    v_mfma_f32_16x16x32_bf16 v[56:59], v[28:31], v[192:195], v[56:59]
    ds_read_b64_tr_b16 v[22:23], v2 offset:39936
    v_mfma_f32_16x16x32_bf16 v[64:67], v[24:27], v[180:183], v[64:67]
    ds_read_b64_tr_b16 v[24:25], v3 offset:33792
    v_mfma_f32_16x16x32_bf16 v[64:67], v[28:31], v[196:199], v[64:67]
    ds_read_b64_tr_b16 v[26:27], v3 offset:35840
    s_waitcnt lgkmcnt(6)
    v_mfma_f32_16x16x32_bf16 v[60:63], v[32:35], v[176:179], v[60:63]
    ds_read_b64_tr_b16 v[28:29], v3 offset:37888
    v_mfma_f32_16x16x32_bf16 v[60:63], v[36:39], v[192:195], v[60:63]
    ds_read_b64_tr_b16 v[30:31], v3 offset:39936
    v_mfma_f32_16x16x32_bf16 v[68:71], v[32:35], v[180:183], v[68:71]
    ds_read_b64_tr_b16 v[32:33], v4 offset:33792
    v_mfma_f32_16x16x32_bf16 v[68:71], v[36:39], v[196:199], v[68:71]
    ds_read_b64_tr_b16 v[34:35], v4 offset:35840
    s_waitcnt lgkmcnt(6)
    v_mfma_f32_16x16x32_bf16 v[40:43], v[16:19], v[120:123], v[40:43]
    ds_read_b64_tr_b16 v[36:37], v4 offset:37888
    v_mfma_f32_16x16x32_bf16 v[40:43], v[20:23], v[152:155], v[40:43]
    ds_read_b64_tr_b16 v[38:39], v4 offset:39936
    v_mfma_f32_16x16x32_bf16 v[48:51], v[16:19], v[124:127], v[48:51]
    ds_read_b64_tr_b16 v[16:17], v5 offset:33792
    v_mfma_f32_16x16x32_bf16 v[48:51], v[20:23], v[156:159], v[48:51]
    ds_read_b64_tr_b16 v[18:19], v5 offset:35840
    v_mfma_f32_16x16x32_bf16 v[92:95], v[88:91], v[120:123], v[92:95]
    v_mfma_f32_16x16x32_bf16 v[92:95], v[88:91], v[152:155], v[92:95]
    s_waitcnt lgkmcnt(6)
    v_mfma_f32_16x16x32_bf16 v[44:47], v[24:27], v[120:123], v[44:47]
    ds_read_b64_tr_b16 v[20:21], v5 offset:37888
    v_mfma_f32_16x16x32_bf16 v[44:47], v[28:31], v[152:155], v[44:47]
    ds_read_b64_tr_b16 v[22:23], v5 offset:39936
    v_mfma_f32_16x16x32_bf16 v[52:55], v[24:27], v[124:127], v[52:55]
    ds_read_b64_tr_b16 v[24:25], v2 offset:41984
    v_mfma_f32_16x16x32_bf16 v[52:55], v[28:31], v[156:159], v[52:55]
    ds_read_b64_tr_b16 v[26:27], v2 offset:44032
    v_mfma_f32_16x16x32_bf16 v[100:103], v[88:91], v[124:127], v[100:103]
    v_mfma_f32_16x16x32_bf16 v[100:103], v[88:91], v[156:159], v[100:103]
    s_waitcnt lgkmcnt(6)
    v_mfma_f32_16x16x32_bf16 v[56:59], v[32:35], v[120:123], v[56:59]
    ds_read_b64_tr_b16 v[28:29], v2 offset:46080
    v_mfma_f32_16x16x32_bf16 v[56:59], v[36:39], v[152:155], v[56:59]
    ds_read_b64_tr_b16 v[30:31], v2 offset:48128
    v_mfma_f32_16x16x32_bf16 v[64:67], v[32:35], v[124:127], v[64:67]
    ds_read_b64_tr_b16 v[32:33], v3 offset:41984
    v_mfma_f32_16x16x32_bf16 v[64:67], v[36:39], v[156:159], v[64:67]
    ds_read_b64_tr_b16 v[34:35], v3 offset:44032
    s_waitcnt lgkmcnt(6)
    v_mfma_f32_16x16x32_bf16 v[60:63], v[16:19], v[120:123], v[60:63]
    ds_read_b64_tr_b16 v[36:37], v3 offset:46080
    v_mfma_f32_16x16x32_bf16 v[60:63], v[20:23], v[152:155], v[60:63]
    ds_read_b64_tr_b16 v[38:39], v3 offset:48128
    v_mfma_f32_16x16x32_bf16 v[68:71], v[16:19], v[124:127], v[68:71]
    ds_read_b64_tr_b16 v[16:17], v4 offset:41984
    v_mfma_f32_16x16x32_bf16 v[68:71], v[20:23], v[156:159], v[68:71]
    ds_read_b64_tr_b16 v[18:19], v4 offset:44032
    s_waitcnt lgkmcnt(6)
    v_mfma_f32_16x16x32_bf16 v[40:43], v[24:27], v[240:243], v[40:43]
    ds_read_b64_tr_b16 v[20:21], v4 offset:46080
    v_mfma_f32_16x16x32_bf16 v[40:43], v[28:31], v[224:227], v[40:43]
    ds_read_b64_tr_b16 v[22:23], v4 offset:48128
    v_mfma_f32_16x16x32_bf16 v[48:51], v[24:27], v[244:247], v[48:51]
    ds_read_b64_tr_b16 v[24:25], v5 offset:41984
    v_mfma_f32_16x16x32_bf16 v[48:51], v[28:31], v[228:231], v[48:51]
    ds_read_b64_tr_b16 v[26:27], v5 offset:44032
    v_mfma_f32_16x16x32_bf16 v[92:95], v[88:91], v[240:243], v[92:95]
    v_mfma_f32_16x16x32_bf16 v[92:95], v[88:91], v[224:227], v[92:95]
    s_waitcnt lgkmcnt(6)
    v_mfma_f32_16x16x32_bf16 v[44:47], v[32:35], v[240:243], v[44:47]
    ds_read_b64_tr_b16 v[28:29], v5 offset:46080
    v_mfma_f32_16x16x32_bf16 v[44:47], v[36:39], v[224:227], v[44:47]
    ds_read_b64_tr_b16 v[30:31], v5 offset:48128
    v_mfma_f32_16x16x32_bf16 v[52:55], v[32:35], v[244:247], v[52:55]
    s_barrier
    ds_read_b64_tr_b16 v[32:33], v2 offset:50688
    v_mfma_f32_16x16x32_bf16 v[52:55], v[36:39], v[228:231], v[52:55]
    ds_read_b64_tr_b16 v[34:35], v2 offset:52736
    v_mfma_f32_16x16x32_bf16 v[100:103], v[88:91], v[244:247], v[100:103]
    v_mfma_f32_16x16x32_bf16 v[100:103], v[88:91], v[228:231], v[100:103]
    s_waitcnt lgkmcnt(6)
    v_mfma_f32_16x16x32_bf16 v[56:59], v[16:19], v[240:243], v[56:59]
    ds_read_b64_tr_b16 v[36:37], v2 offset:54784
    v_mfma_f32_16x16x32_bf16 v[56:59], v[20:23], v[224:227], v[56:59]
    ds_read_b64_tr_b16 v[38:39], v2 offset:56832
    v_mfma_f32_16x16x32_bf16 v[64:67], v[16:19], v[244:247], v[64:67]
    ds_read_b64_tr_b16 v[16:17], v3 offset:50688
    v_mfma_f32_16x16x32_bf16 v[64:67], v[20:23], v[228:231], v[64:67]
    ds_read_b64_tr_b16 v[18:19], v3 offset:52736
    s_waitcnt lgkmcnt(6)
    v_mfma_f32_16x16x32_bf16 v[60:63], v[24:27], v[240:243], v[60:63]
    ds_read_b64_tr_b16 v[20:21], v3 offset:54784
    v_mfma_f32_16x16x32_bf16 v[60:63], v[28:31], v[224:227], v[60:63]
    ds_read_b64_tr_b16 v[22:23], v3 offset:56832
    v_mfma_f32_16x16x32_bf16 v[68:71], v[24:27], v[244:247], v[68:71]
    ds_read_b64_tr_b16 v[24:25], v4 offset:50688
    v_mfma_f32_16x16x32_bf16 v[68:71], v[28:31], v[228:231], v[68:71]
    ds_read_b64_tr_b16 v[26:27], v4 offset:52736
    s_waitcnt lgkmcnt(6)
    v_mfma_f32_16x16x32_bf16 v[40:43], v[32:35], v[128:131], v[40:43]
    ds_read_b64_tr_b16 v[28:29], v4 offset:54784
    v_mfma_f32_16x16x32_bf16 v[40:43], v[36:39], v[160:163], v[40:43]
    ds_read_b64_tr_b16 v[30:31], v4 offset:56832
    v_mfma_f32_16x16x32_bf16 v[48:51], v[32:35], v[132:135], v[48:51]
    ds_read_b64_tr_b16 v[32:33], v5 offset:50688
    v_mfma_f32_16x16x32_bf16 v[48:51], v[36:39], v[164:167], v[48:51]
    ds_read_b64_tr_b16 v[34:35], v5 offset:52736
    v_mfma_f32_16x16x32_bf16 v[92:95], v[88:91], v[128:131], v[92:95]
    v_mfma_f32_16x16x32_bf16 v[92:95], v[88:91], v[160:163], v[92:95]
    s_waitcnt lgkmcnt(6)
    v_mfma_f32_16x16x32_bf16 v[44:47], v[16:19], v[128:131], v[44:47]
    ds_read_b64_tr_b16 v[36:37], v5 offset:54784
    v_mfma_f32_16x16x32_bf16 v[44:47], v[20:23], v[160:163], v[44:47]
    ds_read_b64_tr_b16 v[38:39], v5 offset:56832
    v_mfma_f32_16x16x32_bf16 v[52:55], v[16:19], v[132:135], v[52:55]
    ds_read_b64_tr_b16 v[16:17], v2 offset:58880
    v_mfma_f32_16x16x32_bf16 v[52:55], v[20:23], v[164:167], v[52:55]
    ds_read_b64_tr_b16 v[18:19], v2 offset:60928
    v_mfma_f32_16x16x32_bf16 v[100:103], v[88:91], v[132:135], v[100:103]
    v_mfma_f32_16x16x32_bf16 v[100:103], v[88:91], v[164:167], v[100:103]
    s_waitcnt lgkmcnt(6)
    v_mfma_f32_16x16x32_bf16 v[56:59], v[24:27], v[128:131], v[56:59]
    ds_read_b64_tr_b16 v[20:21], v2 offset:62976
    v_mfma_f32_16x16x32_bf16 v[56:59], v[28:31], v[160:163], v[56:59]
    ds_read_b64_tr_b16 v[22:23], v2 offset:65024
    v_mfma_f32_16x16x32_bf16 v[64:67], v[24:27], v[132:135], v[64:67]
    ds_read_b64_tr_b16 v[24:25], v3 offset:58880
    v_mfma_f32_16x16x32_bf16 v[64:67], v[28:31], v[164:167], v[64:67]
    ds_read_b64_tr_b16 v[26:27], v3 offset:60928
    s_waitcnt lgkmcnt(6)
    v_mfma_f32_16x16x32_bf16 v[60:63], v[32:35], v[128:131], v[60:63]
    ds_read_b64_tr_b16 v[28:29], v3 offset:62976
    v_mfma_f32_16x16x32_bf16 v[60:63], v[36:39], v[160:163], v[60:63]
    ds_read_b64_tr_b16 v[30:31], v3 offset:65024
    v_mfma_f32_16x16x32_bf16 v[68:71], v[32:35], v[132:135], v[68:71]
    ds_read_b64_tr_b16 v[32:33], v4 offset:58880
    v_mfma_f32_16x16x32_bf16 v[68:71], v[36:39], v[164:167], v[68:71]
    ds_read_b64_tr_b16 v[34:35], v4 offset:60928
    s_waitcnt lgkmcnt(6)
    v_mfma_f32_16x16x32_bf16 v[40:43], v[16:19], v[184:187], v[40:43]
    ds_read_b64_tr_b16 v[36:37], v4 offset:62976
    v_mfma_f32_16x16x32_bf16 v[40:43], v[20:23], v[200:203], v[40:43]
    ds_read_b64_tr_b16 v[38:39], v4 offset:65024
    v_mfma_f32_16x16x32_bf16 v[48:51], v[16:19], v[188:191], v[48:51]
    ds_read_b64_tr_b16 v[16:17], v5 offset:58880
    v_mfma_f32_16x16x32_bf16 v[48:51], v[20:23], v[204:207], v[48:51]
    ds_read_b64_tr_b16 v[18:19], v5 offset:60928
    v_mfma_f32_16x16x32_bf16 v[92:95], v[88:91], v[184:187], v[92:95]
    v_mfma_f32_16x16x32_bf16 v[92:95], v[88:91], v[200:203], v[92:95]
    s_waitcnt lgkmcnt(6)
    v_mfma_f32_16x16x32_bf16 v[44:47], v[24:27], v[184:187], v[44:47]
    ds_read_b64_tr_b16 v[20:21], v5 offset:62976
    v_mfma_f32_16x16x32_bf16 v[44:47], v[28:31], v[200:203], v[44:47]
    ds_read_b64_tr_b16 v[22:23], v5 offset:65024
    v_mfma_f32_16x16x32_bf16 v[52:55], v[24:27], v[188:191], v[52:55]
    v_add_u32 v2, 67584, v2
    ds_read_b64_tr_b16 v[24:25], v2 offset:0
    v_mfma_f32_16x16x32_bf16 v[52:55], v[28:31], v[204:207], v[52:55]
    ds_read_b64_tr_b16 v[26:27], v2 offset:2048
    v_mfma_f32_16x16x32_bf16 v[100:103], v[88:91], v[188:191], v[100:103]
    v_mfma_f32_16x16x32_bf16 v[100:103], v[88:91], v[204:207], v[100:103]
    s_waitcnt lgkmcnt(6)
    v_mfma_f32_16x16x32_bf16 v[56:59], v[32:35], v[184:187], v[56:59]
    ds_read_b64_tr_b16 v[28:29], v2 offset:4096
    v_rcp_f32 v10, v92
    v_subrev_u32 v8, 0x2b800000, v92
    v_mfma_f32_16x16x32_bf16 v[56:59], v[36:39], v[200:203], v[56:59]
    ds_read_b64_tr_b16 v[30:31], v2 offset:6144
    v_mfma_f32_16x16x32_bf16 v[64:67], v[32:35], v[188:191], v[64:67]
    ds_read_b64_tr_b16 v[32:33], v2 offset:8192
    v_rcp_f32 v11, v100
    v_subrev_u32 v9, 0x2b800000, v100
    v_mfma_f32_16x16x32_bf16 v[64:67], v[36:39], v[204:207], v[64:67]
    ds_read_b64_tr_b16 v[34:35], v2 offset:10240
    v_max_u32 v8, v8, v9
    s_waitcnt lgkmcnt(6)
    v_mfma_f32_16x16x32_bf16 v[60:63], v[16:19], v[184:187], v[60:63]
    ds_read_b64_tr_b16 v[36:37], v2 offset:12288
    v_mul_f32 v40, v40, v10
    v_mul_f32 v41, v41, v10
    v_mfma_f32_16x16x32_bf16 v[60:63], v[20:23], v[200:203], v[60:63]
    ds_read_b64_tr_b16 v[38:39], v2 offset:14336
    v_mul_f32 v42, v42, v10
    v_mul_f32 v43, v43, v10
    v_mfma_f32_16x16x32_bf16 v[68:71], v[16:19], v[188:191], v[68:71]
    v_add_u32 v3, 67584, v3
    ds_read_b64_tr_b16 v[16:17], v3 offset:0
    v_cvt_pk_bf16_f32 v208, v40, v41
    v_mfma_f32_16x16x32_bf16 v[68:71], v[20:23], v[204:207], v[68:71]
    ds_read_b64_tr_b16 v[18:19], v3 offset:2048
    v_cvt_pk_bf16_f32 v209, v42, v43
    s_waitcnt lgkmcnt(6)
    v_mfma_f32_16x16x32_bf16 v[72:75], v[24:27], v[104:107], 0
    ds_read_b64_tr_b16 v[20:21], v3 offset:4096
    v_cmp_lt_u32 vcc, 0x28000000, v8
    v_mov_b32 v9, 152064
    s_cmp_lg_u64 vcc, 0
    s_cselect_b32 s36, 1, 0
    v_mov_b32 v8, s36
    ds_write_b32 v7, v8
    v_mfma_f32_16x16x32_bf16 v[72:75], v[28:31], v[136:139], v[72:75]
    ds_read_b64_tr_b16 v[22:23], v3 offset:6144
    v_mul_f32 v44, v44, v10
    v_mfma_f32_16x16x32_bf16 v[80:83], v[24:27], v[108:111], 0
    ds_read_b64_tr_b16 v[24:25], v3 offset:8192
    v_mul_f32 v45, v45, v10
    v_mfma_f32_16x16x32_bf16 v[80:83], v[28:31], v[140:143], v[80:83]
    ds_read_b64_tr_b16 v[26:27], v3 offset:10240
    s_waitcnt lgkmcnt(7)
    v_mfma_f32_16x16x32_bf16 v[80:83], v[32:35], v[172:175], v[80:83]
    ds_read_b64_tr_b16 v[28:29], v3 offset:12288
    v_mul_f32 v46, v46, v10
    v_mfma_f32_16x16x32_bf16 v[80:83], v[36:39], v[252:255], v[80:83]
    ds_read_b64_tr_b16 v[30:31], v3 offset:14336
    v_mul_f32 v47, v47, v10
    v_mfma_f32_16x16x32_bf16 v[72:75], v[32:35], v[168:171], v[72:75]
    v_add_u32 v4, 67584, v4
    ds_read_b64_tr_b16 v[32:33], v4 offset:0
    v_mfma_f32_16x16x32_bf16 v[72:75], v[36:39], v[248:251], v[72:75]
    ds_read_b64_tr_b16 v[34:35], v4 offset:2048
    s_waitcnt lgkmcnt(6)
    v_mfma_f32_16x16x32_bf16 v[76:79], v[16:19], v[104:107], 0
    ds_read_b64_tr_b16 v[36:37], v4 offset:4096
    v_cvt_pk_bf16_f32 v210, v44, v45
    v_mfma_f32_16x16x32_bf16 v[76:79], v[20:23], v[136:139], v[76:79]
    ds_read_b64_tr_b16 v[38:39], v4 offset:6144
    v_cvt_pk_bf16_f32 v211, v46, v47
    v_mfma_f32_16x16x32_bf16 v[84:87], v[16:19], v[108:111], 0
    ds_read_b64_tr_b16 v[16:17], v4 offset:8192
    v_permlane16_swap_b32 v208, v210
    v_mfma_f32_16x16x32_bf16 v[84:87], v[20:23], v[140:143], v[84:87]
    ds_read_b64_tr_b16 v[18:19], v4 offset:10240
    s_waitcnt lgkmcnt(6)
    v_mfma_f32_16x16x32_bf16 v[84:87], v[24:27], v[172:175], v[84:87]
    ds_read_b64_tr_b16 v[20:21], v4 offset:12288
    v_permlane16_swap_b32 v209, v211
    v_mfma_f32_16x16x32_bf16 v[84:87], v[28:31], v[252:255], v[84:87]
    ds_read_b64_tr_b16 v[22:23], v4 offset:14336
    v_mul_f32 v48, v48, v11
    v_mfma_f32_16x16x32_bf16 v[76:79], v[24:27], v[168:171], v[76:79]
    v_add_u32 v5, 67584, v5
    ds_read_b64_tr_b16 v[24:25], v5 offset:0
    v_mfma_f32_16x16x32_bf16 v[76:79], v[28:31], v[248:251], v[76:79]
    ds_read_b64_tr_b16 v[26:27], v5 offset:2048
    s_waitcnt lgkmcnt(6)
    v_mfma_f32_16x16x32_bf16 v[88:91], v[32:35], v[104:107], 0
    ds_read_b64_tr_b16 v[28:29], v5 offset:4096
    buffer_store_dwordx4 v[208:211], v6, s[24:27], s16 offen offset:0 sc0 sc1
    v_mfma_f32_16x16x32_bf16 v[88:91], v[36:39], v[136:139], v[88:91]
    ds_read_b64_tr_b16 v[30:31], v5 offset:6144
    v_mul_f32 v49, v49, v11
    v_mfma_f32_16x16x32_bf16 v[96:99], v[32:35], v[108:111], 0
    ds_read_b64_tr_b16 v[32:33], v5 offset:8192
    v_mul_f32 v50, v50, v11
    v_mfma_f32_16x16x32_bf16 v[96:99], v[36:39], v[140:143], v[96:99]
    ds_read_b64_tr_b16 v[34:35], v5 offset:10240
    s_waitcnt lgkmcnt(6)
    v_mfma_f32_16x16x32_bf16 v[96:99], v[16:19], v[172:175], v[96:99]
    ds_read_b64_tr_b16 v[36:37], v5 offset:12288
    v_mul_f32 v51, v51, v11
    v_mfma_f32_16x16x32_bf16 v[96:99], v[20:23], v[252:255], v[96:99]
    ds_read_b64_tr_b16 v[38:39], v5 offset:14336
    v_cvt_pk_bf16_f32 v212, v48, v49
    v_mfma_f32_16x16x32_bf16 v[88:91], v[16:19], v[168:171], v[88:91]
    s_barrier
    ds_read_b128 v[12:15], v9
    ds_read_b64_tr_b16 v[16:17], v2 offset:16896
    v_mfma_f32_16x16x32_bf16 v[88:91], v[20:23], v[248:251], v[88:91]
    ds_read_b64_tr_b16 v[18:19], v2 offset:18944
    s_waitcnt lgkmcnt(7)
    v_mfma_f32_16x16x32_bf16 v[92:95], v[24:27], v[104:107], 0
    ds_read_b64_tr_b16 v[20:21], v2 offset:20992
    v_cvt_pk_bf16_f32 v213, v50, v51
    v_mfma_f32_16x16x32_bf16 v[92:95], v[28:31], v[136:139], v[92:95]
    ds_read_b64_tr_b16 v[22:23], v2 offset:23040
    v_mul_f32 v52, v52, v11
    v_mfma_f32_16x16x32_bf16 v[100:103], v[24:27], v[108:111], 0
    ds_read_b64_tr_b16 v[24:25], v2 offset:25088
    v_mul_f32 v53, v53, v11
    v_mfma_f32_16x16x32_bf16 v[100:103], v[28:31], v[140:143], v[100:103]
    ds_read_b64_tr_b16 v[26:27], v2 offset:27136
    s_waitcnt lgkmcnt(7)
    v_mfma_f32_16x16x32_bf16 v[100:103], v[32:35], v[172:175], v[100:103]
    ds_read_b64_tr_b16 v[28:29], v2 offset:29184
    v_mul_f32 v54, v54, v11
    v_mfma_f32_16x16x32_bf16 v[100:103], v[36:39], v[252:255], v[100:103]
    ds_read_b64_tr_b16 v[30:31], v2 offset:31232
    v_mul_f32 v55, v55, v11
    v_mfma_f32_16x16x32_bf16 v[92:95], v[32:35], v[168:171], v[92:95]
    ds_read_b64_tr_b16 v[32:33], v3 offset:16896
    v_cvt_pk_bf16_f32 v214, v52, v53
    v_mfma_f32_16x16x32_bf16 v[92:95], v[36:39], v[248:251], v[92:95]
    ds_read_b64_tr_b16 v[34:35], v3 offset:18944
    s_waitcnt lgkmcnt(6)
    v_mfma_f32_16x16x32_bf16 v[72:75], v[16:19], v[112:115], v[72:75]
    ds_read_b64_tr_b16 v[36:37], v3 offset:20992
    v_or3_b32 v9, v12, v13, v14
    v_or_b32 v9, v9, v15
    v_cmp_ne_u32 vcc, 0, v9
    s_cbranch_vccnz L_redo_compute_fast
    v_mfma_f32_16x16x32_bf16 v[72:75], v[20:23], v[144:147], v[72:75]
    ds_read_b64_tr_b16 v[38:39], v3 offset:23040
    v_cvt_pk_bf16_f32 v215, v54, v55
    v_mfma_f32_16x16x32_bf16 v[80:83], v[16:19], v[116:119], v[80:83]
    ds_read_b64_tr_b16 v[16:17], v3 offset:25088
    v_permlane16_swap_b32 v212, v214
    v_mfma_f32_16x16x32_bf16 v[80:83], v[20:23], v[148:151], v[80:83]
    ds_read_b64_tr_b16 v[18:19], v3 offset:27136
    s_waitcnt lgkmcnt(6)
    v_mfma_f32_16x16x32_bf16 v[80:83], v[24:27], v[180:183], v[80:83]
    ds_read_b64_tr_b16 v[20:21], v3 offset:29184
    v_permlane16_swap_b32 v213, v215
    v_mfma_f32_16x16x32_bf16 v[80:83], v[28:31], v[196:199], v[80:83]
    ds_read_b64_tr_b16 v[22:23], v3 offset:31232
    v_mul_f32 v56, v56, v10
    v_mfma_f32_16x16x32_bf16 v[72:75], v[24:27], v[176:179], v[72:75]
    ds_read_b64_tr_b16 v[24:25], v4 offset:16896
    v_mul_f32 v57, v57, v10
    v_mfma_f32_16x16x32_bf16 v[72:75], v[28:31], v[192:195], v[72:75]
    ds_read_b64_tr_b16 v[26:27], v4 offset:18944
    s_waitcnt lgkmcnt(6)
    v_mfma_f32_16x16x32_bf16 v[76:79], v[32:35], v[112:115], v[76:79]
    ds_read_b64_tr_b16 v[28:29], v4 offset:20992
    v_mul_f32 v58, v58, v10
    v_mfma_f32_16x16x32_bf16 v[76:79], v[36:39], v[144:147], v[76:79]
    ds_read_b64_tr_b16 v[30:31], v4 offset:23040
    v_mul_f32 v59, v59, v10
    v_mfma_f32_16x16x32_bf16 v[84:87], v[32:35], v[116:119], v[84:87]
    ds_read_b64_tr_b16 v[32:33], v4 offset:25088
    v_cvt_pk_bf16_f32 v216, v56, v57
    v_mfma_f32_16x16x32_bf16 v[84:87], v[36:39], v[148:151], v[84:87]
    ds_read_b64_tr_b16 v[34:35], v4 offset:27136
    s_waitcnt lgkmcnt(6)
    v_mfma_f32_16x16x32_bf16 v[84:87], v[16:19], v[180:183], v[84:87]
    ds_read_b64_tr_b16 v[36:37], v4 offset:29184
    v_cvt_pk_bf16_f32 v217, v58, v59
    v_mfma_f32_16x16x32_bf16 v[84:87], v[20:23], v[196:199], v[84:87]
    ds_read_b64_tr_b16 v[38:39], v4 offset:31232
    v_mul_f32 v60, v60, v10
    v_mfma_f32_16x16x32_bf16 v[76:79], v[16:19], v[176:179], v[76:79]
    ds_read_b64_tr_b16 v[16:17], v5 offset:16896
    v_mul_f32 v61, v61, v10
    v_mfma_f32_16x16x32_bf16 v[76:79], v[20:23], v[192:195], v[76:79]
    ds_read_b64_tr_b16 v[18:19], v5 offset:18944
    s_waitcnt lgkmcnt(6)
    v_mfma_f32_16x16x32_bf16 v[88:91], v[24:27], v[112:115], v[88:91]
    ds_read_b64_tr_b16 v[20:21], v5 offset:20992
    v_mul_f32 v62, v62, v10
    v_mfma_f32_16x16x32_bf16 v[88:91], v[28:31], v[144:147], v[88:91]
    ds_read_b64_tr_b16 v[22:23], v5 offset:23040
    v_mul_f32 v63, v63, v10
    v_mfma_f32_16x16x32_bf16 v[96:99], v[24:27], v[116:119], v[96:99]
    ds_read_b64_tr_b16 v[24:25], v5 offset:25088
    v_cvt_pk_bf16_f32 v218, v60, v61
    v_mfma_f32_16x16x32_bf16 v[96:99], v[28:31], v[148:151], v[96:99]
    ds_read_b64_tr_b16 v[26:27], v5 offset:27136
    s_waitcnt lgkmcnt(6)
    v_mfma_f32_16x16x32_bf16 v[96:99], v[32:35], v[180:183], v[96:99]
    ds_read_b64_tr_b16 v[28:29], v5 offset:29184
    v_cvt_pk_bf16_f32 v219, v62, v63
    v_mfma_f32_16x16x32_bf16 v[96:99], v[36:39], v[196:199], v[96:99]
    ds_read_b64_tr_b16 v[30:31], v5 offset:31232
    v_permlane16_swap_b32 v216, v218
    v_mfma_f32_16x16x32_bf16 v[88:91], v[32:35], v[176:179], v[88:91]
    ds_read_b64_tr_b16 v[32:33], v2 offset:33792
    v_permlane16_swap_b32 v217, v219
    v_mfma_f32_16x16x32_bf16 v[88:91], v[36:39], v[192:195], v[88:91]
    ds_read_b64_tr_b16 v[34:35], v2 offset:35840
    s_waitcnt lgkmcnt(6)
    v_mfma_f32_16x16x32_bf16 v[92:95], v[16:19], v[112:115], v[92:95]
    ds_read_b64_tr_b16 v[36:37], v2 offset:37888
    v_mul_f32 v64, v64, v11
    v_mfma_f32_16x16x32_bf16 v[92:95], v[20:23], v[144:147], v[92:95]
    ds_read_b64_tr_b16 v[38:39], v2 offset:39936
    v_mul_f32 v65, v65, v11
    v_mfma_f32_16x16x32_bf16 v[100:103], v[16:19], v[116:119], v[100:103]
    ds_read_b64_tr_b16 v[16:17], v2 offset:41984
    v_mul_f32 v66, v66, v11
    v_mfma_f32_16x16x32_bf16 v[100:103], v[20:23], v[148:151], v[100:103]
    ds_read_b64_tr_b16 v[18:19], v2 offset:44032
    s_waitcnt lgkmcnt(6)
    v_mfma_f32_16x16x32_bf16 v[100:103], v[24:27], v[180:183], v[100:103]
    ds_read_b64_tr_b16 v[20:21], v2 offset:46080
    v_mul_f32 v67, v67, v11
    v_mfma_f32_16x16x32_bf16 v[100:103], v[28:31], v[196:199], v[100:103]
    ds_read_b64_tr_b16 v[22:23], v2 offset:48128
    v_cvt_pk_bf16_f32 v220, v64, v65
    v_mfma_f32_16x16x32_bf16 v[92:95], v[24:27], v[176:179], v[92:95]
    ds_read_b64_tr_b16 v[24:25], v3 offset:33792
    v_cvt_pk_bf16_f32 v221, v66, v67
    v_mfma_f32_16x16x32_bf16 v[92:95], v[28:31], v[192:195], v[92:95]
    ds_read_b64_tr_b16 v[26:27], v3 offset:35840
    s_waitcnt lgkmcnt(6)
    v_mfma_f32_16x16x32_bf16 v[72:75], v[32:35], v[120:123], v[72:75]
    ds_read_b64_tr_b16 v[28:29], v3 offset:37888
    buffer_store_dwordx4 v[212:215], v6, s[24:27], s17 offen offset:0 sc0 sc1
    v_mfma_f32_16x16x32_bf16 v[72:75], v[36:39], v[152:155], v[72:75]
    ds_read_b64_tr_b16 v[30:31], v3 offset:39936
    v_mul_f32 v68, v68, v11
    v_mfma_f32_16x16x32_bf16 v[80:83], v[32:35], v[124:127], v[80:83]
    ds_read_b64_tr_b16 v[32:33], v3 offset:41984
    v_mul_f32 v69, v69, v11
    v_mfma_f32_16x16x32_bf16 v[80:83], v[36:39], v[156:159], v[80:83]
    ds_read_b64_tr_b16 v[34:35], v3 offset:44032
    s_waitcnt lgkmcnt(6)
    v_mfma_f32_16x16x32_bf16 v[80:83], v[16:19], v[244:247], v[80:83]
    ds_read_b64_tr_b16 v[36:37], v3 offset:46080
    v_mul_f32 v70, v70, v11
    v_mfma_f32_16x16x32_bf16 v[80:83], v[20:23], v[228:231], v[80:83]
    ds_read_b64_tr_b16 v[38:39], v3 offset:48128
    v_mul_f32 v71, v71, v11
    v_mfma_f32_16x16x32_bf16 v[72:75], v[16:19], v[240:243], v[72:75]
    ds_read_b64_tr_b16 v[16:17], v4 offset:33792
    v_cvt_pk_bf16_f32 v222, v68, v69
    v_mfma_f32_16x16x32_bf16 v[72:75], v[20:23], v[224:227], v[72:75]
    ds_read_b64_tr_b16 v[18:19], v4 offset:35840
    s_waitcnt lgkmcnt(6)
    v_mfma_f32_16x16x32_bf16 v[76:79], v[24:27], v[120:123], v[76:79]
    ds_read_b64_tr_b16 v[20:21], v4 offset:37888
    v_cvt_pk_bf16_f32 v223, v70, v71
    v_mfma_f32_16x16x32_bf16 v[76:79], v[28:31], v[152:155], v[76:79]
    ds_read_b64_tr_b16 v[22:23], v4 offset:39936
    v_permlane16_swap_b32 v220, v222
    v_mfma_f32_16x16x32_bf16 v[84:87], v[24:27], v[124:127], v[84:87]
    ds_read_b64_tr_b16 v[24:25], v4 offset:41984
    v_permlane16_swap_b32 v221, v223
    v_mfma_f32_16x16x32_bf16 v[84:87], v[28:31], v[156:159], v[84:87]
    ds_read_b64_tr_b16 v[26:27], v4 offset:44032
    s_waitcnt lgkmcnt(6)
    v_mfma_f32_16x16x32_bf16 v[84:87], v[32:35], v[244:247], v[84:87]
    ds_read_b64_tr_b16 v[28:29], v4 offset:46080
    v_mfma_f32_16x16x32_bf16 v[84:87], v[36:39], v[228:231], v[84:87]
    ds_read_b64_tr_b16 v[30:31], v4 offset:48128
    v_mfma_f32_16x16x32_bf16 v[76:79], v[32:35], v[240:243], v[76:79]
    ds_read_b64_tr_b16 v[32:33], v5 offset:33792
    v_mfma_f32_16x16x32_bf16 v[76:79], v[36:39], v[224:227], v[76:79]
    ds_read_b64_tr_b16 v[34:35], v5 offset:35840
    s_waitcnt lgkmcnt(6)
    v_mfma_f32_16x16x32_bf16 v[88:91], v[16:19], v[120:123], v[88:91]
    ds_read_b64_tr_b16 v[36:37], v5 offset:37888
    buffer_store_dwordx4 v[216:219], v6, s[24:27], s16 offen offset:64 sc0 sc1
    v_mfma_f32_16x16x32_bf16 v[88:91], v[20:23], v[152:155], v[88:91]
    ds_read_b64_tr_b16 v[38:39], v5 offset:39936
    v_mfma_f32_16x16x32_bf16 v[96:99], v[16:19], v[124:127], v[96:99]
    ds_read_b64_tr_b16 v[16:17], v5 offset:41984
    v_mfma_f32_16x16x32_bf16 v[96:99], v[20:23], v[156:159], v[96:99]
    ds_read_b64_tr_b16 v[18:19], v5 offset:44032
    s_waitcnt lgkmcnt(6)
    v_mfma_f32_16x16x32_bf16 v[96:99], v[24:27], v[244:247], v[96:99]
    ds_read_b64_tr_b16 v[20:21], v5 offset:46080
    v_mfma_f32_16x16x32_bf16 v[96:99], v[28:31], v[228:231], v[96:99]
    ds_read_b64_tr_b16 v[22:23], v5 offset:48128
    v_mfma_f32_16x16x32_bf16 v[88:91], v[24:27], v[240:243], v[88:91]
    s_barrier
    ds_read_b64_tr_b16 v[24:25], v2 offset:50688
    v_mfma_f32_16x16x32_bf16 v[88:91], v[28:31], v[224:227], v[88:91]
    ds_read_b64_tr_b16 v[26:27], v2 offset:52736
    s_waitcnt lgkmcnt(6)
    v_mfma_f32_16x16x32_bf16 v[92:95], v[32:35], v[120:123], v[92:95]
    ds_read_b64_tr_b16 v[28:29], v2 offset:54784
    v_mfma_f32_16x16x32_bf16 v[92:95], v[36:39], v[152:155], v[92:95]
    ds_read_b64_tr_b16 v[30:31], v2 offset:56832
    v_mfma_f32_16x16x32_bf16 v[100:103], v[32:35], v[124:127], v[100:103]
    ds_read_b64_tr_b16 v[32:33], v2 offset:58880
    v_mfma_f32_16x16x32_bf16 v[100:103], v[36:39], v[156:159], v[100:103]
    ds_read_b64_tr_b16 v[34:35], v2 offset:60928
    s_waitcnt lgkmcnt(6)
    v_mfma_f32_16x16x32_bf16 v[100:103], v[16:19], v[244:247], v[100:103]
    ds_read_b64_tr_b16 v[36:37], v2 offset:62976
    v_mfma_f32_16x16x32_bf16 v[100:103], v[20:23], v[228:231], v[100:103]
    ds_read_b64_tr_b16 v[38:39], v2 offset:65024
    v_mfma_f32_16x16x32_bf16 v[92:95], v[16:19], v[240:243], v[92:95]
    ds_read_b64_tr_b16 v[16:17], v3 offset:50688
    v_mfma_f32_16x16x32_bf16 v[92:95], v[20:23], v[224:227], v[92:95]
    ds_read_b64_tr_b16 v[18:19], v3 offset:52736
    s_waitcnt lgkmcnt(6)
    v_mfma_f32_16x16x32_bf16 v[72:75], v[24:27], v[128:131], v[72:75]
    ds_read_b64_tr_b16 v[20:21], v3 offset:54784
    v_mfma_f32_16x16x32_bf16 v[72:75], v[28:31], v[160:163], v[72:75]
    ds_read_b64_tr_b16 v[22:23], v3 offset:56832
    v_mfma_f32_16x16x32_bf16 v[80:83], v[24:27], v[132:135], v[80:83]
    ds_read_b64_tr_b16 v[24:25], v3 offset:58880
    v_mfma_f32_16x16x32_bf16 v[80:83], v[28:31], v[164:167], v[80:83]
    ds_read_b64_tr_b16 v[26:27], v3 offset:60928
    s_waitcnt lgkmcnt(6)
    v_mfma_f32_16x16x32_bf16 v[80:83], v[32:35], v[188:191], v[80:83]
    ds_read_b64_tr_b16 v[28:29], v3 offset:62976
    v_mfma_f32_16x16x32_bf16 v[80:83], v[36:39], v[204:207], v[80:83]
    ds_read_b64_tr_b16 v[30:31], v3 offset:65024
    v_mfma_f32_16x16x32_bf16 v[72:75], v[32:35], v[184:187], v[72:75]
    ds_read_b64_tr_b16 v[32:33], v4 offset:50688
    v_mfma_f32_16x16x32_bf16 v[72:75], v[36:39], v[200:203], v[72:75]
    ds_read_b64_tr_b16 v[34:35], v4 offset:52736
    s_waitcnt lgkmcnt(6)
    v_mfma_f32_16x16x32_bf16 v[76:79], v[16:19], v[128:131], v[76:79]
    ds_read_b64_tr_b16 v[36:37], v4 offset:54784
    v_mfma_f32_16x16x32_bf16 v[76:79], v[20:23], v[160:163], v[76:79]
    ds_read_b64_tr_b16 v[38:39], v4 offset:56832
    v_mfma_f32_16x16x32_bf16 v[84:87], v[16:19], v[132:135], v[84:87]
    ds_read_b64_tr_b16 v[16:17], v4 offset:58880
    v_mfma_f32_16x16x32_bf16 v[84:87], v[20:23], v[164:167], v[84:87]
    ds_read_b64_tr_b16 v[18:19], v4 offset:60928
    s_waitcnt lgkmcnt(6)
    v_mfma_f32_16x16x32_bf16 v[84:87], v[24:27], v[188:191], v[84:87]
    ds_read_b64_tr_b16 v[20:21], v4 offset:62976
    v_mfma_f32_16x16x32_bf16 v[84:87], v[28:31], v[204:207], v[84:87]
    ds_read_b64_tr_b16 v[22:23], v4 offset:65024
    v_mfma_f32_16x16x32_bf16 v[76:79], v[24:27], v[184:187], v[76:79]
    ds_read_b64_tr_b16 v[24:25], v5 offset:50688
    v_mfma_f32_16x16x32_bf16 v[76:79], v[28:31], v[200:203], v[76:79]
    ds_read_b64_tr_b16 v[26:27], v5 offset:52736
    s_waitcnt lgkmcnt(6)
    v_mfma_f32_16x16x32_bf16 v[88:91], v[32:35], v[128:131], v[88:91]
    ds_read_b64_tr_b16 v[28:29], v5 offset:54784
    buffer_store_dwordx4 v[220:223], v6, s[24:27], s17 offen offset:64 sc0 sc1
    v_mfma_f32_16x16x32_bf16 v[88:91], v[36:39], v[160:163], v[88:91]
    ds_read_b64_tr_b16 v[30:31], v5 offset:56832
    v_mul_f32 v72, v72, v10
    v_mfma_f32_16x16x32_bf16 v[96:99], v[32:35], v[132:135], v[96:99]
    ds_read_b64_tr_b16 v[32:33], v5 offset:58880
    v_mul_f32 v73, v73, v10
    v_mfma_f32_16x16x32_bf16 v[96:99], v[36:39], v[164:167], v[96:99]
    ds_read_b64_tr_b16 v[34:35], v5 offset:60928
    s_waitcnt lgkmcnt(6)
    v_mfma_f32_16x16x32_bf16 v[96:99], v[16:19], v[188:191], v[96:99]
    ds_read_b64_tr_b16 v[36:37], v5 offset:62976
    v_mul_f32 v74, v74, v10
    v_mfma_f32_16x16x32_bf16 v[96:99], v[20:23], v[204:207], v[96:99]
    ds_read_b64_tr_b16 v[38:39], v5 offset:65024
    v_mul_f32 v75, v75, v10
    v_mfma_f32_16x16x32_bf16 v[88:91], v[16:19], v[184:187], v[88:91]
    v_add_u32 v2, 67584, v2
    ds_read_b64_tr_b16 v[16:17], v2 offset:0
    v_mfma_f32_16x16x32_bf16 v[88:91], v[20:23], v[200:203], v[88:91]
    ds_read_b64_tr_b16 v[18:19], v2 offset:2048
    s_waitcnt lgkmcnt(6)
    v_mfma_f32_16x16x32_bf16 v[92:95], v[24:27], v[128:131], v[92:95]
    ds_read_b64_tr_b16 v[20:21], v2 offset:4096
    v_cvt_pk_bf16_f32 v72, v72, v73
    v_mfma_f32_16x16x32_bf16 v[92:95], v[28:31], v[160:163], v[92:95]
    ds_read_b64_tr_b16 v[22:23], v2 offset:6144
    v_cvt_pk_bf16_f32 v73, v74, v75
    v_mfma_f32_16x16x32_bf16 v[100:103], v[24:27], v[132:135], v[100:103]
    ds_read_b64_tr_b16 v[24:25], v2 offset:8192
    v_mul_f32 v76, v76, v10
    v_mfma_f32_16x16x32_bf16 v[100:103], v[28:31], v[164:167], v[100:103]
    ds_read_b64_tr_b16 v[26:27], v2 offset:10240
    s_waitcnt lgkmcnt(6)
    v_mfma_f32_16x16x32_bf16 v[100:103], v[32:35], v[188:191], v[100:103]
    ds_read_b64_tr_b16 v[28:29], v2 offset:12288
    v_mul_f32 v77, v77, v10
    v_mfma_f32_16x16x32_bf16 v[100:103], v[36:39], v[204:207], v[100:103]
    ds_read_b64_tr_b16 v[30:31], v2 offset:14336
    v_mul_f32 v78, v78, v10
    v_mfma_f32_16x16x32_bf16 v[92:95], v[32:35], v[184:187], v[92:95]
    v_add_u32 v3, 67584, v3
L_pad3:
    s_cbranch_execz L_back3
    ds_read_b64_tr_b16 v[32:33], v3 offset:0
    v_mfma_f32_16x16x32_bf16 v[92:95], v[36:39], v[200:203], v[92:95]
    ds_read_b64_tr_b16 v[34:35], v3 offset:2048
    s_waitcnt lgkmcnt(6)
    v_mfma_f32_16x16x32_bf16 v[40:43], v[16:19], v[104:107], 0
    ds_read_b64_tr_b16 v[36:37], v3 offset:4096
    v_mul_f32 v79, v79, v10
    v_mfma_f32_16x16x32_bf16 v[40:43], v[20:23], v[136:139], v[40:43]
    ds_read_b64_tr_b16 v[38:39], v3 offset:6144
    v_cvt_pk_bf16_f32 v74, v76, v77
    v_mfma_f32_16x16x32_bf16 v[48:51], v[16:19], v[108:111], 0
    ds_read_b64_tr_b16 v[16:17], v3 offset:8192
    v_cvt_pk_bf16_f32 v75, v78, v79
    v_mfma_f32_16x16x32_bf16 v[48:51], v[20:23], v[140:143], v[48:51]
    ds_read_b64_tr_b16 v[18:19], v3 offset:10240
    s_waitcnt lgkmcnt(6)
    v_mfma_f32_16x16x32_bf16 v[48:51], v[24:27], v[172:175], v[48:51]
    ds_read_b64_tr_b16 v[20:21], v3 offset:12288
    v_permlane16_swap_b32 v72, v74
    v_mfma_f32_16x16x32_bf16 v[48:51], v[28:31], v[252:255], v[48:51]
    ds_read_b64_tr_b16 v[22:23], v3 offset:14336
    v_permlane16_swap_b32 v73, v75
    v_mfma_f32_16x16x32_bf16 v[40:43], v[24:27], v[168:171], v[40:43]
    s_barrier
    v_subrev_u32 v2, 135168, v2
    ds_read_b64_tr_b16 v[24:25], v2 offset:0
    v_mfma_f32_16x16x32_bf16 v[40:43], v[28:31], v[248:251], v[40:43]
    ds_read_b64_tr_b16 v[26:27], v2 offset:2048
    s_waitcnt lgkmcnt(6)
    v_mfma_f32_16x16x32_bf16 v[44:47], v[32:35], v[104:107], 0
    ds_read_b64_tr_b16 v[28:29], v2 offset:4096
    v_mul_f32 v80, v80, v11
    v_mfma_f32_16x16x32_bf16 v[44:47], v[36:39], v[136:139], v[44:47]
    ds_read_b64_tr_b16 v[30:31], v2 offset:6144
    v_mul_f32 v81, v81, v11
    v_mfma_f32_16x16x32_bf16 v[52:55], v[32:35], v[108:111], 0
    ds_read_b64_tr_b16 v[32:33], v2 offset:8192
    v_mul_f32 v82, v82, v11
    v_mfma_f32_16x16x32_bf16 v[52:55], v[36:39], v[140:143], v[52:55]
    ds_read_b64_tr_b16 v[34:35], v2 offset:10240
    s_waitcnt lgkmcnt(6)
    v_mfma_f32_16x16x32_bf16 v[52:55], v[16:19], v[172:175], v[52:55]
    ds_read_b64_tr_b16 v[36:37], v2 offset:12288
    v_mul_f32 v83, v83, v11
    v_mfma_f32_16x16x32_bf16 v[52:55], v[20:23], v[252:255], v[52:55]
    ds_read_b64_tr_b16 v[38:39], v2 offset:14336
    v_cvt_pk_bf16_f32 v76, v80, v81
    v_mfma_f32_16x16x32_bf16 v[44:47], v[16:19], v[168:171], v[44:47]
    v_subrev_u32 v3, 135168, v3
    ds_read_b64_tr_b16 v[16:17], v3 offset:0
    v_mfma_f32_16x16x32_bf16 v[44:47], v[20:23], v[248:251], v[44:47]
    ds_read_b64_tr_b16 v[18:19], v3 offset:2048
    s_waitcnt lgkmcnt(6)
    v_mfma_f32_16x16x32_bf16 v[40:43], v[24:27], v[112:115], v[40:43]
    ds_read_b64_tr_b16 v[20:21], v3 offset:4096
    buffer_store_dwordx4 v[72:75], v6, s[24:27], s18 offen offset:0 sc0 sc1
    v_mfma_f32_16x16x32_bf16 v[40:43], v[28:31], v[144:147], v[40:43]
    ds_read_b64_tr_b16 v[22:23], v3 offset:6144
    v_cvt_pk_bf16_f32 v77, v82, v83
    v_mfma_f32_16x16x32_bf16 v[48:51], v[24:27], v[116:119], v[48:51]
    ds_read_b64_tr_b16 v[24:25], v3 offset:8192
    v_mul_f32 v84, v84, v11
    v_mfma_f32_16x16x32_bf16 v[48:51], v[28:31], v[148:151], v[48:51]
    ds_read_b64_tr_b16 v[26:27], v3 offset:10240
    s_waitcnt lgkmcnt(6)
    v_mfma_f32_16x16x32_bf16 v[48:51], v[32:35], v[180:183], v[48:51]
    ds_read_b64_tr_b16 v[28:29], v3 offset:12288
    v_mul_f32 v85, v85, v11
    v_mfma_f32_16x16x32_bf16 v[48:51], v[36:39], v[196:199], v[48:51]
    ds_read_b64_tr_b16 v[30:31], v3 offset:14336
    v_mul_f32 v86, v86, v11
    v_mfma_f32_16x16x32_bf16 v[40:43], v[32:35], v[176:179], v[40:43]
    ds_read_b64_tr_b16 v[32:33], v2 offset:16896
    v_mul_f32 v87, v87, v11
    v_mfma_f32_16x16x32_bf16 v[40:43], v[36:39], v[192:195], v[40:43]
    ds_read_b64_tr_b16 v[34:35], v2 offset:18944
    s_waitcnt lgkmcnt(6)
    v_mfma_f32_16x16x32_bf16 v[44:47], v[16:19], v[112:115], v[44:47]
    ds_read_b64_tr_b16 v[36:37], v2 offset:20992
    v_cvt_pk_bf16_f32 v78, v84, v85
    v_mfma_f32_16x16x32_bf16 v[44:47], v[20:23], v[144:147], v[44:47]
    ds_read_b64_tr_b16 v[38:39], v2 offset:23040
    v_cvt_pk_bf16_f32 v79, v86, v87
    v_mfma_f32_16x16x32_bf16 v[52:55], v[16:19], v[116:119], v[52:55]
    ds_read_b64_tr_b16 v[16:17], v2 offset:25088
    v_permlane16_swap_b32 v76, v78
    v_mfma_f32_16x16x32_bf16 v[52:55], v[20:23], v[148:151], v[52:55]
    ds_read_b64_tr_b16 v[18:19], v2 offset:27136
    s_waitcnt lgkmcnt(6)
    v_mfma_f32_16x16x32_bf16 v[52:55], v[24:27], v[180:183], v[52:55]
    ds_read_b64_tr_b16 v[20:21], v2 offset:29184
    v_permlane16_swap_b32 v77, v79
    v_mfma_f32_16x16x32_bf16 v[52:55], v[28:31], v[196:199], v[52:55]
    ds_read_b64_tr_b16 v[22:23], v2 offset:31232
    v_mul_f32 v88, v88, v10
    v_mfma_f32_16x16x32_bf16 v[44:47], v[24:27], v[176:179], v[44:47]
    ds_read_b64_tr_b16 v[24:25], v3 offset:16896
    v_mul_f32 v89, v89, v10
    v_mfma_f32_16x16x32_bf16 v[44:47], v[28:31], v[192:195], v[44:47]
    ds_read_b64_tr_b16 v[26:27], v3 offset:18944
    s_waitcnt lgkmcnt(6)
    v_mfma_f32_16x16x32_bf16 v[40:43], v[32:35], v[120:123], v[40:43]
    ds_read_b64_tr_b16 v[28:29], v3 offset:20992
    buffer_store_dwordx4 v[76:79], v6, s[24:27], s19 offen offset:0 sc0 sc1
    v_mfma_f32_16x16x32_bf16 v[40:43], v[36:39], v[152:155], v[40:43]
    ds_read_b64_tr_b16 v[30:31], v3 offset:23040
    v_mul_f32 v90, v90, v10
    v_mfma_f32_16x16x32_bf16 v[48:51], v[32:35], v[124:127], v[48:51]
    ds_read_b64_tr_b16 v[32:33], v3 offset:25088
    v_mul_f32 v91, v91, v10
    v_mfma_f32_16x16x32_bf16 v[48:51], v[36:39], v[156:159], v[48:51]
    ds_read_b64_tr_b16 v[34:35], v3 offset:27136
    s_waitcnt lgkmcnt(6)
    v_mfma_f32_16x16x32_bf16 v[48:51], v[16:19], v[244:247], v[48:51]
    ds_read_b64_tr_b16 v[36:37], v3 offset:29184
    v_cvt_pk_bf16_f32 v80, v88, v89
    v_mfma_f32_16x16x32_bf16 v[48:51], v[20:23], v[228:231], v[48:51]
    ds_read_b64_tr_b16 v[38:39], v3 offset:31232
    v_cvt_pk_bf16_f32 v81, v90, v91
    v_mfma_f32_16x16x32_bf16 v[40:43], v[16:19], v[240:243], v[40:43]
    s_barrier
    ds_read_b64_tr_b16 v[16:17], v2 offset:33792
    v_mfma_f32_16x16x32_bf16 v[40:43], v[20:23], v[224:227], v[40:43]
    ds_read_b64_tr_b16 v[18:19], v2 offset:35840
    s_waitcnt lgkmcnt(6)
    v_mfma_f32_16x16x32_bf16 v[44:47], v[24:27], v[120:123], v[44:47]
    ds_read_b64_tr_b16 v[20:21], v2 offset:37888
    v_mul_f32 v92, v92, v10
    v_mfma_f32_16x16x32_bf16 v[44:47], v[28:31], v[152:155], v[44:47]
    ds_read_b64_tr_b16 v[22:23], v2 offset:39936
    v_mul_f32 v93, v93, v10
    v_mfma_f32_16x16x32_bf16 v[52:55], v[24:27], v[124:127], v[52:55]
    ds_read_b64_tr_b16 v[24:25], v2 offset:41984
    v_mul_f32 v94, v94, v10
    v_mfma_f32_16x16x32_bf16 v[52:55], v[28:31], v[156:159], v[52:55]
    ds_read_b64_tr_b16 v[26:27], v2 offset:44032
    s_waitcnt lgkmcnt(6)
    v_mfma_f32_16x16x32_bf16 v[52:55], v[32:35], v[244:247], v[52:55]
    ds_read_b64_tr_b16 v[28:29], v2 offset:46080
    v_mul_f32 v95, v95, v10
    v_mfma_f32_16x16x32_bf16 v[52:55], v[36:39], v[228:231], v[52:55]
    ds_read_b64_tr_b16 v[30:31], v2 offset:48128
    v_cvt_pk_bf16_f32 v82, v92, v93
    v_mfma_f32_16x16x32_bf16 v[44:47], v[32:35], v[240:243], v[44:47]
    ds_read_b64_tr_b16 v[32:33], v3 offset:33792
    v_cvt_pk_bf16_f32 v83, v94, v95
    v_mfma_f32_16x16x32_bf16 v[44:47], v[36:39], v[224:227], v[44:47]
    ds_read_b64_tr_b16 v[34:35], v3 offset:35840
    s_waitcnt lgkmcnt(6)
    v_mfma_f32_16x16x32_bf16 v[40:43], v[16:19], v[128:131], v[40:43]
    ds_read_b64_tr_b16 v[36:37], v3 offset:37888
    v_permlane16_swap_b32 v80, v82
    v_mfma_f32_16x16x32_bf16 v[40:43], v[20:23], v[160:163], v[40:43]
    ds_read_b64_tr_b16 v[38:39], v3 offset:39936
    v_permlane16_swap_b32 v81, v83
    v_mfma_f32_16x16x32_bf16 v[48:51], v[16:19], v[132:135], v[48:51]
    ds_read_b64_tr_b16 v[16:17], v3 offset:41984
    buffer_store_dwordx4 v[80:83], v6, s[24:27], s18 offen offset:64 sc0 sc1
    v_mfma_f32_16x16x32_bf16 v[48:51], v[20:23], v[164:167], v[48:51]
    ds_read_b64_tr_b16 v[18:19], v3 offset:44032
    s_waitcnt lgkmcnt(6)
    v_mfma_f32_16x16x32_bf16 v[48:51], v[24:27], v[188:191], v[48:51]
    ds_read_b64_tr_b16 v[20:21], v3 offset:46080
    v_mul_f32 v96, v96, v11
    v_mfma_f32_16x16x32_bf16 v[48:51], v[28:31], v[204:207], v[48:51]
    ds_read_b64_tr_b16 v[22:23], v3 offset:48128
    v_mul_f32 v97, v97, v11
    v_mfma_f32_16x16x32_bf16 v[40:43], v[24:27], v[184:187], v[40:43]
    v_add_u32 v4, 67584, v4
    ds_read_b64_tr_b16 v[24:25], v4 offset:0
    v_mfma_f32_16x16x32_bf16 v[40:43], v[28:31], v[200:203], v[40:43]
    ds_read_b64_tr_b16 v[26:27], v4 offset:2048
    s_waitcnt lgkmcnt(6)
    v_mfma_f32_16x16x32_bf16 v[44:47], v[32:35], v[128:131], v[44:47]
    ds_read_b64_tr_b16 v[28:29], v4 offset:4096
    v_mul_f32 v98, v98, v11
    v_mfma_f32_16x16x32_bf16 v[44:47], v[36:39], v[160:163], v[44:47]
    ds_read_b64_tr_b16 v[30:31], v4 offset:6144
    v_mul_f32 v99, v99, v11
    v_mfma_f32_16x16x32_bf16 v[52:55], v[32:35], v[132:135], v[52:55]
    ds_read_b64_tr_b16 v[32:33], v4 offset:8192
    v_cvt_pk_bf16_f32 v84, v96, v97
    v_mfma_f32_16x16x32_bf16 v[52:55], v[36:39], v[164:167], v[52:55]
    ds_read_b64_tr_b16 v[34:35], v4 offset:10240
    s_waitcnt lgkmcnt(6)
    v_mfma_f32_16x16x32_bf16 v[52:55], v[16:19], v[188:191], v[52:55]
    ds_read_b64_tr_b16 v[36:37], v4 offset:12288
    v_cvt_pk_bf16_f32 v85, v98, v99
    v_mfma_f32_16x16x32_bf16 v[52:55], v[20:23], v[204:207], v[52:55]
    ds_read_b64_tr_b16 v[38:39], v4 offset:14336
    v_mul_f32 v100, v100, v11
    v_mfma_f32_16x16x32_bf16 v[44:47], v[16:19], v[184:187], v[44:47]
    v_add_u32 v5, 67584, v5
    ds_read_b64_tr_b16 v[16:17], v5 offset:0
    v_mfma_f32_16x16x32_bf16 v[44:47], v[20:23], v[200:203], v[44:47]
    ds_read_b64_tr_b16 v[18:19], v5 offset:2048
    s_waitcnt lgkmcnt(6)
    v_mfma_f32_16x16x32_bf16 v[56:59], v[24:27], v[104:107], 0
    ds_read_b64_tr_b16 v[20:21], v5 offset:4096
    v_mul_f32 v101, v101, v11
    v_mfma_f32_16x16x32_bf16 v[56:59], v[28:31], v[136:139], v[56:59]
    ds_read_b64_tr_b16 v[22:23], v5 offset:6144
    v_mul_f32 v102, v102, v11
    v_mfma_f32_16x16x32_bf16 v[64:67], v[24:27], v[108:111], 0
    ds_read_b64_tr_b16 v[24:25], v5 offset:8192
    v_mul_f32 v103, v103, v11
    v_mfma_f32_16x16x32_bf16 v[64:67], v[28:31], v[140:143], v[64:67]
    ds_read_b64_tr_b16 v[26:27], v5 offset:10240
    s_waitcnt lgkmcnt(6)
    v_mfma_f32_16x16x32_bf16 v[64:67], v[32:35], v[172:175], v[64:67]
    ds_read_b64_tr_b16 v[28:29], v5 offset:12288
    v_cvt_pk_bf16_f32 v86, v100, v101
    v_mfma_f32_16x16x32_bf16 v[64:67], v[36:39], v[252:255], v[64:67]
    ds_read_b64_tr_b16 v[30:31], v5 offset:14336
    v_cvt_pk_bf16_f32 v87, v102, v103
    v_mfma_f32_16x16x32_bf16 v[56:59], v[32:35], v[168:171], v[56:59]
    v_subrev_u32 v4, 135168, v4
    ds_read_b64_tr_b16 v[32:33], v4 offset:0
    v_mfma_f32_16x16x32_bf16 v[56:59], v[36:39], v[248:251], v[56:59]
    ds_read_b64_tr_b16 v[34:35], v4 offset:2048
    s_waitcnt lgkmcnt(6)
    v_mfma_f32_16x16x32_bf16 v[60:63], v[16:19], v[104:107], 0
    ds_read_b64_tr_b16 v[36:37], v4 offset:4096
    v_permlane16_swap_b32 v84, v86
    v_mfma_f32_16x16x32_bf16 v[60:63], v[20:23], v[136:139], v[60:63]
    ds_read_b64_tr_b16 v[38:39], v4 offset:6144
    v_permlane16_swap_b32 v85, v87
    v_mfma_f32_16x16x32_bf16 v[68:71], v[16:19], v[108:111], 0
    ds_read_b64_tr_b16 v[16:17], v4 offset:8192
    buffer_store_dwordx4 v[84:87], v6, s[24:27], s19 offen offset:64 sc0 sc1
    v_mfma_f32_16x16x32_bf16 v[68:71], v[20:23], v[140:143], v[68:71]
    ds_read_b64_tr_b16 v[18:19], v4 offset:10240
    s_waitcnt lgkmcnt(6)
    v_mfma_f32_16x16x32_bf16 v[68:71], v[24:27], v[172:175], v[68:71]
    ds_read_b64_tr_b16 v[20:21], v4 offset:12288
    v_mul_f32 v40, v40, v10
    v_mfma_f32_16x16x32_bf16 v[68:71], v[28:31], v[252:255], v[68:71]
    ds_read_b64_tr_b16 v[22:23], v4 offset:14336
    v_mul_f32 v41, v41, v10
    v_mfma_f32_16x16x32_bf16 v[60:63], v[24:27], v[168:171], v[60:63]
    v_subrev_u32 v5, 135168, v5
    ds_read_b64_tr_b16 v[24:25], v5 offset:0
    v_mfma_f32_16x16x32_bf16 v[60:63], v[28:31], v[248:251], v[60:63]
    ds_read_b64_tr_b16 v[26:27], v5 offset:2048
    s_waitcnt lgkmcnt(6)
    v_mfma_f32_16x16x32_bf16 v[56:59], v[32:35], v[112:115], v[56:59]
    ds_read_b64_tr_b16 v[28:29], v5 offset:4096
    v_mul_f32 v42, v42, v10
    v_mfma_f32_16x16x32_bf16 v[56:59], v[36:39], v[144:147], v[56:59]
    ds_read_b64_tr_b16 v[30:31], v5 offset:6144
    v_mul_f32 v43, v43, v10
    v_mfma_f32_16x16x32_bf16 v[64:67], v[32:35], v[116:119], v[64:67]
    ds_read_b64_tr_b16 v[32:33], v5 offset:8192
    v_cvt_pk_bf16_f32 v208, v40, v41
    v_mfma_f32_16x16x32_bf16 v[64:67], v[36:39], v[148:151], v[64:67]
    ds_read_b64_tr_b16 v[34:35], v5 offset:10240
    s_waitcnt lgkmcnt(6)
    v_mfma_f32_16x16x32_bf16 v[64:67], v[16:19], v[180:183], v[64:67]
    ds_read_b64_tr_b16 v[36:37], v5 offset:12288
    v_cvt_pk_bf16_f32 v209, v42, v43
    v_mfma_f32_16x16x32_bf16 v[64:67], v[20:23], v[196:199], v[64:67]
    ds_read_b64_tr_b16 v[38:39], v5 offset:14336
    v_mul_f32 v44, v44, v10
    v_mfma_f32_16x16x32_bf16 v[56:59], v[16:19], v[176:179], v[56:59]
    ds_read_b64_tr_b16 v[16:17], v4 offset:16896
    v_mul_f32 v45, v45, v10
    v_mfma_f32_16x16x32_bf16 v[56:59], v[20:23], v[192:195], v[56:59]
    ds_read_b64_tr_b16 v[18:19], v4 offset:18944
    s_waitcnt lgkmcnt(6)
    v_mfma_f32_16x16x32_bf16 v[60:63], v[24:27], v[112:115], v[60:63]
    ds_read_b64_tr_b16 v[20:21], v4 offset:20992
    v_mul_f32 v46, v46, v10
    v_mfma_f32_16x16x32_bf16 v[60:63], v[28:31], v[144:147], v[60:63]
    ds_read_b64_tr_b16 v[22:23], v4 offset:23040
    v_mul_f32 v47, v47, v10
    v_mfma_f32_16x16x32_bf16 v[68:71], v[24:27], v[116:119], v[68:71]
    ds_read_b64_tr_b16 v[24:25], v4 offset:25088
    v_cvt_pk_bf16_f32 v210, v44, v45
    v_mfma_f32_16x16x32_bf16 v[68:71], v[28:31], v[148:151], v[68:71]
    ds_read_b64_tr_b16 v[26:27], v4 offset:27136
    s_waitcnt lgkmcnt(6)
    v_mfma_f32_16x16x32_bf16 v[68:71], v[32:35], v[180:183], v[68:71]
    ds_read_b64_tr_b16 v[28:29], v4 offset:29184
    v_cvt_pk_bf16_f32 v211, v46, v47
    v_mfma_f32_16x16x32_bf16 v[68:71], v[36:39], v[196:199], v[68:71]
    ds_read_b64_tr_b16 v[30:31], v4 offset:31232
    v_permlane16_swap_b32 v208, v210
    v_mfma_f32_16x16x32_bf16 v[60:63], v[32:35], v[176:179], v[60:63]
    ds_read_b64_tr_b16 v[32:33], v5 offset:16896
    v_permlane16_swap_b32 v209, v211
    v_mfma_f32_16x16x32_bf16 v[60:63], v[36:39], v[192:195], v[60:63]
    ds_read_b64_tr_b16 v[34:35], v5 offset:18944
    s_waitcnt lgkmcnt(6)
    v_mfma_f32_16x16x32_bf16 v[56:59], v[16:19], v[120:123], v[56:59]
    ds_read_b64_tr_b16 v[36:37], v5 offset:20992
    buffer_store_dwordx4 v[208:211], v6, s[24:27], s20 offen offset:0 sc0 sc1
    v_mfma_f32_16x16x32_bf16 v[56:59], v[20:23], v[152:155], v[56:59]
    ds_read_b64_tr_b16 v[38:39], v5 offset:23040
    v_mul_f32 v48, v48, v11
    v_mfma_f32_16x16x32_bf16 v[64:67], v[16:19], v[124:127], v[64:67]
    ds_read_b64_tr_b16 v[16:17], v5 offset:25088
    v_mul_f32 v49, v49, v11
    v_mfma_f32_16x16x32_bf16 v[64:67], v[20:23], v[156:159], v[64:67]
    ds_read_b64_tr_b16 v[18:19], v5 offset:27136
    s_waitcnt lgkmcnt(6)
    v_mfma_f32_16x16x32_bf16 v[64:67], v[24:27], v[244:247], v[64:67]
    ds_read_b64_tr_b16 v[20:21], v5 offset:29184
    v_mul_f32 v50, v50, v11
    v_mfma_f32_16x16x32_bf16 v[64:67], v[28:31], v[228:231], v[64:67]
    ds_read_b64_tr_b16 v[22:23], v5 offset:31232
    v_mul_f32 v51, v51, v11
    v_mfma_f32_16x16x32_bf16 v[56:59], v[24:27], v[240:243], v[56:59]
    ds_read_b64_tr_b16 v[24:25], v4 offset:33792
    v_cvt_pk_bf16_f32 v212, v48, v49
    v_mfma_f32_16x16x32_bf16 v[56:59], v[28:31], v[224:227], v[56:59]
    ds_read_b64_tr_b16 v[26:27], v4 offset:35840
    s_waitcnt lgkmcnt(6)
    v_mfma_f32_16x16x32_bf16 v[60:63], v[32:35], v[120:123], v[60:63]
    ds_read_b64_tr_b16 v[28:29], v4 offset:37888
    v_cvt_pk_bf16_f32 v213, v50, v51
    v_mfma_f32_16x16x32_bf16 v[60:63], v[36:39], v[152:155], v[60:63]
    ds_read_b64_tr_b16 v[30:31], v4 offset:39936
    v_mul_f32 v52, v52, v11
    v_mfma_f32_16x16x32_bf16 v[68:71], v[32:35], v[124:127], v[68:71]
    ds_read_b64_tr_b16 v[32:33], v4 offset:41984
    v_mul_f32 v53, v53, v11
    v_mfma_f32_16x16x32_bf16 v[68:71], v[36:39], v[156:159], v[68:71]
    ds_read_b64_tr_b16 v[34:35], v4 offset:44032
    s_waitcnt lgkmcnt(6)
    v_mfma_f32_16x16x32_bf16 v[68:71], v[16:19], v[244:247], v[68:71]
    ds_read_b64_tr_b16 v[36:37], v4 offset:46080
    v_mul_f32 v54, v54, v11
    v_mfma_f32_16x16x32_bf16 v[68:71], v[20:23], v[228:231], v[68:71]
    ds_read_b64_tr_b16 v[38:39], v4 offset:48128
    v_mul_f32 v55, v55, v11
    v_mfma_f32_16x16x32_bf16 v[60:63], v[16:19], v[240:243], v[60:63]
    ds_read_b64_tr_b16 v[16:17], v5 offset:33792
    v_cvt_pk_bf16_f32 v214, v52, v53
    v_mfma_f32_16x16x32_bf16 v[60:63], v[20:23], v[224:227], v[60:63]
    ds_read_b64_tr_b16 v[18:19], v5 offset:35840
    s_waitcnt lgkmcnt(6)
    v_mfma_f32_16x16x32_bf16 v[56:59], v[24:27], v[128:131], v[56:59]
    ds_read_b64_tr_b16 v[20:21], v5 offset:37888
    v_cvt_pk_bf16_f32 v215, v54, v55
    v_mfma_f32_16x16x32_bf16 v[56:59], v[28:31], v[160:163], v[56:59]
    ds_read_b64_tr_b16 v[22:23], v5 offset:39936
    v_permlane16_swap_b32 v212, v214
    v_mfma_f32_16x16x32_bf16 v[64:67], v[24:27], v[132:135], v[64:67]
    ds_read_b64_tr_b16 v[24:25], v5 offset:41984
    v_permlane16_swap_b32 v213, v215
    v_mfma_f32_16x16x32_bf16 v[64:67], v[28:31], v[164:167], v[64:67]
    ds_read_b64_tr_b16 v[26:27], v5 offset:44032
    s_waitcnt lgkmcnt(6)
    v_mfma_f32_16x16x32_bf16 v[64:67], v[32:35], v[188:191], v[64:67]
    ds_read_b64_tr_b16 v[28:29], v5 offset:46080
    buffer_store_dwordx4 v[212:215], v6, s[24:27], s21 offen offset:0 sc0 sc1
    v_mfma_f32_16x16x32_bf16 v[64:67], v[36:39], v[204:207], v[64:67]
    ds_read_b64_tr_b16 v[30:31], v5 offset:48128
    v_mfma_f32_16x16x32_bf16 v[56:59], v[32:35], v[184:187], v[56:59]
    s_barrier
    ds_read_b64_tr_b16 v[32:33], v2 offset:50688
    v_mfma_f32_16x16x32_bf16 v[56:59], v[36:39], v[200:203], v[56:59]
    ds_read_b64_tr_b16 v[34:35], v2 offset:52736
    s_waitcnt lgkmcnt(6)
    v_mfma_f32_16x16x32_bf16 v[60:63], v[16:19], v[128:131], v[60:63]
    ds_read_b64_tr_b16 v[36:37], v2 offset:54784
    v_mfma_f32_16x16x32_bf16 v[60:63], v[20:23], v[160:163], v[60:63]
    ds_read_b64_tr_b16 v[38:39], v2 offset:56832
    v_mfma_f32_16x16x32_bf16 v[68:71], v[16:19], v[132:135], v[68:71]
    ds_read_b64_tr_b16 v[16:17], v2 offset:58880
    v_mfma_f32_16x16x32_bf16 v[68:71], v[20:23], v[164:167], v[68:71]
    ds_read_b64_tr_b16 v[18:19], v2 offset:60928
    s_waitcnt lgkmcnt(6)
    v_mfma_f32_16x16x32_bf16 v[68:71], v[24:27], v[188:191], v[68:71]
    ds_read_b64_tr_b16 v[20:21], v2 offset:62976
    v_mfma_f32_16x16x32_bf16 v[68:71], v[28:31], v[204:207], v[68:71]
    ds_read_b64_tr_b16 v[22:23], v2 offset:65024
    v_mfma_f32_16x16x32_bf16 v[60:63], v[24:27], v[184:187], v[60:63]
    ds_read_b64_tr_b16 v[24:25], v3 offset:50688
    v_mfma_f32_16x16x32_bf16 v[60:63], v[28:31], v[200:203], v[60:63]
    ds_read_b64_tr_b16 v[26:27], v3 offset:52736
    s_nop 1
    s_waitcnt lgkmcnt(6)
    v_mfma_f32_16x16x32_bf16 v[72:75], v[32:35], v[104:107], 0
    ds_read_b64_tr_b16 v[28:29], v3 offset:54784
    v_mul_f32 v56, v56, v10
    v_mfma_f32_16x16x32_bf16 v[72:75], v[36:39], v[136:139], v[72:75]
    ds_read_b64_tr_b16 v[30:31], v3 offset:56832
    v_mul_f32 v57, v57, v10
    v_mfma_f32_16x16x32_bf16 v[80:83], v[32:35], v[108:111], 0
    ds_read_b64_tr_b16 v[32:33], v3 offset:58880
    v_mul_f32 v58, v58, v10
    v_mfma_f32_16x16x32_bf16 v[80:83], v[36:39], v[140:143], v[80:83]
    ds_read_b64_tr_b16 v[34:35], v3 offset:60928
    s_waitcnt lgkmcnt(6)
    v_mfma_f32_16x16x32_bf16 v[80:83], v[16:19], v[172:175], v[80:83]
    ds_read_b64_tr_b16 v[36:37], v3 offset:62976
    v_mul_f32 v59, v59, v10
    v_mfma_f32_16x16x32_bf16 v[80:83], v[20:23], v[252:255], v[80:83]
    ds_read_b64_tr_b16 v[38:39], v3 offset:65024
    v_cvt_pk_bf16_f32 v216, v56, v57
    v_mfma_f32_16x16x32_bf16 v[72:75], v[16:19], v[168:171], v[72:75]
    v_add_u32 v2, 67584, v2
    ds_read_b64_tr_b16 v[16:17], v2 offset:0
    v_mfma_f32_16x16x32_bf16 v[72:75], v[20:23], v[248:251], v[72:75]
    ds_read_b64_tr_b16 v[18:19], v2 offset:2048
    s_waitcnt lgkmcnt(6)
    v_mfma_f32_16x16x32_bf16 v[76:79], v[24:27], v[104:107], 0
    ds_read_b64_tr_b16 v[20:21], v2 offset:4096
    v_cvt_pk_bf16_f32 v217, v58, v59
    v_mfma_f32_16x16x32_bf16 v[76:79], v[28:31], v[136:139], v[76:79]
    ds_read_b64_tr_b16 v[22:23], v2 offset:6144
    v_mul_f32 v60, v60, v10
    v_mfma_f32_16x16x32_bf16 v[84:87], v[24:27], v[108:111], 0
    ds_read_b64_tr_b16 v[24:25], v2 offset:8192
    v_mul_f32 v61, v61, v10
    v_mfma_f32_16x16x32_bf16 v[84:87], v[28:31], v[140:143], v[84:87]
    ds_read_b64_tr_b16 v[26:27], v2 offset:10240
    s_waitcnt lgkmcnt(6)
    v_mfma_f32_16x16x32_bf16 v[84:87], v[32:35], v[172:175], v[84:87]
    ds_read_b64_tr_b16 v[28:29], v2 offset:12288
    v_mul_f32 v62, v62, v10
    v_mfma_f32_16x16x32_bf16 v[84:87], v[36:39], v[252:255], v[84:87]
    ds_read_b64_tr_b16 v[30:31], v2 offset:14336
    v_mul_f32 v63, v63, v10
    v_mfma_f32_16x16x32_bf16 v[76:79], v[32:35], v[168:171], v[76:79]
    v_add_u32 v3, 67584, v3
    ds_read_b64_tr_b16 v[32:33], v3 offset:0
    v_mfma_f32_16x16x32_bf16 v[76:79], v[36:39], v[248:251], v[76:79]
    ds_read_b64_tr_b16 v[34:35], v3 offset:2048
    s_waitcnt lgkmcnt(6)
    v_mfma_f32_16x16x32_bf16 v[72:75], v[16:19], v[112:115], v[72:75]
    ds_read_b64_tr_b16 v[36:37], v3 offset:4096
    v_cvt_pk_bf16_f32 v218, v60, v61
    v_mfma_f32_16x16x32_bf16 v[72:75], v[20:23], v[144:147], v[72:75]
    ds_read_b64_tr_b16 v[38:39], v3 offset:6144
    v_cvt_pk_bf16_f32 v219, v62, v63
    v_mfma_f32_16x16x32_bf16 v[80:83], v[16:19], v[116:119], v[80:83]
    ds_read_b64_tr_b16 v[16:17], v3 offset:8192
    v_permlane16_swap_b32 v216, v218
    v_mfma_f32_16x16x32_bf16 v[80:83], v[20:23], v[148:151], v[80:83]
    ds_read_b64_tr_b16 v[18:19], v3 offset:10240
    s_waitcnt lgkmcnt(6)
    v_mfma_f32_16x16x32_bf16 v[80:83], v[24:27], v[180:183], v[80:83]
    ds_read_b64_tr_b16 v[20:21], v3 offset:12288
    v_permlane16_swap_b32 v217, v219
    v_mfma_f32_16x16x32_bf16 v[80:83], v[28:31], v[196:199], v[80:83]
    ds_read_b64_tr_b16 v[22:23], v3 offset:14336
    buffer_store_dwordx4 v[216:219], v6, s[24:27], s20 offen offset:64 sc0 sc1
    v_mfma_f32_16x16x32_bf16 v[72:75], v[24:27], v[176:179], v[72:75]
    ds_read_b64_tr_b16 v[24:25], v2 offset:16896
    v_mul_f32 v64, v64, v11
    v_mfma_f32_16x16x32_bf16 v[72:75], v[28:31], v[192:195], v[72:75]
    ds_read_b64_tr_b16 v[26:27], v2 offset:18944
    s_waitcnt lgkmcnt(6)
    v_mfma_f32_16x16x32_bf16 v[76:79], v[32:35], v[112:115], v[76:79]
    ds_read_b64_tr_b16 v[28:29], v2 offset:20992
    v_mul_f32 v65, v65, v11
    v_mfma_f32_16x16x32_bf16 v[76:79], v[36:39], v[144:147], v[76:79]
    ds_read_b64_tr_b16 v[30:31], v2 offset:23040
    v_mul_f32 v66, v66, v11
    v_mfma_f32_16x16x32_bf16 v[84:87], v[32:35], v[116:119], v[84:87]
    ds_read_b64_tr_b16 v[32:33], v2 offset:25088
    v_mul_f32 v67, v67, v11
    v_mfma_f32_16x16x32_bf16 v[84:87], v[36:39], v[148:151], v[84:87]
    ds_read_b64_tr_b16 v[34:35], v2 offset:27136
    s_waitcnt lgkmcnt(6)
    v_mfma_f32_16x16x32_bf16 v[84:87], v[16:19], v[180:183], v[84:87]
    ds_read_b64_tr_b16 v[36:37], v2 offset:29184
    v_cvt_pk_bf16_f32 v220, v64, v65
    v_mfma_f32_16x16x32_bf16 v[84:87], v[20:23], v[196:199], v[84:87]
    ds_read_b64_tr_b16 v[38:39], v2 offset:31232
    v_cvt_pk_bf16_f32 v221, v66, v67
    v_mfma_f32_16x16x32_bf16 v[76:79], v[16:19], v[176:179], v[76:79]
    ds_read_b64_tr_b16 v[16:17], v3 offset:16896
    v_mul_f32 v68, v68, v11
    v_mfma_f32_16x16x32_bf16 v[76:79], v[20:23], v[192:195], v[76:79]
    ds_read_b64_tr_b16 v[18:19], v3 offset:18944
    s_waitcnt lgkmcnt(6)
    v_mfma_f32_16x16x32_bf16 v[72:75], v[24:27], v[120:123], v[72:75]
    ds_read_b64_tr_b16 v[20:21], v3 offset:20992
    v_mul_f32 v69, v69, v11
    v_mfma_f32_16x16x32_bf16 v[72:75], v[28:31], v[152:155], v[72:75]
    ds_read_b64_tr_b16 v[22:23], v3 offset:23040
    v_mul_f32 v70, v70, v11
    v_mfma_f32_16x16x32_bf16 v[80:83], v[24:27], v[124:127], v[80:83]
    ds_read_b64_tr_b16 v[24:25], v3 offset:25088
    v_mul_f32 v71, v71, v11
    v_mfma_f32_16x16x32_bf16 v[80:83], v[28:31], v[156:159], v[80:83]
    ds_read_b64_tr_b16 v[26:27], v3 offset:27136
    s_waitcnt lgkmcnt(6)
    v_mfma_f32_16x16x32_bf16 v[80:83], v[32:35], v[244:247], v[80:83]
    ds_read_b64_tr_b16 v[28:29], v3 offset:29184
    v_cvt_pk_bf16_f32 v222, v68, v69
    v_mfma_f32_16x16x32_bf16 v[80:83], v[36:39], v[228:231], v[80:83]
    ds_read_b64_tr_b16 v[30:31], v3 offset:31232
    v_cvt_pk_bf16_f32 v223, v70, v71
    v_mfma_f32_16x16x32_bf16 v[72:75], v[32:35], v[240:243], v[72:75]
    ds_read_b64_tr_b16 v[32:33], v2 offset:33792
    v_permlane16_swap_b32 v220, v222
    v_mfma_f32_16x16x32_bf16 v[72:75], v[36:39], v[224:227], v[72:75]
    ds_read_b64_tr_b16 v[34:35], v2 offset:35840
    s_waitcnt lgkmcnt(6)
    v_mfma_f32_16x16x32_bf16 v[76:79], v[16:19], v[120:123], v[76:79]
    ds_read_b64_tr_b16 v[36:37], v2 offset:37888
    v_permlane16_swap_b32 v221, v223
    v_mfma_f32_16x16x32_bf16 v[76:79], v[20:23], v[152:155], v[76:79]
    ds_read_b64_tr_b16 v[38:39], v2 offset:39936
    buffer_store_dwordx4 v[220:223], v6, s[24:27], s21 offen offset:64 sc0 sc1
    v_mfma_f32_16x16x32_bf16 v[84:87], v[16:19], v[124:127], v[84:87]
    ds_read_b64_tr_b16 v[16:17], v2 offset:41984
    v_mfma_f32_16x16x32_bf16 v[84:87], v[20:23], v[156:159], v[84:87]
    ds_read_b64_tr_b16 v[18:19], v2 offset:44032
    s_waitcnt lgkmcnt(6)
    v_mfma_f32_16x16x32_bf16 v[84:87], v[24:27], v[244:247], v[84:87]
    ds_read_b64_tr_b16 v[20:21], v2 offset:46080
    v_mfma_f32_16x16x32_bf16 v[84:87], v[28:31], v[228:231], v[84:87]
    ds_read_b64_tr_b16 v[22:23], v2 offset:48128
    v_mfma_f32_16x16x32_bf16 v[76:79], v[24:27], v[240:243], v[76:79]
    ds_read_b64_tr_b16 v[24:25], v3 offset:33792
    v_mfma_f32_16x16x32_bf16 v[76:79], v[28:31], v[224:227], v[76:79]
    ds_read_b64_tr_b16 v[26:27], v3 offset:35840
    s_waitcnt lgkmcnt(6)
    v_mfma_f32_16x16x32_bf16 v[72:75], v[32:35], v[128:131], v[72:75]
    ds_read_b64_tr_b16 v[28:29], v3 offset:37888
    v_mfma_f32_16x16x32_bf16 v[72:75], v[36:39], v[160:163], v[72:75]
    ds_read_b64_tr_b16 v[30:31], v3 offset:39936
    v_mfma_f32_16x16x32_bf16 v[80:83], v[32:35], v[132:135], v[80:83]
    ds_read_b64_tr_b16 v[32:33], v3 offset:41984
    v_mfma_f32_16x16x32_bf16 v[80:83], v[36:39], v[164:167], v[80:83]
    ds_read_b64_tr_b16 v[34:35], v3 offset:44032
    s_waitcnt lgkmcnt(6)
    v_mfma_f32_16x16x32_bf16 v[80:83], v[16:19], v[188:191], v[80:83]
    ds_read_b64_tr_b16 v[36:37], v3 offset:46080
    v_mfma_f32_16x16x32_bf16 v[80:83], v[20:23], v[204:207], v[80:83]
    ds_read_b64_tr_b16 v[38:39], v3 offset:48128
    v_mfma_f32_16x16x32_bf16 v[72:75], v[16:19], v[184:187], v[72:75]
    ds_read_b64_tr_b16 v[16:17], v4 offset:50688
    v_mfma_f32_16x16x32_bf16 v[72:75], v[20:23], v[200:203], v[72:75]
    ds_read_b64_tr_b16 v[18:19], v4 offset:52736
    s_waitcnt lgkmcnt(6)
    v_mfma_f32_16x16x32_bf16 v[76:79], v[24:27], v[128:131], v[76:79]
    ds_read_b64_tr_b16 v[20:21], v4 offset:54784
    v_mfma_f32_16x16x32_bf16 v[76:79], v[28:31], v[160:163], v[76:79]
    ds_read_b64_tr_b16 v[22:23], v4 offset:56832
    v_mfma_f32_16x16x32_bf16 v[84:87], v[24:27], v[132:135], v[84:87]
    ds_read_b64_tr_b16 v[24:25], v4 offset:58880
    v_mfma_f32_16x16x32_bf16 v[84:87], v[28:31], v[164:167], v[84:87]
    ds_read_b64_tr_b16 v[26:27], v4 offset:60928
    s_waitcnt lgkmcnt(6)
    v_mfma_f32_16x16x32_bf16 v[84:87], v[32:35], v[188:191], v[84:87]
    ds_read_b64_tr_b16 v[28:29], v4 offset:62976
    v_mfma_f32_16x16x32_bf16 v[84:87], v[36:39], v[204:207], v[84:87]
    ds_read_b64_tr_b16 v[30:31], v4 offset:65024
    v_mfma_f32_16x16x32_bf16 v[76:79], v[32:35], v[184:187], v[76:79]
    ds_read_b64_tr_b16 v[32:33], v5 offset:50688
    v_mfma_f32_16x16x32_bf16 v[76:79], v[36:39], v[200:203], v[76:79]
    ds_read_b64_tr_b16 v[34:35], v5 offset:52736
    s_waitcnt lgkmcnt(6)
    v_mfma_f32_16x16x32_bf16 v[88:91], v[16:19], v[104:107], 0
    ds_read_b64_tr_b16 v[36:37], v5 offset:54784
    v_mul_f32 v72, v72, v10
    v_mfma_f32_16x16x32_bf16 v[88:91], v[20:23], v[136:139], v[88:91]
    ds_read_b64_tr_b16 v[38:39], v5 offset:56832
    v_mul_f32 v73, v73, v10
    v_mfma_f32_16x16x32_bf16 v[96:99], v[16:19], v[108:111], 0
    ds_read_b64_tr_b16 v[16:17], v5 offset:58880
    v_mul_f32 v74, v74, v10
    v_mfma_f32_16x16x32_bf16 v[96:99], v[20:23], v[140:143], v[96:99]
    ds_read_b64_tr_b16 v[18:19], v5 offset:60928
    s_waitcnt lgkmcnt(6)
    v_mfma_f32_16x16x32_bf16 v[96:99], v[24:27], v[172:175], v[96:99]
    ds_read_b64_tr_b16 v[20:21], v5 offset:62976
    v_mul_f32 v75, v75, v10
    v_mfma_f32_16x16x32_bf16 v[96:99], v[28:31], v[252:255], v[96:99]
    ds_read_b64_tr_b16 v[22:23], v5 offset:65024
    v_cvt_pk_bf16_f32 v72, v72, v73
L_pad4:
    s_cbranch_execz L_back4
    v_mfma_f32_16x16x32_bf16 v[88:91], v[24:27], v[168:171], v[88:91]
    v_add_u32 v4, 67584, v4
    ds_read_b64_tr_b16 v[24:25], v4 offset:0
    v_mfma_f32_16x16x32_bf16 v[88:91], v[28:31], v[248:251], v[88:91]
    ds_read_b64_tr_b16 v[26:27], v4 offset:2048
    s_waitcnt lgkmcnt(6)
    v_mfma_f32_16x16x32_bf16 v[92:95], v[32:35], v[104:107], 0
    ds_read_b64_tr_b16 v[28:29], v4 offset:4096
    v_cvt_pk_bf16_f32 v73, v74, v75
    v_mfma_f32_16x16x32_bf16 v[92:95], v[36:39], v[136:139], v[92:95]
    ds_read_b64_tr_b16 v[30:31], v4 offset:6144
    v_mul_f32 v76, v76, v10
    v_mfma_f32_16x16x32_bf16 v[100:103], v[32:35], v[108:111], 0
    ds_read_b64_tr_b16 v[32:33], v4 offset:8192
    v_mul_f32 v77, v77, v10
    v_mfma_f32_16x16x32_bf16 v[100:103], v[36:39], v[140:143], v[100:103]
    ds_read_b64_tr_b16 v[34:35], v4 offset:10240
    s_waitcnt lgkmcnt(6)
    v_mfma_f32_16x16x32_bf16 v[100:103], v[16:19], v[172:175], v[100:103]
    ds_read_b64_tr_b16 v[36:37], v4 offset:12288
    v_mul_f32 v78, v78, v10
    v_mfma_f32_16x16x32_bf16 v[100:103], v[20:23], v[252:255], v[100:103]
    ds_read_b64_tr_b16 v[38:39], v4 offset:14336
    v_mul_f32 v79, v79, v10
    v_mfma_f32_16x16x32_bf16 v[92:95], v[16:19], v[168:171], v[92:95]
    v_add_u32 v5, 67584, v5
    ds_read_b64_tr_b16 v[16:17], v5 offset:0
    v_mfma_f32_16x16x32_bf16 v[92:95], v[20:23], v[248:251], v[92:95]
    ds_read_b64_tr_b16 v[18:19], v5 offset:2048
    s_waitcnt lgkmcnt(6)
    v_mfma_f32_16x16x32_bf16 v[88:91], v[24:27], v[112:115], v[88:91]
    ds_read_b64_tr_b16 v[20:21], v5 offset:4096
    v_cvt_pk_bf16_f32 v74, v76, v77
    v_mfma_f32_16x16x32_bf16 v[88:91], v[28:31], v[144:147], v[88:91]
    ds_read_b64_tr_b16 v[22:23], v5 offset:6144
    v_cvt_pk_bf16_f32 v75, v78, v79
    v_mfma_f32_16x16x32_bf16 v[96:99], v[24:27], v[116:119], v[96:99]
    ds_read_b64_tr_b16 v[24:25], v5 offset:8192
    v_permlane16_swap_b32 v72, v74
    v_mfma_f32_16x16x32_bf16 v[96:99], v[28:31], v[148:151], v[96:99]
    ds_read_b64_tr_b16 v[26:27], v5 offset:10240
    s_waitcnt lgkmcnt(6)
    v_mfma_f32_16x16x32_bf16 v[96:99], v[32:35], v[180:183], v[96:99]
    ds_read_b64_tr_b16 v[28:29], v5 offset:12288
    v_permlane16_swap_b32 v73, v75
    v_mfma_f32_16x16x32_bf16 v[96:99], v[36:39], v[196:199], v[96:99]
    ds_read_b64_tr_b16 v[30:31], v5 offset:14336
    buffer_store_dwordx4 v[72:75], v6, s[24:27], s22 offen offset:0 sc0 sc1
    v_mfma_f32_16x16x32_bf16 v[88:91], v[32:35], v[176:179], v[88:91]
    ds_read_b64_tr_b16 v[32:33], v4 offset:16896
    v_mul_f32 v80, v80, v11
    v_mfma_f32_16x16x32_bf16 v[88:91], v[36:39], v[192:195], v[88:91]
    ds_read_b64_tr_b16 v[34:35], v4 offset:18944
    s_waitcnt lgkmcnt(6)
    v_mfma_f32_16x16x32_bf16 v[92:95], v[16:19], v[112:115], v[92:95]
    ds_read_b64_tr_b16 v[36:37], v4 offset:20992
    v_mul_f32 v81, v81, v11
    v_mfma_f32_16x16x32_bf16 v[92:95], v[20:23], v[144:147], v[92:95]
    ds_read_b64_tr_b16 v[38:39], v4 offset:23040
    v_mul_f32 v82, v82, v11
    v_mfma_f32_16x16x32_bf16 v[100:103], v[16:19], v[116:119], v[100:103]
    ds_read_b64_tr_b16 v[16:17], v4 offset:25088
    v_mul_f32 v83, v83, v11
    v_mfma_f32_16x16x32_bf16 v[100:103], v[20:23], v[148:151], v[100:103]
    ds_read_b64_tr_b16 v[18:19], v4 offset:27136
    s_waitcnt lgkmcnt(6)
    v_mfma_f32_16x16x32_bf16 v[100:103], v[24:27], v[180:183], v[100:103]
    ds_read_b64_tr_b16 v[20:21], v4 offset:29184
    v_cvt_pk_bf16_f32 v76, v80, v81
    v_mfma_f32_16x16x32_bf16 v[100:103], v[28:31], v[196:199], v[100:103]
    ds_read_b64_tr_b16 v[22:23], v4 offset:31232
    v_cvt_pk_bf16_f32 v77, v82, v83
    v_mfma_f32_16x16x32_bf16 v[92:95], v[24:27], v[176:179], v[92:95]
    ds_read_b64_tr_b16 v[24:25], v5 offset:16896
    v_mul_f32 v84, v84, v11
    v_mfma_f32_16x16x32_bf16 v[92:95], v[28:31], v[192:195], v[92:95]
    ds_read_b64_tr_b16 v[26:27], v5 offset:18944
    s_waitcnt lgkmcnt(6)
    v_mfma_f32_16x16x32_bf16 v[88:91], v[32:35], v[120:123], v[88:91]
    ds_read_b64_tr_b16 v[28:29], v5 offset:20992
    v_mul_f32 v85, v85, v11
    v_mfma_f32_16x16x32_bf16 v[88:91], v[36:39], v[152:155], v[88:91]
    ds_read_b64_tr_b16 v[30:31], v5 offset:23040
    v_mul_f32 v86, v86, v11
    v_mfma_f32_16x16x32_bf16 v[96:99], v[32:35], v[124:127], v[96:99]
    ds_read_b64_tr_b16 v[32:33], v5 offset:25088
    v_mul_f32 v87, v87, v11
    v_mfma_f32_16x16x32_bf16 v[96:99], v[36:39], v[156:159], v[96:99]
    ds_read_b64_tr_b16 v[34:35], v5 offset:27136
    s_waitcnt lgkmcnt(6)
    v_mfma_f32_16x16x32_bf16 v[96:99], v[16:19], v[244:247], v[96:99]
    ds_read_b64_tr_b16 v[36:37], v5 offset:29184
    v_cvt_pk_bf16_f32 v78, v84, v85
    v_mfma_f32_16x16x32_bf16 v[96:99], v[20:23], v[228:231], v[96:99]
    ds_read_b64_tr_b16 v[38:39], v5 offset:31232
    v_cvt_pk_bf16_f32 v79, v86, v87
    v_mfma_f32_16x16x32_bf16 v[88:91], v[16:19], v[240:243], v[88:91]
    ds_read_b64_tr_b16 v[16:17], v4 offset:33792
    v_permlane16_swap_b32 v76, v78
    v_mfma_f32_16x16x32_bf16 v[88:91], v[20:23], v[224:227], v[88:91]
    ds_read_b64_tr_b16 v[18:19], v4 offset:35840
    s_waitcnt lgkmcnt(6)
    v_mfma_f32_16x16x32_bf16 v[92:95], v[24:27], v[120:123], v[92:95]
    ds_read_b64_tr_b16 v[20:21], v4 offset:37888
    v_permlane16_swap_b32 v77, v79
    v_mfma_f32_16x16x32_bf16 v[92:95], v[28:31], v[152:155], v[92:95]
    ds_read_b64_tr_b16 v[22:23], v4 offset:39936
    buffer_store_dwordx4 v[76:79], v6, s[24:27], s23 offen offset:0 sc0 sc1
    v_mfma_f32_16x16x32_bf16 v[100:103], v[24:27], v[124:127], v[100:103]
    ds_read_b64_tr_b16 v[24:25], v4 offset:41984
    v_mfma_f32_16x16x32_bf16 v[100:103], v[28:31], v[156:159], v[100:103]
    ds_read_b64_tr_b16 v[26:27], v4 offset:44032
    s_waitcnt lgkmcnt(6)
    v_mfma_f32_16x16x32_bf16 v[100:103], v[32:35], v[244:247], v[100:103]
    ds_read_b64_tr_b16 v[28:29], v4 offset:46080
    v_mfma_f32_16x16x32_bf16 v[100:103], v[36:39], v[228:231], v[100:103]
    ds_read_b64_tr_b16 v[30:31], v4 offset:48128
    v_mfma_f32_16x16x32_bf16 v[92:95], v[32:35], v[240:243], v[92:95]
    ds_read_b64_tr_b16 v[32:33], v5 offset:33792
    v_mfma_f32_16x16x32_bf16 v[92:95], v[36:39], v[224:227], v[92:95]
    ds_read_b64_tr_b16 v[34:35], v5 offset:35840
    s_waitcnt lgkmcnt(6)
    v_mfma_f32_16x16x32_bf16 v[88:91], v[16:19], v[128:131], v[88:91]
    ds_read_b64_tr_b16 v[36:37], v5 offset:37888
    v_mfma_f32_16x16x32_bf16 v[88:91], v[20:23], v[160:163], v[88:91]
    ds_read_b64_tr_b16 v[38:39], v5 offset:39936
    v_mfma_f32_16x16x32_bf16 v[96:99], v[16:19], v[132:135], v[96:99]
    ds_read_b64_tr_b16 v[16:17], v5 offset:41984
    v_mfma_f32_16x16x32_bf16 v[96:99], v[20:23], v[164:167], v[96:99]
    ds_read_b64_tr_b16 v[18:19], v5 offset:44032
    s_waitcnt lgkmcnt(6)
    v_mfma_f32_16x16x32_bf16 v[96:99], v[24:27], v[188:191], v[96:99]
    ds_read_b64_tr_b16 v[20:21], v5 offset:46080
    v_mfma_f32_16x16x32_bf16 v[96:99], v[28:31], v[204:207], v[96:99]
    ds_read_b64_tr_b16 v[22:23], v5 offset:48128
    v_mfma_f32_16x16x32_bf16 v[88:91], v[24:27], v[184:187], v[88:91]
    v_mfma_f32_16x16x32_bf16 v[88:91], v[28:31], v[200:203], v[88:91]
    s_waitcnt lgkmcnt(4)
    v_mfma_f32_16x16x32_bf16 v[92:95], v[32:35], v[128:131], v[92:95]
    v_mfma_f32_16x16x32_bf16 v[92:95], v[36:39], v[160:163], v[92:95]
    v_mfma_f32_16x16x32_bf16 v[100:103], v[32:35], v[132:135], v[100:103]
    v_mfma_f32_16x16x32_bf16 v[100:103], v[36:39], v[164:167], v[100:103]
    v_mul_f32 v96, v96, v11
    s_waitcnt lgkmcnt(0)
    v_mfma_f32_16x16x32_bf16 v[100:103], v[16:19], v[188:191], v[100:103]
    v_mul_f32 v88, v88, v10
    v_mul_f32 v89, v89, v10
    v_mfma_f32_16x16x32_bf16 v[100:103], v[20:23], v[204:207], v[100:103]
    v_mul_f32 v90, v90, v10
    v_mul_f32 v91, v91, v10
    v_mfma_f32_16x16x32_bf16 v[92:95], v[16:19], v[184:187], v[92:95]
    v_cvt_pk_bf16_f32 v80, v88, v89
    v_cvt_pk_bf16_f32 v81, v90, v91
    v_mfma_f32_16x16x32_bf16 v[92:95], v[20:23], v[200:203], v[92:95]
    v_mul_f32 v97, v97, v11
    v_mul_f32 v98, v98, v11
    v_mul_f32 v99, v99, v11
    v_cvt_pk_bf16_f32 v84, v96, v97
    v_cvt_pk_bf16_f32 v85, v98, v99
    s_nop 0
    s_nop 0
    s_nop 0
    v_mul_f32 v92, v92, v10
    v_mul_f32 v93, v93, v10
    v_mul_f32 v94, v94, v10
    v_mul_f32 v95, v95, v10
    v_cvt_pk_bf16_f32 v82, v92, v93
    v_cvt_pk_bf16_f32 v83, v94, v95
    v_mul_f32 v100, v100, v11
    v_permlane16_swap_b32 v80, v82
    v_permlane16_swap_b32 v81, v83
    buffer_store_dwordx4 v[80:83], v6, s[24:27], s22 offen offset:64 sc0 sc1
    v_mul_f32 v101, v101, v11
    v_mul_f32 v102, v102, v11
    v_mul_f32 v103, v103, v11
    v_cvt_pk_bf16_f32 v86, v100, v101
    v_cvt_pk_bf16_f32 v87, v102, v103
    s_nop 0
    v_permlane16_swap_b32 v84, v86
    v_permlane16_swap_b32 v85, v87
    buffer_store_dwordx4 v[84:87], v6, s[24:27], s23 offen offset:64 sc0 sc1
L_end:
    s_endpgm
L_redo_compute_fast:
    s_waitcnt vmcnt(0) lgkmcnt(0)
    s_barrier
    v_mov_b32 v12, 0
    v_mov_b32 v13, 0
    s_mov_b64 s[32:33], 0
    s_nop 15
    s_branch L_restart_compute_safe
L_fast_end:
L_restart_compute_safe:
    v_lshrrev_b32 v9, 4, v0
    v_bfe_u32 v8, v0, 1, 3
    v_xor_b32 v10, v8, v9
    v_lshlrev_b32 v10, 4, v10
    v_and_b32 v6, 15, v0
    v_lshl_add_u32 v10, v6, 7, v10
    v_xor_b32 v11, 64, v10
    s_lshl_b32 s93, s29, 12
    v_mul_u32_u24 v1, 1056, v8
    v_and_b32 v8, 1, v0
    v_lshl_add_u32 v1, v8, 9, v1
    v_xor_b32 v8, v8, v9
    v_lshl_add_u32 v1, v8, 4, v1
    v_lshlrev_b32 v6, 9, v6
    v_bfe_u32 v8, v0, 4, 1
    v_lshl_add_u32 v6, v8, 5, v6
    v_lshrrev_b32 v8, 5, v0
    v_lshl_add_u32 v6, v8, 4, v6
    s_lshl_b32 s37, s29, 14
    v_add_u32 v6, s37, v6
    v_lshrrev_b32 v8, 2, v0
    v_lshlrev_b32 v2, 7, v8
    v_bfe_u32 v8, v0, 3, 2
    v_lshl_add_u32 v2, v8, 5, v2
    v_and_b32 v8, 3, v0
    v_lshl_add_u32 v2, v8, 3, v2
    v_xor_b32 v3, 32, v2
    v_xor_b32 v4, 64, v2
    v_xor_b32 v5, 96, v2
    s_lshl_b32 s36, s29, 2
    s_add_u32 s36, s36, 152064
    v_mov_b32 v7, s36
    s_mov_b32 s31, 0x3db8aa3b
    s_mov_b32 s35, 0x00000000
    v_mov_b32 v14, 0
    v_mov_b32 v15, 0
    s_waitcnt lgkmcnt(0)
    s_add_u32 s24, s10, s39
    s_addc_u32 s25, s11, 0
    s_mov_b32 s26, 0x10000
    s_mov_b32 s27, 0x20000
    s_xor_b32 s16, s34, 0
    s_add_u32 s17, s16, 8192
    s_xor_b32 s18, s34, 128
    s_add_u32 s19, s18, 8192
    s_xor_b32 s20, s34, 256
    s_add_u32 s21, s20, 8192
    s_xor_b32 s22, s34, 384
    s_add_u32 s23, s22, 8192
    s_barrier
    s_add_u32 s36, s93, 118272
    v_add_u32 v8, s36, v10
    s_add_u32 s36, s93, 118272
    v_add_u32 v9, s36, v11
    ds_read_b128 v[40:43], v8 offset:0
    ds_read_b128 v[44:47], v8 offset:2048
    ds_read_b128 v[48:51], v9 offset:0
    ds_read_b128 v[52:55], v9 offset:2048
    s_waitcnt lgkmcnt(0)
    s_barrier
    v_add_u32 v10, 135168, v10
    ds_read_b128 v[16:19], v10 offset:0
    v_add_u32 v11, 135168, v11
    ds_read_b128 v[20:23], v11 offset:0
    ds_read_b128 v[24:27], v10 offset:2048
    ds_read_b128 v[28:31], v11 offset:2048
    ds_read_b128 v[32:35], v10 offset:4096
    s_waitcnt lgkmcnt(3)
    v_mfma_f32_16x16x32_bf16 v[240:243], v[16:19], v[40:43], 0
    ds_read_b128 v[36:39], v11 offset:4096
    v_mfma_f32_16x16x32_bf16 v[240:243], v[20:23], v[48:51], v[240:243]
    v_mfma_f32_16x16x32_bf16 v[248:251], v[16:19], v[44:47], 0
    v_mfma_f32_16x16x32_bf16 v[248:251], v[20:23], v[52:55], v[248:251]
    ds_read_b128 v[16:19], v10 offset:6144
    s_waitcnt lgkmcnt(3)
    v_mfma_f32_16x16x32_bf16 v[244:247], v[24:27], v[40:43], 0
    ds_read_b128 v[20:23], v11 offset:6144
    v_mfma_f32_16x16x32_bf16 v[244:247], v[28:31], v[48:51], v[244:247]
    v_mfma_f32_16x16x32_bf16 v[252:255], v[24:27], v[44:47], 0
    v_mfma_f32_16x16x32_bf16 v[252:255], v[28:31], v[52:55], v[252:255]
    ds_read_b128 v[24:27], v10 offset:8192
    s_waitcnt lgkmcnt(3)
    v_mfma_f32_16x16x32_bf16 v[224:227], v[32:35], v[40:43], 0
    ds_read_b128 v[28:31], v11 offset:8192
    v_mfma_f32_16x16x32_bf16 v[224:227], v[36:39], v[48:51], v[224:227]
    v_mfma_f32_16x16x32_bf16 v[232:235], v[32:35], v[44:47], 0
    v_mfma_f32_16x16x32_bf16 v[232:235], v[36:39], v[52:55], v[232:235]
    s_barrier
    s_add_u32 s36, s93, 4294832128
    v_add_u32 v8, s36, v10
    s_add_u32 s36, s93, 4294832128
    v_add_u32 v9, s36, v11
    ds_read_b128 v[56:59], v8 offset:0
    ds_read_b128 v[60:63], v8 offset:2048
    ds_read_b128 v[64:67], v9 offset:0
    ds_read_b128 v[68:71], v9 offset:2048
    ds_read_b128 v[32:35], v10 offset:10240
    s_waitcnt lgkmcnt(7)
    v_mfma_f32_16x16x32_bf16 v[228:231], v[16:19], v[40:43], 0
    ds_read_b128 v[36:39], v11 offset:10240
    v_mfma_f32_16x16x32_bf16 v[228:231], v[20:23], v[48:51], v[228:231]
    v_mfma_f32_16x16x32_bf16 v[236:239], v[16:19], v[44:47], 0
    v_mfma_f32_16x16x32_bf16 v[236:239], v[20:23], v[52:55], v[236:239]
    ds_read_b128 v[16:19], v10 offset:12288
    s_waitcnt lgkmcnt(7)
    v_mfma_f32_16x16x32_bf16 v[208:211], v[24:27], v[40:43], 0
    ds_read_b128 v[20:23], v11 offset:12288
    v_mfma_f32_16x16x32_bf16 v[208:211], v[28:31], v[48:51], v[208:211]
    v_mfma_f32_16x16x32_bf16 v[216:219], v[24:27], v[44:47], 0
    v_mfma_f32_16x16x32_bf16 v[216:219], v[28:31], v[52:55], v[216:219]
    ds_read_b128 v[24:27], v10 offset:14336
    s_waitcnt lgkmcnt(3)
    v_mfma_f32_16x16x32_bf16 v[212:215], v[32:35], v[40:43], 0
    ds_read_b128 v[28:31], v11 offset:14336
    v_mfma_f32_16x16x32_bf16 v[212:215], v[36:39], v[48:51], v[212:215]
    v_mfma_f32_16x16x32_bf16 v[220:223], v[32:35], v[44:47], 0
    v_mfma_f32_16x16x32_bf16 v[220:223], v[36:39], v[52:55], v[220:223]
    s_barrier
    v_subrev_u32 v10, 118272, v10
    ds_read_b128 v[32:35], v10 offset:0
    s_waitcnt lgkmcnt(3)
    v_mfma_f32_16x16x32_bf16 v[192:195], v[16:19], v[40:43], 0
    v_subrev_u32 v11, 118272, v11
    ds_read_b128 v[36:39], v11 offset:0
    v_mfma_f32_16x16x32_bf16 v[192:195], v[20:23], v[48:51], v[192:195]
    v_mfma_f32_16x16x32_bf16 v[200:203], v[16:19], v[44:47], 0
    v_mfma_f32_16x16x32_bf16 v[200:203], v[20:23], v[52:55], v[200:203]
    ds_read_b128 v[16:19], v10 offset:2048
    s_waitcnt lgkmcnt(3)
    v_mfma_f32_16x16x32_bf16 v[196:199], v[24:27], v[40:43], 0
    ds_read_b128 v[20:23], v11 offset:2048
    v_mfma_f32_16x16x32_bf16 v[196:199], v[28:31], v[48:51], v[196:199]
    v_mfma_f32_16x16x32_bf16 v[204:207], v[24:27], v[44:47], 0
    v_mfma_f32_16x16x32_bf16 v[204:207], v[28:31], v[52:55], v[204:207]
    ds_read_b128 v[24:27], v10 offset:4096
    s_waitcnt lgkmcnt(3)
    v_mfma_f32_16x16x32_bf16 v[240:243], v[32:35], v[56:59], v[240:243]
    ds_read_b128 v[28:31], v11 offset:4096
    v_mfma_f32_16x16x32_bf16 v[240:243], v[36:39], v[64:67], v[240:243]
    v_mfma_f32_16x16x32_bf16 v[248:251], v[32:35], v[60:63], v[248:251]
    v_mfma_f32_16x16x32_bf16 v[248:251], v[36:39], v[68:71], v[248:251]
    ds_read_b128 v[32:35], v10 offset:6144
    s_waitcnt lgkmcnt(3)
    v_mfma_f32_16x16x32_bf16 v[244:247], v[16:19], v[56:59], v[244:247]
    ds_read_b128 v[36:39], v11 offset:6144
    v_mfma_f32_16x16x32_bf16 v[244:247], v[20:23], v[64:67], v[244:247]
    v_mfma_f32_16x16x32_bf16 v[252:255], v[16:19], v[60:63], v[252:255]
    v_mfma_f32_16x16x32_bf16 v[252:255], v[20:23], v[68:71], v[252:255]
    ds_read_b128 v[16:19], v10 offset:8192
    s_waitcnt lgkmcnt(3)
    v_mfma_f32_16x16x32_bf16 v[224:227], v[24:27], v[56:59], v[224:227]
    ds_read_b128 v[20:23], v11 offset:8192
    v_mfma_f32_16x16x32_bf16 v[224:227], v[28:31], v[64:67], v[224:227]
    v_mfma_f32_16x16x32_bf16 v[232:235], v[24:27], v[60:63], v[232:235]
    v_mfma_f32_16x16x32_bf16 v[232:235], v[28:31], v[68:71], v[232:235]
    s_barrier
    s_add_u32 s36, s93, 16896
    v_add_u32 v8, s36, v10
    s_add_u32 s36, s93, 16896
    v_add_u32 v9, s36, v11
    ds_read_b128 v[72:75], v8 offset:0
    ds_read_b128 v[76:79], v8 offset:2048
    ds_read_b128 v[80:83], v9 offset:0
    ds_read_b128 v[84:87], v9 offset:2048
    ds_read_b128 v[24:27], v10 offset:10240
    s_waitcnt lgkmcnt(7)
    v_mfma_f32_16x16x32_bf16 v[228:231], v[32:35], v[56:59], v[228:231]
    ds_read_b128 v[28:31], v11 offset:10240
    v_mfma_f32_16x16x32_bf16 v[228:231], v[36:39], v[64:67], v[228:231]
    v_mfma_f32_16x16x32_bf16 v[236:239], v[32:35], v[60:63], v[236:239]
    v_mfma_f32_16x16x32_bf16 v[236:239], v[36:39], v[68:71], v[236:239]
    ds_read_b128 v[32:35], v10 offset:12288
    s_waitcnt lgkmcnt(7)
    v_mfma_f32_16x16x32_bf16 v[208:211], v[16:19], v[56:59], v[208:211]
    ds_read_b128 v[36:39], v11 offset:12288
    v_mfma_f32_16x16x32_bf16 v[208:211], v[20:23], v[64:67], v[208:211]
    v_mfma_f32_16x16x32_bf16 v[216:219], v[16:19], v[60:63], v[216:219]
    v_mfma_f32_16x16x32_bf16 v[216:219], v[20:23], v[68:71], v[216:219]
    ds_read_b128 v[16:19], v10 offset:14336
    s_waitcnt lgkmcnt(3)
    v_mfma_f32_16x16x32_bf16 v[212:215], v[24:27], v[56:59], v[212:215]
    ds_read_b128 v[20:23], v11 offset:14336
    v_mfma_f32_16x16x32_bf16 v[212:215], v[28:31], v[64:67], v[212:215]
    v_mfma_f32_16x16x32_bf16 v[220:223], v[24:27], v[60:63], v[220:223]
    v_mfma_f32_16x16x32_bf16 v[220:223], v[28:31], v[68:71], v[220:223]
    s_barrier
    ds_read_b128 v[24:27], v10 offset:33792
    s_waitcnt lgkmcnt(3)
    v_mfma_f32_16x16x32_bf16 v[192:195], v[32:35], v[56:59], v[192:195]
    ds_read_b128 v[28:31], v11 offset:33792
    v_mfma_f32_16x16x32_bf16 v[192:195], v[36:39], v[64:67], v[192:195]
    v_mfma_f32_16x16x32_bf16 v[200:203], v[32:35], v[60:63], v[200:203]
    v_mfma_f32_16x16x32_bf16 v[200:203], v[36:39], v[68:71], v[200:203]
    ds_read_b128 v[32:35], v10 offset:35840
    s_waitcnt lgkmcnt(3)
    v_mfma_f32_16x16x32_bf16 v[196:199], v[16:19], v[56:59], v[196:199]
    ds_read_b128 v[36:39], v11 offset:35840
    v_mfma_f32_16x16x32_bf16 v[196:199], v[20:23], v[64:67], v[196:199]
    v_mfma_f32_16x16x32_bf16 v[204:207], v[16:19], v[60:63], v[204:207]
    v_mfma_f32_16x16x32_bf16 v[204:207], v[20:23], v[68:71], v[204:207]
    ds_read_b128 v[16:19], v10 offset:37888
    s_waitcnt lgkmcnt(3)
    v_mfma_f32_16x16x32_bf16 v[240:243], v[24:27], v[72:75], v[240:243]
    ds_read_b128 v[20:23], v11 offset:37888
    v_mfma_f32_16x16x32_bf16 v[240:243], v[28:31], v[80:83], v[240:243]
    v_mfma_f32_16x16x32_bf16 v[248:251], v[24:27], v[76:79], v[248:251]
    v_mfma_f32_16x16x32_bf16 v[248:251], v[28:31], v[84:87], v[248:251]
    ds_read_b128 v[24:27], v10 offset:39936
    s_waitcnt lgkmcnt(3)
    v_mfma_f32_16x16x32_bf16 v[244:247], v[32:35], v[72:75], v[244:247]
    ds_read_b128 v[28:31], v11 offset:39936
    v_mfma_f32_16x16x32_bf16 v[244:247], v[36:39], v[80:83], v[244:247]
    v_mfma_f32_16x16x32_bf16 v[252:255], v[32:35], v[76:79], v[252:255]
    v_mfma_f32_16x16x32_bf16 v[252:255], v[36:39], v[84:87], v[252:255]
    ds_read_b128 v[32:35], v10 offset:41984
    s_waitcnt lgkmcnt(3)
    v_mfma_f32_16x16x32_bf16 v[224:227], v[16:19], v[72:75], v[224:227]
    ds_read_b128 v[36:39], v11 offset:41984
    v_mfma_f32_16x16x32_bf16 v[224:227], v[20:23], v[80:83], v[224:227]
    v_mfma_f32_16x16x32_bf16 v[232:235], v[16:19], v[76:79], v[232:235]
    v_mfma_f32_16x16x32_bf16 v[232:235], v[20:23], v[84:87], v[232:235]
    s_barrier
    s_add_u32 s36, s93, 50688
    v_add_u32 v8, s36, v10
    s_add_u32 s36, s93, 50688
    v_add_u32 v9, s36, v11
    ds_read_b128 v[88:91], v8 offset:0
    ds_read_b128 v[92:95], v8 offset:2048
    ds_read_b128 v[96:99], v9 offset:0
    ds_read_b128 v[100:103], v9 offset:2048
    ds_read_b128 v[16:19], v10 offset:44032
    s_waitcnt lgkmcnt(7)
    v_mfma_f32_16x16x32_bf16 v[228:231], v[24:27], v[72:75], v[228:231]
    ds_read_b128 v[20:23], v11 offset:44032
    v_mfma_f32_16x16x32_bf16 v[228:231], v[28:31], v[80:83], v[228:231]
    v_mfma_f32_16x16x32_bf16 v[236:239], v[24:27], v[76:79], v[236:239]
    v_mfma_f32_16x16x32_bf16 v[236:239], v[28:31], v[84:87], v[236:239]
    ds_read_b128 v[24:27], v10 offset:46080
    s_waitcnt lgkmcnt(7)
    v_mfma_f32_16x16x32_bf16 v[208:211], v[32:35], v[72:75], v[208:211]
    ds_read_b128 v[28:31], v11 offset:46080
    v_mfma_f32_16x16x32_bf16 v[208:211], v[36:39], v[80:83], v[208:211]
    v_mfma_f32_16x16x32_bf16 v[216:219], v[32:35], v[76:79], v[216:219]
    v_mfma_f32_16x16x32_bf16 v[216:219], v[36:39], v[84:87], v[216:219]
    ds_read_b128 v[32:35], v10 offset:48128
    s_waitcnt lgkmcnt(3)
    v_mfma_f32_16x16x32_bf16 v[212:215], v[16:19], v[72:75], v[212:215]
    ds_read_b128 v[36:39], v11 offset:48128
    v_mfma_f32_16x16x32_bf16 v[212:215], v[20:23], v[80:83], v[212:215]
    v_mfma_f32_16x16x32_bf16 v[220:223], v[16:19], v[76:79], v[220:223]
    v_mfma_f32_16x16x32_bf16 v[220:223], v[20:23], v[84:87], v[220:223]
    s_barrier
    v_add_u32 v10, 67584, v10
    ds_read_b128 v[16:19], v10 offset:0
    s_waitcnt lgkmcnt(3)
    v_mfma_f32_16x16x32_bf16 v[192:195], v[24:27], v[72:75], v[192:195]
    v_add_u32 v11, 67584, v11
    ds_read_b128 v[20:23], v11 offset:0
    v_mfma_f32_16x16x32_bf16 v[192:195], v[28:31], v[80:83], v[192:195]
    v_mfma_f32_16x16x32_bf16 v[200:203], v[24:27], v[76:79], v[200:203]
    v_mfma_f32_16x16x32_bf16 v[200:203], v[28:31], v[84:87], v[200:203]
    ds_read_b128 v[24:27], v10 offset:2048
    s_waitcnt lgkmcnt(3)
    v_mfma_f32_16x16x32_bf16 v[196:199], v[32:35], v[72:75], v[196:199]
    ds_read_b128 v[28:31], v11 offset:2048
    v_mfma_f32_16x16x32_bf16 v[196:199], v[36:39], v[80:83], v[196:199]
    v_mfma_f32_16x16x32_bf16 v[204:207], v[32:35], v[76:79], v[204:207]
    v_mfma_f32_16x16x32_bf16 v[204:207], v[36:39], v[84:87], v[204:207]
    ds_read_b128 v[32:35], v10 offset:4096
    s_waitcnt lgkmcnt(3)
    v_mfma_f32_16x16x32_bf16 v[240:243], v[16:19], v[88:91], v[240:243]
    ds_read_b128 v[36:39], v11 offset:4096
    v_mfma_f32_16x16x32_bf16 v[240:243], v[20:23], v[96:99], v[240:243]
    v_mfma_f32_16x16x32_bf16 v[248:251], v[16:19], v[92:95], v[248:251]
    v_mfma_f32_16x16x32_bf16 v[248:251], v[20:23], v[100:103], v[248:251]
    ds_read_b128 v[16:19], v10 offset:6144
    s_waitcnt lgkmcnt(3)
    v_mfma_f32_16x16x32_bf16 v[244:247], v[24:27], v[88:91], v[244:247]
    ds_read_b128 v[20:23], v11 offset:6144
    v_mfma_f32_16x16x32_bf16 v[244:247], v[28:31], v[96:99], v[244:247]
    v_mfma_f32_16x16x32_bf16 v[252:255], v[24:27], v[92:95], v[252:255]
    v_mfma_f32_16x16x32_bf16 v[252:255], v[28:31], v[100:103], v[252:255]
    ds_read_b128 v[24:27], v10 offset:8192
    s_waitcnt lgkmcnt(3)
    v_mfma_f32_16x16x32_bf16 v[224:227], v[32:35], v[88:91], v[224:227]
    ds_read_b128 v[28:31], v11 offset:8192
    v_max3_f32 v8, v240, v241, v242
    v_mfma_f32_16x16x32_bf16 v[224:227], v[36:39], v[96:99], v[224:227]
    v_max3_f32 v9, v243, v244, v245
    v_max3_f32 v8, v8, v246, v247
    v_max_f32 v8, v8, v9
    v_mov_b32 v9, v8
    v_mfma_f32_16x16x32_bf16 v[232:235], v[32:35], v[92:95], v[232:235]
    v_mfma_f32_16x16x32_bf16 v[232:235], v[36:39], v[100:103], v[232:235]
    ds_read_b128 v[32:35], v10 offset:10240
    v_permlane32_swap_b32 v8, v9
    v_max_f32 v8, v8, v9
    s_waitcnt lgkmcnt(3)
    v_mfma_f32_16x16x32_bf16 v[228:231], v[16:19], v[88:91], v[228:231]
    ds_read_b128 v[36:39], v11 offset:10240
    v_mov_b32 v9, v8
    v_mfma_f32_16x16x32_bf16 v[228:231], v[20:23], v[96:99], v[228:231]
    v_mfma_f32_16x16x32_bf16 v[236:239], v[16:19], v[92:95], v[236:239]
    v_permlane16_swap_b32 v8, v9
    v_max_f32 v8, v8, v9
    v_mul_f32 v8, s31, v8
    v_cndmask_b32 v12, -v8, v12, s[32:33]
    v_mfma_f32_16x16x32_bf16 v[236:239], v[20:23], v[100:103], v[236:239]
    ds_read_b128 v[16:19], v10 offset:12288
    v_max3_f32 v8, v248, v249, v250
    v_max3_f32 v9, v251, v252, v253
    s_waitcnt lgkmcnt(3)
    v_mfma_f32_16x16x32_bf16 v[208:211], v[24:27], v[88:91], v[208:211]
    ds_read_b128 v[20:23], v11 offset:12288
    v_max3_f32 v8, v8, v254, v255
    v_max_f32 v8, v8, v9
    v_mov_b32 v9, v8
    v_mfma_f32_16x16x32_bf16 v[208:211], v[28:31], v[96:99], v[208:211]
    v_fma_f32 v240, v240, s31, v12
    v_permlane32_swap_b32 v8, v9
    v_max_f32 v8, v8, v9
    v_mov_b32 v9, v8
    v_mfma_f32_16x16x32_bf16 v[216:219], v[24:27], v[92:95], v[216:219]
    v_fma_f32 v241, v241, s31, v12
    v_permlane16_swap_b32 v8, v9
    v_max_f32 v8, v8, v9
    v_mul_f32 v8, s31, v8
    v_mfma_f32_16x16x32_bf16 v[216:219], v[28:31], v[100:103], v[216:219]
    ds_read_b128 v[24:27], v10 offset:14336
    v_cndmask_b32 v13, -v8, v13, s[32:33]
    v_fma_f32 v242, v242, s31, v12
    s_waitcnt lgkmcnt(3)
    v_mfma_f32_16x16x32_bf16 v[212:215], v[32:35], v[88:91], v[212:215]
    ds_read_b128 v[28:31], v11 offset:14336
    v_fma_f32 v243, v243, s31, v12
    v_exp_f32 v240, v240
    v_mfma_f32_16x16x32_bf16 v[212:215], v[36:39], v[96:99], v[212:215]
    v_exp_f32 v241, v241
    v_fma_f32 v244, v244, s31, v12
    v_fma_f32 v245, v245, s31, v12
    v_mfma_f32_16x16x32_bf16 v[220:223], v[32:35], v[92:95], v[220:223]
    v_exp_f32 v242, v242
    v_exp_f32 v243, v243
    v_mfma_f32_16x16x32_bf16 v[220:223], v[36:39], v[100:103], v[220:223]
    s_barrier
    v_add_u32 v1, 101376, v1
    ds_read_b128 v[32:35], v1 offset:0
    s_waitcnt lgkmcnt(3)
    v_mfma_f32_16x16x32_bf16 v[192:195], v[16:19], v[88:91], v[192:195]
    ds_read_b128 v[36:39], v1 offset:64
    v_cvt_pk_bf16_f32 v104, v240, v241
    v_fma_f32 v246, v246, s31, v12
    v_fma_f32 v247, v247, s31, v12
    v_mfma_f32_16x16x32_bf16 v[192:195], v[20:23], v[96:99], v[192:195]
    v_exp_f32 v244, v244
    v_exp_f32 v245, v245
    v_mfma_f32_16x16x32_bf16 v[200:203], v[16:19], v[92:95], v[200:203]
    v_cvt_pk_bf16_f32 v105, v242, v243
    v_fma_f32 v248, v248, s31, v13
    v_fma_f32 v249, v249, s31, v13
    v_cvt_pk_bf16_f32 v106, v244, v245
    v_mfma_f32_16x16x32_bf16 v[200:203], v[20:23], v[100:103], v[200:203]
    ds_read_b128 v[16:19], v1 offset:128
    v_exp_f32 v246, v246
    s_waitcnt lgkmcnt(3)
    v_mfma_f32_16x16x32_bf16 v[196:199], v[24:27], v[88:91], v[196:199]
    ds_read_b128 v[20:23], v1 offset:192
    v_exp_f32 v247, v247
    v_fma_f32 v250, v250, s31, v13
    v_mfma_f32_16x16x32_bf16 v[196:199], v[28:31], v[96:99], v[196:199]
    v_fma_f32 v251, v251, s31, v13
    v_exp_f32 v248, v248
    v_cvt_pk_bf16_f32 v107, v246, v247
    v_mfma_f32_16x16x32_bf16 v[204:207], v[24:27], v[92:95], v[204:207]
    v_exp_f32 v249, v249
    v_fma_f32 v252, v252, s31, v13
    v_fma_f32 v253, v253, s31, v13
    v_mfma_f32_16x16x32_bf16 v[204:207], v[28:31], v[100:103], v[204:207]
    ds_read_b128 v[24:27], v1 offset:256
    v_exp_f32 v250, v250
    s_waitcnt lgkmcnt(3)
    v_mfma_f32_16x16x32_bf16 v[176:179], v[32:35], v[40:43], 0
    ds_read_b128 v[28:31], v1 offset:320
    v_exp_f32 v251, v251
    v_cvt_pk_bf16_f32 v108, v248, v249
    v_mfma_f32_16x16x32_bf16 v[176:179], v[36:39], v[48:51], v[176:179]
    v_fma_f32 v254, v254, s31, v13
    v_fma_f32 v255, v255, s31, v13
    v_exp_f32 v252, v252
    v_mfma_f32_16x16x32_bf16 v[184:187], v[32:35], v[44:47], 0
    v_exp_f32 v253, v253
    v_cvt_pk_bf16_f32 v109, v250, v251
    v_cvt_pk_bf16_f32 v110, v252, v253
    v_mfma_f32_16x16x32_bf16 v[184:187], v[36:39], v[52:55], v[184:187]
    ds_read_b128 v[32:35], v1 offset:384
    v_exp_f32 v254, v254
    s_waitcnt lgkmcnt(3)
    v_mfma_f32_16x16x32_bf16 v[184:187], v[16:19], v[60:63], v[184:187]
    ds_read_b128 v[36:39], v1 offset:448
    v_exp_f32 v255, v255
    v_fma_f32 v224, v224, s31, v12
    v_mfma_f32_16x16x32_bf16 v[184:187], v[20:23], v[68:71], v[184:187]
    v_cvt_pk_bf16_f32 v111, v254, v255
    v_fma_f32 v225, v225, s31, v12
    v_max3_f32 v14, v14, v224, v225
    v_fma_f32 v226, v226, s31, v12
    v_mfma_f32_16x16x32_bf16 v[176:179], v[16:19], v[56:59], v[176:179]
    v_fma_f32 v227, v227, s31, v12
    v_exp_f32 v224, v224
    v_max3_f32 v14, v14, v226, v227
    v_mfma_f32_16x16x32_bf16 v[176:179], v[20:23], v[64:67], v[176:179]
    ds_read_b128 v[16:19], v1 offset:8448
    v_exp_f32 v225, v225
    s_waitcnt lgkmcnt(3)
    v_mfma_f32_16x16x32_bf16 v[176:179], v[24:27], v[72:75], v[176:179]
    ds_read_b128 v[20:23], v1 offset:8512
    v_fma_f32 v228, v228, s31, v12
    v_fma_f32 v229, v229, s31, v12
    v_cvt_pk_bf16_f32 v224, v224, v225
    v_mfma_f32_16x16x32_bf16 v[176:179], v[28:31], v[80:83], v[176:179]
    v_exp_f32 v226, v226
    v_exp_f32 v227, v227
    v_mfma_f32_16x16x32_bf16 v[184:187], v[24:27], v[76:79], v[184:187]
    v_max3_f32 v14, v14, v228, v229
    v_fma_f32 v230, v230, s31, v12
    v_fma_f32 v231, v231, s31, v12
    v_cvt_pk_bf16_f32 v225, v226, v227
    v_mfma_f32_16x16x32_bf16 v[184:187], v[28:31], v[84:87], v[184:187]
    ds_read_b128 v[24:27], v1 offset:8576
    v_exp_f32 v228, v228
    s_waitcnt lgkmcnt(3)
    v_mfma_f32_16x16x32_bf16 v[184:187], v[32:35], v[92:95], v[184:187]
    ds_read_b128 v[28:31], v1 offset:8640
    v_exp_f32 v229, v229
    v_max3_f32 v14, v14, v230, v231
    v_mfma_f32_16x16x32_bf16 v[184:187], v[36:39], v[100:103], v[184:187]
    v_fma_f32 v232, v232, s31, v13
    v_fma_f32 v233, v233, s31, v13
    v_exp_f32 v230, v230
    v_mfma_f32_16x16x32_bf16 v[176:179], v[32:35], v[88:91], v[176:179]
    v_exp_f32 v231, v231
    v_cvt_pk_bf16_f32 v226, v228, v229
    v_max3_f32 v15, v15, v232, v233
    v_mfma_f32_16x16x32_bf16 v[176:179], v[36:39], v[96:99], v[176:179]
    ds_read_b128 v[32:35], v1 offset:8704
    v_fma_f32 v234, v234, s31, v13
    v_fma_f32 v235, v235, s31, v13
    s_waitcnt lgkmcnt(3)
    v_mfma_f32_16x16x32_bf16 v[180:183], v[16:19], v[40:43], 0
    ds_read_b128 v[36:39], v1 offset:8768
    v_exp_f32 v232, v232
    v_cvt_pk_bf16_f32 v227, v230, v231
    v_mfma_f32_16x16x32_bf16 v[180:183], v[20:23], v[48:51], v[180:183]
    v_exp_f32 v233, v233
    v_max3_f32 v15, v15, v234, v235
    v_fma_f32 v236, v236, s31, v13
    v_mfma_f32_16x16x32_bf16 v[188:191], v[16:19], v[44:47], 0
    v_fma_f32 v237, v237, s31, v13
    v_exp_f32 v234, v234
    v_cvt_pk_bf16_f32 v228, v232, v233
    v_mfma_f32_16x16x32_bf16 v[188:191], v[20:23], v[52:55], v[188:191]
    ds_read_b128 v[16:19], v1 offset:8832
    v_exp_f32 v235, v235
    s_waitcnt lgkmcnt(3)
    v_mfma_f32_16x16x32_bf16 v[188:191], v[24:27], v[60:63], v[188:191]
    ds_read_b128 v[20:23], v1 offset:8896
    v_max3_f32 v15, v15, v236, v237
    v_fma_f32 v238, v238, s31, v13
    v_fma_f32 v239, v239, s31, v13
    v_mfma_f32_16x16x32_bf16 v[188:191], v[28:31], v[68:71], v[188:191]
    v_exp_f32 v236, v236
    v_exp_f32 v237, v237
    v_mfma_f32_16x16x32_bf16 v[180:183], v[24:27], v[56:59], v[180:183]
    v_cvt_pk_bf16_f32 v229, v234, v235
    v_max3_f32 v15, v15, v238, v239
    v_exp_f32 v238, v238
    v_mfma_f32_16x16x32_bf16 v[180:183], v[28:31], v[64:67], v[180:183]
    s_barrier
    ds_read_b128 v[24:27], v1 offset:16896
    v_cvt_pk_bf16_f32 v230, v236, v237
    s_waitcnt lgkmcnt(3)
    v_mfma_f32_16x16x32_bf16 v[180:183], v[32:35], v[72:75], v[180:183]
    ds_read_b128 v[28:31], v1 offset:16960
    v_exp_f32 v239, v239
    v_fma_f32 v208, v208, s31, v12
    v_mfma_f32_16x16x32_bf16 v[180:183], v[36:39], v[80:83], v[180:183]
    v_cvt_pk_bf16_f32 v231, v238, v239
    v_fma_f32 v209, v209, s31, v12
    v_max3_f32 v14, v14, v208, v209
    v_fma_f32 v210, v210, s31, v12
    v_mfma_f32_16x16x32_bf16 v[188:191], v[32:35], v[76:79], v[188:191]
    v_fma_f32 v211, v211, s31, v12
    v_exp_f32 v208, v208
    v_max3_f32 v14, v14, v210, v211
    v_mfma_f32_16x16x32_bf16 v[188:191], v[36:39], v[84:87], v[188:191]
    ds_read_b128 v[32:35], v1 offset:17024
    v_exp_f32 v209, v209
    s_waitcnt lgkmcnt(3)
    v_mfma_f32_16x16x32_bf16 v[188:191], v[16:19], v[92:95], v[188:191]
    ds_read_b128 v[36:39], v1 offset:17088
    v_fma_f32 v212, v212, s31, v12
    v_fma_f32 v213, v213, s31, v12
    v_cvt_pk_bf16_f32 v112, v208, v209
    v_mfma_f32_16x16x32_bf16 v[188:191], v[20:23], v[100:103], v[188:191]
    v_exp_f32 v210, v210
    v_exp_f32 v211, v211
    v_mfma_f32_16x16x32_bf16 v[180:183], v[16:19], v[88:91], v[180:183]
    v_max3_f32 v14, v14, v212, v213
    v_fma_f32 v214, v214, s31, v12
    v_fma_f32 v215, v215, s31, v12
    v_cvt_pk_bf16_f32 v113, v210, v211
    v_mfma_f32_16x16x32_bf16 v[180:183], v[20:23], v[96:99], v[180:183]
    ds_read_b128 v[16:19], v1 offset:17152
    v_exp_f32 v212, v212
    s_waitcnt lgkmcnt(3)
    v_mfma_f32_16x16x32_bf16 v[240:243], v[24:27], v[40:43], 0
    ds_read_b128 v[20:23], v1 offset:17216
    v_exp_f32 v213, v213
    v_max3_f32 v14, v14, v214, v215
    v_mfma_f32_16x16x32_bf16 v[240:243], v[28:31], v[48:51], v[240:243]
    v_fma_f32 v216, v216, s31, v13
    v_fma_f32 v217, v217, s31, v13
    v_exp_f32 v214, v214
    v_mfma_f32_16x16x32_bf16 v[248:251], v[24:27], v[44:47], 0
    v_exp_f32 v215, v215
    v_cvt_pk_bf16_f32 v114, v212, v213
    v_max3_f32 v15, v15, v216, v217
    v_mfma_f32_16x16x32_bf16 v[248:251], v[28:31], v[52:55], v[248:251]
    ds_read_b128 v[24:27], v1 offset:17280
    v_fma_f32 v218, v218, s31, v13
    v_fma_f32 v219, v219, s31, v13
    s_waitcnt lgkmcnt(3)
    v_mfma_f32_16x16x32_bf16 v[248:251], v[32:35], v[60:63], v[248:251]
    ds_read_b128 v[28:31], v1 offset:17344
    v_exp_f32 v216, v216
    v_cvt_pk_bf16_f32 v115, v214, v215
    v_mfma_f32_16x16x32_bf16 v[248:251], v[36:39], v[68:71], v[248:251]
    v_exp_f32 v217, v217
    v_max3_f32 v15, v15, v218, v219
    v_fma_f32 v220, v220, s31, v13
    v_mfma_f32_16x16x32_bf16 v[240:243], v[32:35], v[56:59], v[240:243]
    v_fma_f32 v221, v221, s31, v13
    v_exp_f32 v218, v218
    v_cvt_pk_bf16_f32 v116, v216, v217
    v_mfma_f32_16x16x32_bf16 v[240:243], v[36:39], v[64:67], v[240:243]
    ds_read_b128 v[32:35], v1 offset:25344
    v_exp_f32 v219, v219
    s_waitcnt lgkmcnt(3)
    v_mfma_f32_16x16x32_bf16 v[240:243], v[16:19], v[72:75], v[240:243]
    ds_read_b128 v[36:39], v1 offset:25408
    v_max3_f32 v15, v15, v220, v221
    v_fma_f32 v222, v222, s31, v13
    v_fma_f32 v223, v223, s31, v13
    v_mfma_f32_16x16x32_bf16 v[240:243], v[20:23], v[80:83], v[240:243]
    v_exp_f32 v220, v220
    v_exp_f32 v221, v221
    v_mfma_f32_16x16x32_bf16 v[248:251], v[16:19], v[76:79], v[248:251]
    v_cvt_pk_bf16_f32 v117, v218, v219
    v_max3_f32 v15, v15, v222, v223
    v_exp_f32 v222, v222
    v_mfma_f32_16x16x32_bf16 v[248:251], v[20:23], v[84:87], v[248:251]
    ds_read_b128 v[16:19], v1 offset:25472
    v_exp_f32 v223, v223
    s_waitcnt lgkmcnt(3)
    v_mfma_f32_16x16x32_bf16 v[248:251], v[24:27], v[92:95], v[248:251]
    ds_read_b128 v[20:23], v1 offset:25536
    v_cvt_pk_bf16_f32 v118, v220, v221
    v_cvt_pk_bf16_f32 v119, v222, v223
    v_fma_f32 v192, v192, s31, v12
    v_mfma_f32_16x16x32_bf16 v[248:251], v[28:31], v[100:103], v[248:251]
    v_fma_f32 v193, v193, s31, v12
    v_max3_f32 v14, v14, v192, v193
    v_fma_f32 v194, v194, s31, v12
    v_fma_f32 v195, v195, s31, v12
    v_mfma_f32_16x16x32_bf16 v[240:243], v[24:27], v[88:91], v[240:243]
    v_exp_f32 v192, v192
    v_exp_f32 v193, v193
    v_mfma_f32_16x16x32_bf16 v[240:243], v[28:31], v[96:99], v[240:243]
    ds_read_b128 v[24:27], v1 offset:25600
    v_max3_f32 v14, v14, v194, v195
    v_fma_f32 v196, v196, s31, v12
    s_waitcnt lgkmcnt(3)
    v_mfma_f32_16x16x32_bf16 v[244:247], v[32:35], v[40:43], 0
    ds_read_b128 v[28:31], v1 offset:25664
    v_fma_f32 v197, v197, s31, v12
    v_exp_f32 v194, v194
    v_mfma_f32_16x16x32_bf16 v[244:247], v[36:39], v[48:51], v[244:247]
    v_exp_f32 v195, v195
    v_cvt_pk_bf16_f32 v232, v192, v193
    v_max3_f32 v14, v14, v196, v197
    v_mfma_f32_16x16x32_bf16 v[252:255], v[32:35], v[44:47], 0
    v_fma_f32 v198, v198, s31, v12
    v_fma_f32 v199, v199, s31, v12
    v_exp_f32 v196, v196
    v_mfma_f32_16x16x32_bf16 v[252:255], v[36:39], v[52:55], v[252:255]
    ds_read_b128 v[32:35], v1 offset:25728
    v_exp_f32 v197, v197
    s_waitcnt lgkmcnt(3)
    v_mfma_f32_16x16x32_bf16 v[252:255], v[16:19], v[60:63], v[252:255]
    ds_read_b128 v[36:39], v1 offset:25792
    v_cvt_pk_bf16_f32 v233, v194, v195
    v_max3_f32 v14, v14, v198, v199
    v_fma_f32 v200, v200, s31, v13
    v_mfma_f32_16x16x32_bf16 v[252:255], v[20:23], v[68:71], v[252:255]
    v_fma_f32 v201, v201, s31, v13
    v_exp_f32 v198, v198
    v_cvt_pk_bf16_f32 v234, v196, v197
    v_mfma_f32_16x16x32_bf16 v[244:247], v[16:19], v[56:59], v[244:247]
    v_exp_f32 v199, v199
    v_max3_f32 v15, v15, v200, v201
    v_fma_f32 v202, v202, s31, v13
    v_mfma_f32_16x16x32_bf16 v[244:247], v[20:23], v[64:67], v[244:247]
    s_barrier
    ds_read_b128 v[16:19], v1 offset:33792
    v_fma_f32 v203, v203, s31, v13
    s_waitcnt lgkmcnt(3)
    v_mfma_f32_16x16x32_bf16 v[244:247], v[24:27], v[72:75], v[244:247]
    ds_read_b128 v[20:23], v1 offset:33856
    v_exp_f32 v200, v200
    v_cvt_pk_bf16_f32 v235, v198, v199
    v_mfma_f32_16x16x32_bf16 v[244:247], v[28:31], v[80:83], v[244:247]
    v_exp_f32 v201, v201
    v_max3_f32 v15, v15, v202, v203
    v_fma_f32 v204, v204, s31, v13
    v_mfma_f32_16x16x32_bf16 v[252:255], v[24:27], v[76:79], v[252:255]
    v_fma_f32 v205, v205, s31, v13
    v_exp_f32 v202, v202
    v_cvt_pk_bf16_f32 v236, v200, v201
    v_mfma_f32_16x16x32_bf16 v[252:255], v[28:31], v[84:87], v[252:255]
    ds_read_b128 v[24:27], v1 offset:33920
    v_exp_f32 v203, v203
    s_waitcnt lgkmcnt(3)
    v_mfma_f32_16x16x32_bf16 v[252:255], v[32:35], v[92:95], v[252:255]
    ds_read_b128 v[28:31], v1 offset:33984
    v_max3_f32 v15, v15, v204, v205
    v_fma_f32 v206, v206, s31, v13
    v_fma_f32 v207, v207, s31, v13
    v_mfma_f32_16x16x32_bf16 v[252:255], v[36:39], v[100:103], v[252:255]
    v_exp_f32 v204, v204
    v_exp_f32 v205, v205
    v_mfma_f32_16x16x32_bf16 v[244:247], v[32:35], v[88:91], v[244:247]
    v_cvt_pk_bf16_f32 v237, v202, v203
    v_max3_f32 v15, v15, v206, v207
    v_exp_f32 v206, v206
    v_mfma_f32_16x16x32_bf16 v[244:247], v[36:39], v[96:99], v[244:247]
    ds_read_b128 v[32:35], v1 offset:34048
    v_exp_f32 v207, v207
    s_waitcnt lgkmcnt(3)
    v_mfma_f32_16x16x32_bf16 v[208:211], v[16:19], v[40:43], 0
    ds_read_b128 v[36:39], v1 offset:34112
    v_cvt_pk_bf16_f32 v238, v204, v205
    v_cvt_pk_bf16_f32 v239, v206, v207
    v_fma_f32 v176, v176, s31, v12
    v_mfma_f32_16x16x32_bf16 v[208:211], v[20:23], v[48:51], v[208:211]
    v_fma_f32 v177, v177, s31, v12
    v_max3_f32 v14, v14, v176, v177
    v_fma_f32 v178, v178, s31, v12
    v_fma_f32 v179, v179, s31, v12
    v_mfma_f32_16x16x32_bf16 v[216:219], v[16:19], v[44:47], 0
    v_exp_f32 v176, v176
    v_exp_f32 v177, v177
    v_mfma_f32_16x16x32_bf16 v[216:219], v[20:23], v[52:55], v[216:219]
    ds_read_b128 v[16:19], v1 offset:34176
    v_max3_f32 v14, v14, v178, v179
    v_fma_f32 v180, v180, s31, v12
    s_waitcnt lgkmcnt(3)
    v_mfma_f32_16x16x32_bf16 v[216:219], v[24:27], v[60:63], v[216:219]
    ds_read_b128 v[20:23], v1 offset:34240
    v_fma_f32 v181, v181, s31, v12
    v_exp_f32 v178, v178
    v_mfma_f32_16x16x32_bf16 v[216:219], v[28:31], v[68:71], v[216:219]
    v_exp_f32 v179, v179
    v_cvt_pk_bf16_f32 v176, v176, v177
    v_max3_f32 v14, v14, v180, v181
    v_mfma_f32_16x16x32_bf16 v[208:211], v[24:27], v[56:59], v[208:211]
    v_fma_f32 v182, v182, s31, v12
    v_fma_f32 v183, v183, s31, v12
    v_exp_f32 v180, v180
    v_mfma_f32_16x16x32_bf16 v[208:211], v[28:31], v[64:67], v[208:211]
    ds_read_b128 v[24:27], v1 offset:42240
    v_exp_f32 v181, v181
    s_waitcnt lgkmcnt(3)
    v_mfma_f32_16x16x32_bf16 v[208:211], v[32:35], v[72:75], v[208:211]
    ds_read_b128 v[28:31], v1 offset:42304
    v_cvt_pk_bf16_f32 v177, v178, v179
    v_max3_f32 v14, v14, v182, v183
    v_fma_f32 v184, v184, s31, v13
    v_mfma_f32_16x16x32_bf16 v[208:211], v[36:39], v[80:83], v[208:211]
    v_fma_f32 v185, v185, s31, v13
    v_exp_f32 v182, v182
    v_cvt_pk_bf16_f32 v178, v180, v181
    v_mfma_f32_16x16x32_bf16 v[216:219], v[32:35], v[76:79], v[216:219]
    v_exp_f32 v183, v183
    v_max3_f32 v15, v15, v184, v185
    v_fma_f32 v186, v186, s31, v13
    v_mfma_f32_16x16x32_bf16 v[216:219], v[36:39], v[84:87], v[216:219]
    ds_read_b128 v[32:35], v1 offset:42368
    v_fma_f32 v187, v187, s31, v13
    v_cvt_pk_bf16_f32 v179, v182, v183
    s_waitcnt lgkmcnt(3)
    v_mfma_f32_16x16x32_bf16 v[216:219], v[16:19], v[92:95], v[216:219]
    ds_read_b128 v[36:39], v1 offset:42432
    v_exp_f32 v184, v184
    v_max3_f32 v15, v15, v186, v187
    v_mfma_f32_16x16x32_bf16 v[216:219], v[20:23], v[100:103], v[216:219]
    v_exp_f32 v185, v185
    v_fma_f32 v188, v188, s31, v13
    v_fma_f32 v189, v189, s31, v13
    v_mfma_f32_16x16x32_bf16 v[208:211], v[16:19], v[88:91], v[208:211]
    v_exp_f32 v186, v186
    v_exp_f32 v187, v187
    v_mfma_f32_16x16x32_bf16 v[208:211], v[20:23], v[96:99], v[208:211]
    ds_read_b128 v[16:19], v1 offset:42496
    v_cvt_pk_bf16_f32 v180, v184, v185
    v_max3_f32 v15, v15, v188, v189
    s_waitcnt lgkmcnt(3)
    v_mfma_f32_16x16x32_bf16 v[212:215], v[24:27], v[40:43], 0
    ds_read_b128 v[20:23], v1 offset:42560
    v_fma_f32 v190, v190, s31, v13
    v_fma_f32 v191, v191, s31, v13
    v_cvt_pk_bf16_f32 v181, v186, v187
    v_mfma_f32_16x16x32_bf16 v[212:215], v[28:31], v[48:51], v[212:215]
    v_exp_f32 v188, v188
    v_exp_f32 v189, v189
    v_mfma_f32_16x16x32_bf16 v[220:223], v[24:27], v[44:47], 0
    v_max3_f32 v15, v15, v190, v191
    v_exp_f32 v190, v190
    v_cvt_pk_bf16_f32 v182, v188, v189
    v_mfma_f32_16x16x32_bf16 v[220:223], v[28:31], v[52:55], v[220:223]
    ds_read_b128 v[24:27], v1 offset:42624
    v_exp_f32 v191, v191
    s_waitcnt lgkmcnt(3)
    v_mfma_f32_16x16x32_bf16 v[220:223], v[32:35], v[60:63], v[220:223]
    ds_read_b128 v[28:31], v1 offset:42688
    v_cvt_pk_bf16_f32 v183, v190, v191
    v_fma_f32 v240, v240, s31, v12
    v_fma_f32 v241, v241, s31, v12
    v_mfma_f32_16x16x32_bf16 v[220:223], v[36:39], v[68:71], v[220:223]
    v_max3_f32 v14, v14, v240, v241
    v_fma_f32 v242, v242, s31, v12
    v_fma_f32 v243, v243, s31, v12
    v_max3_f32 v14, v14, v242, v243
    v_mfma_f32_16x16x32_bf16 v[212:215], v[32:35], v[56:59], v[212:215]
    v_exp_f32 v240, v240
    v_exp_f32 v241, v241
    v_mfma_f32_16x16x32_bf16 v[212:215], v[36:39], v[64:67], v[212:215]
    s_barrier
    v_subrev_u32 v1, 101376, v1
    ds_read_b128 v[32:35], v1 offset:0
    s_waitcnt lgkmcnt(3)
    v_mfma_f32_16x16x32_bf16 v[212:215], v[16:19], v[72:75], v[212:215]
    ds_read_b128 v[36:39], v1 offset:64
    v_fma_f32 v244, v244, s31, v12
    v_fma_f32 v245, v245, s31, v12
    v_cvt_pk_bf16_f32 v120, v240, v241
    v_mfma_f32_16x16x32_bf16 v[212:215], v[20:23], v[80:83], v[212:215]
    v_exp_f32 v242, v242
    v_exp_f32 v243, v243
    v_mfma_f32_16x16x32_bf16 v[220:223], v[16:19], v[76:79], v[220:223]
    v_max3_f32 v14, v14, v244, v245
    v_fma_f32 v246, v246, s31, v12
    v_fma_f32 v247, v247, s31, v12
    v_cvt_pk_bf16_f32 v121, v242, v243
    v_mfma_f32_16x16x32_bf16 v[220:223], v[20:23], v[84:87], v[220:223]
    ds_read_b128 v[16:19], v1 offset:128
    v_exp_f32 v244, v244
    s_waitcnt lgkmcnt(3)
    v_mfma_f32_16x16x32_bf16 v[220:223], v[24:27], v[92:95], v[220:223]
    ds_read_b128 v[20:23], v1 offset:192
    v_exp_f32 v245, v245
    v_max3_f32 v14, v14, v246, v247
    v_mfma_f32_16x16x32_bf16 v[220:223], v[28:31], v[100:103], v[220:223]
    v_fma_f32 v248, v248, s31, v13
    v_fma_f32 v249, v249, s31, v13
    v_exp_f32 v246, v246
    v_mfma_f32_16x16x32_bf16 v[212:215], v[24:27], v[88:91], v[212:215]
    v_exp_f32 v247, v247
    v_cvt_pk_bf16_f32 v122, v244, v245
    v_max3_f32 v15, v15, v248, v249
    v_mfma_f32_16x16x32_bf16 v[212:215], v[28:31], v[96:99], v[212:215]
    ds_read_b128 v[24:27], v1 offset:256
    v_fma_f32 v250, v250, s31, v13
    v_fma_f32 v251, v251, s31, v13
    s_waitcnt lgkmcnt(3)
    v_mfma_f32_16x16x32_bf16 v[192:195], v[32:35], v[40:43], 0
    ds_read_b128 v[28:31], v1 offset:320
    v_exp_f32 v248, v248
    v_cvt_pk_bf16_f32 v123, v246, v247
    v_mfma_f32_16x16x32_bf16 v[192:195], v[36:39], v[48:51], v[192:195]
    v_exp_f32 v249, v249
    v_max3_f32 v15, v15, v250, v251
    v_fma_f32 v252, v252, s31, v13
    v_mfma_f32_16x16x32_bf16 v[200:203], v[32:35], v[44:47], 0
    v_fma_f32 v253, v253, s31, v13
    v_exp_f32 v250, v250
    v_cvt_pk_bf16_f32 v124, v248, v249
    v_mfma_f32_16x16x32_bf16 v[200:203], v[36:39], v[52:55], v[200:203]
    ds_read_b128 v[32:35], v1 offset:384
    v_exp_f32 v251, v251
    s_waitcnt lgkmcnt(3)
    v_mfma_f32_16x16x32_bf16 v[200:203], v[16:19], v[60:63], v[200:203]
    ds_read_b128 v[36:39], v1 offset:448
    v_max3_f32 v15, v15, v252, v253
    v_fma_f32 v254, v254, s31, v13
    v_fma_f32 v255, v255, s31, v13
    v_mfma_f32_16x16x32_bf16 v[200:203], v[20:23], v[68:71], v[200:203]
    v_exp_f32 v252, v252
    v_exp_f32 v253, v253
    v_mfma_f32_16x16x32_bf16 v[192:195], v[16:19], v[56:59], v[192:195]
    v_cvt_pk_bf16_f32 v125, v250, v251
    v_max3_f32 v15, v15, v254, v255
    v_exp_f32 v254, v254
    v_mfma_f32_16x16x32_bf16 v[192:195], v[20:23], v[64:67], v[192:195]
    ds_read_b128 v[16:19], v1 offset:8448
    v_exp_f32 v255, v255
    s_waitcnt lgkmcnt(3)
    v_mfma_f32_16x16x32_bf16 v[192:195], v[24:27], v[72:75], v[192:195]
    ds_read_b128 v[20:23], v1 offset:8512
    v_cvt_pk_bf16_f32 v126, v252, v253
    v_cvt_pk_bf16_f32 v127, v254, v255
    v_fma_f32 v208, v208, s31, v12
    v_mfma_f32_16x16x32_bf16 v[192:195], v[28:31], v[80:83], v[192:195]
    v_fma_f32 v209, v209, s31, v12
    v_max3_f32 v14, v14, v208, v209
    v_fma_f32 v210, v210, s31, v12
    v_fma_f32 v211, v211, s31, v12
    v_mfma_f32_16x16x32_bf16 v[200:203], v[24:27], v[76:79], v[200:203]
    v_exp_f32 v208, v208
    v_exp_f32 v209, v209
    v_mfma_f32_16x16x32_bf16 v[200:203], v[28:31], v[84:87], v[200:203]
    ds_read_b128 v[24:27], v1 offset:8576
    v_max3_f32 v14, v14, v210, v211
    v_fma_f32 v212, v212, s31, v12
    s_waitcnt lgkmcnt(3)
    v_mfma_f32_16x16x32_bf16 v[200:203], v[32:35], v[92:95], v[200:203]
    ds_read_b128 v[28:31], v1 offset:8640
    v_fma_f32 v213, v213, s31, v12
    v_exp_f32 v210, v210
    v_mfma_f32_16x16x32_bf16 v[200:203], v[36:39], v[100:103], v[200:203]
    v_exp_f32 v211, v211
    v_cvt_pk_bf16_f32 v184, v208, v209
    v_max3_f32 v14, v14, v212, v213
    v_mfma_f32_16x16x32_bf16 v[192:195], v[32:35], v[88:91], v[192:195]
    v_fma_f32 v214, v214, s31, v12
    v_fma_f32 v215, v215, s31, v12
    v_exp_f32 v212, v212
    v_mfma_f32_16x16x32_bf16 v[192:195], v[36:39], v[96:99], v[192:195]
    ds_read_b128 v[32:35], v1 offset:8704
    v_exp_f32 v213, v213
    s_waitcnt lgkmcnt(3)
    v_mfma_f32_16x16x32_bf16 v[196:199], v[16:19], v[40:43], 0
    ds_read_b128 v[36:39], v1 offset:8768
    v_cvt_pk_bf16_f32 v185, v210, v211
    v_max3_f32 v14, v14, v214, v215
    v_fma_f32 v216, v216, s31, v13
    v_mfma_f32_16x16x32_bf16 v[196:199], v[20:23], v[48:51], v[196:199]
    v_fma_f32 v217, v217, s31, v13
    v_exp_f32 v214, v214
    v_cvt_pk_bf16_f32 v186, v212, v213
    v_mfma_f32_16x16x32_bf16 v[204:207], v[16:19], v[44:47], 0
    v_exp_f32 v215, v215
    v_max3_f32 v15, v15, v216, v217
    v_fma_f32 v218, v218, s31, v13
    v_mfma_f32_16x16x32_bf16 v[204:207], v[20:23], v[52:55], v[204:207]
    ds_read_b128 v[16:19], v1 offset:8832
    v_fma_f32 v219, v219, s31, v13
    v_cvt_pk_bf16_f32 v187, v214, v215
    s_waitcnt lgkmcnt(3)
    v_mfma_f32_16x16x32_bf16 v[204:207], v[24:27], v[60:63], v[204:207]
    ds_read_b128 v[20:23], v1 offset:8896
    v_exp_f32 v216, v216
    v_max3_f32 v15, v15, v218, v219
    v_mfma_f32_16x16x32_bf16 v[204:207], v[28:31], v[68:71], v[204:207]
    v_exp_f32 v217, v217
    v_fma_f32 v220, v220, s31, v13
    v_fma_f32 v221, v221, s31, v13
    v_mfma_f32_16x16x32_bf16 v[196:199], v[24:27], v[56:59], v[196:199]
    v_exp_f32 v218, v218
    v_exp_f32 v219, v219
    v_mfma_f32_16x16x32_bf16 v[196:199], v[28:31], v[64:67], v[196:199]
    s_barrier
    ds_read_b128 v[24:27], v1 offset:16896
    v_cvt_pk_bf16_f32 v188, v216, v217
    s_waitcnt lgkmcnt(3)
    v_mfma_f32_16x16x32_bf16 v[196:199], v[32:35], v[72:75], v[196:199]
    ds_read_b128 v[28:31], v1 offset:16960
    v_max3_f32 v15, v15, v220, v221
    v_fma_f32 v222, v222, s31, v13
    v_fma_f32 v223, v223, s31, v13
    v_mfma_f32_16x16x32_bf16 v[196:199], v[36:39], v[80:83], v[196:199]
    v_exp_f32 v220, v220
    v_exp_f32 v221, v221
    v_mfma_f32_16x16x32_bf16 v[204:207], v[32:35], v[76:79], v[204:207]
    v_cvt_pk_bf16_f32 v189, v218, v219
    v_max3_f32 v15, v15, v222, v223
    v_exp_f32 v222, v222
    v_mfma_f32_16x16x32_bf16 v[204:207], v[36:39], v[84:87], v[204:207]
    ds_read_b128 v[32:35], v1 offset:17024
    v_exp_f32 v223, v223
    s_waitcnt lgkmcnt(3)
    v_mfma_f32_16x16x32_bf16 v[204:207], v[16:19], v[92:95], v[204:207]
    ds_read_b128 v[36:39], v1 offset:17088
    v_cvt_pk_bf16_f32 v190, v220, v221
    v_cvt_pk_bf16_f32 v191, v222, v223
    v_mfma_f32_16x16x32_bf16 v[204:207], v[20:23], v[100:103], v[204:207]
    v_mfma_f32_16x16x32_bf16 v[196:199], v[16:19], v[88:91], v[196:199]
    v_mfma_f32_16x16x32_bf16 v[196:199], v[20:23], v[96:99], v[196:199]
    ds_read_b128 v[16:19], v1 offset:17152
    s_waitcnt lgkmcnt(3)
    v_mfma_f32_16x16x32_bf16 v[240:243], v[24:27], v[40:43], 0
    ds_read_b128 v[20:23], v1 offset:17216
    v_fma_f32 v192, v192, s31, v12
    v_fma_f32 v193, v193, s31, v12
    v_max3_f32 v14, v14, v192, v193
    v_mfma_f32_16x16x32_bf16 v[240:243], v[28:31], v[48:51], v[240:243]
    v_fma_f32 v194, v194, s31, v12
    v_fma_f32 v195, v195, s31, v12
    v_exp_f32 v192, v192
    v_mfma_f32_16x16x32_bf16 v[248:251], v[24:27], v[44:47], 0
    v_exp_f32 v193, v193
    v_max3_f32 v14, v14, v194, v195
    v_fma_f32 v196, v196, s31, v12
    v_mfma_f32_16x16x32_bf16 v[248:251], v[28:31], v[52:55], v[248:251]
    ds_read_b128 v[24:27], v1 offset:17280
    v_fma_f32 v197, v197, s31, v12
    v_cvt_pk_bf16_f32 v192, v192, v193
    s_waitcnt lgkmcnt(3)
    v_mfma_f32_16x16x32_bf16 v[248:251], v[32:35], v[60:63], v[248:251]
    ds_read_b128 v[28:31], v1 offset:17344
    v_exp_f32 v194, v194
    v_max3_f32 v14, v14, v196, v197
    v_mfma_f32_16x16x32_bf16 v[248:251], v[36:39], v[68:71], v[248:251]
    v_exp_f32 v195, v195
    v_fma_f32 v198, v198, s31, v12
    v_fma_f32 v199, v199, s31, v12
    v_mfma_f32_16x16x32_bf16 v[240:243], v[32:35], v[56:59], v[240:243]
    v_exp_f32 v196, v196
    v_exp_f32 v197, v197
    v_mfma_f32_16x16x32_bf16 v[240:243], v[36:39], v[64:67], v[240:243]
    ds_read_b128 v[32:35], v1 offset:25344
    v_cvt_pk_bf16_f32 v193, v194, v195
    v_max3_f32 v14, v14, v198, v199
    s_waitcnt lgkmcnt(3)
    v_mfma_f32_16x16x32_bf16 v[240:243], v[16:19], v[72:75], v[240:243]
    ds_read_b128 v[36:39], v1 offset:25408
    v_fma_f32 v200, v200, s31, v13
    v_fma_f32 v201, v201, s31, v13
    v_cvt_pk_bf16_f32 v194, v196, v197
    v_mfma_f32_16x16x32_bf16 v[240:243], v[20:23], v[80:83], v[240:243]
    v_exp_f32 v198, v198
    v_exp_f32 v199, v199
    v_mfma_f32_16x16x32_bf16 v[248:251], v[16:19], v[76:79], v[248:251]
    v_max3_f32 v15, v15, v200, v201
    v_fma_f32 v202, v202, s31, v13
    v_fma_f32 v203, v203, s31, v13
    v_cvt_pk_bf16_f32 v195, v198, v199
    v_mfma_f32_16x16x32_bf16 v[248:251], v[20:23], v[84:87], v[248:251]
    ds_read_b128 v[16:19], v1 offset:25472
    v_exp_f32 v200, v200
    s_waitcnt lgkmcnt(3)
    v_mfma_f32_16x16x32_bf16 v[248:251], v[24:27], v[92:95], v[248:251]
    ds_read_b128 v[20:23], v1 offset:25536
    v_exp_f32 v201, v201
    v_max3_f32 v15, v15, v202, v203
    v_mfma_f32_16x16x32_bf16 v[248:251], v[28:31], v[100:103], v[248:251]
    v_fma_f32 v204, v204, s31, v13
    v_fma_f32 v205, v205, s31, v13
    v_exp_f32 v202, v202
    v_mfma_f32_16x16x32_bf16 v[240:243], v[24:27], v[88:91], v[240:243]
    v_exp_f32 v203, v203
    v_cvt_pk_bf16_f32 v196, v200, v201
    v_max3_f32 v15, v15, v204, v205
    v_mfma_f32_16x16x32_bf16 v[240:243], v[28:31], v[96:99], v[240:243]
    ds_read_b128 v[24:27], v1 offset:25600
    v_fma_f32 v206, v206, s31, v13
    v_fma_f32 v207, v207, s31, v13
    s_waitcnt lgkmcnt(3)
    v_mfma_f32_16x16x32_bf16 v[244:247], v[32:35], v[40:43], 0
    ds_read_b128 v[28:31], v1 offset:25664
    v_exp_f32 v204, v204
    v_cvt_pk_bf16_f32 v197, v202, v203
    v_mfma_f32_16x16x32_bf16 v[244:247], v[36:39], v[48:51], v[244:247]
    v_exp_f32 v205, v205
    v_max3_f32 v15, v15, v206, v207
    v_cvt_pk_bf16_f32 v198, v204, v205
    v_mfma_f32_16x16x32_bf16 v[252:255], v[32:35], v[44:47], 0
    v_exp_f32 v206, v206
    v_exp_f32 v207, v207
    v_mfma_f32_16x16x32_bf16 v[252:255], v[36:39], v[52:55], v[252:255]
    ds_read_b128 v[32:35], v1 offset:25728
    v_cvt_pk_bf16_f32 v199, v206, v207
    s_waitcnt lgkmcnt(3)
    v_mfma_f32_16x16x32_bf16 v[252:255], v[16:19], v[60:63], v[252:255]
    ds_read_b128 v[36:39], v1 offset:25792
    v_mfma_f32_16x16x32_bf16 v[252:255], v[20:23], v[68:71], v[252:255]
    v_mfma_f32_16x16x32_bf16 v[244:247], v[16:19], v[56:59], v[244:247]
    v_mfma_f32_16x16x32_bf16 v[244:247], v[20:23], v[64:67], v[244:247]
    s_barrier
    ds_read_b128 v[16:19], v1 offset:33792
    s_waitcnt lgkmcnt(3)
    v_mfma_f32_16x16x32_bf16 v[244:247], v[24:27], v[72:75], v[244:247]
    ds_read_b128 v[20:23], v1 offset:33856
    v_mfma_f32_16x16x32_bf16 v[244:247], v[28:31], v[80:83], v[244:247]
    v_mfma_f32_16x16x32_bf16 v[252:255], v[24:27], v[76:79], v[252:255]
    v_mfma_f32_16x16x32_bf16 v[252:255], v[28:31], v[84:87], v[252:255]
    ds_read_b128 v[24:27], v1 offset:33920
    s_waitcnt lgkmcnt(3)
    v_mfma_f32_16x16x32_bf16 v[252:255], v[32:35], v[92:95], v[252:255]
    ds_read_b128 v[28:31], v1 offset:33984
    v_mfma_f32_16x16x32_bf16 v[252:255], v[36:39], v[100:103], v[252:255]
    v_mfma_f32_16x16x32_bf16 v[244:247], v[32:35], v[88:91], v[244:247]
    v_mfma_f32_16x16x32_bf16 v[244:247], v[36:39], v[96:99], v[244:247]
    ds_read_b128 v[32:35], v1 offset:34048
    s_waitcnt lgkmcnt(3)
    v_mfma_f32_16x16x32_bf16 v[208:211], v[16:19], v[40:43], 0
    ds_read_b128 v[36:39], v1 offset:34112
    v_fma_f32 v240, v240, s31, v12
    v_fma_f32 v241, v241, s31, v12
    v_max3_f32 v14, v14, v240, v241
    v_mfma_f32_16x16x32_bf16 v[208:211], v[20:23], v[48:51], v[208:211]
    v_fma_f32 v242, v242, s31, v12
    v_fma_f32 v243, v243, s31, v12
    v_exp_f32 v240, v240
    v_mfma_f32_16x16x32_bf16 v[216:219], v[16:19], v[44:47], 0
    v_exp_f32 v241, v241
    v_max3_f32 v14, v14, v242, v243
    v_fma_f32 v244, v244, s31, v12
    v_mfma_f32_16x16x32_bf16 v[216:219], v[20:23], v[52:55], v[216:219]
    ds_read_b128 v[16:19], v1 offset:34176
    v_fma_f32 v245, v245, s31, v12
    v_cvt_pk_bf16_f32 v200, v240, v241
    s_waitcnt lgkmcnt(3)
    v_mfma_f32_16x16x32_bf16 v[216:219], v[24:27], v[60:63], v[216:219]
    ds_read_b128 v[20:23], v1 offset:34240
    v_exp_f32 v242, v242
    v_max3_f32 v14, v14, v244, v245
    v_mfma_f32_16x16x32_bf16 v[216:219], v[28:31], v[68:71], v[216:219]
    v_exp_f32 v243, v243
    v_fma_f32 v246, v246, s31, v12
    v_fma_f32 v247, v247, s31, v12
    v_mfma_f32_16x16x32_bf16 v[208:211], v[24:27], v[56:59], v[208:211]
    v_exp_f32 v244, v244
    v_exp_f32 v245, v245
    v_mfma_f32_16x16x32_bf16 v[208:211], v[28:31], v[64:67], v[208:211]
    ds_read_b128 v[24:27], v1 offset:42240
    v_cvt_pk_bf16_f32 v201, v242, v243
    v_max3_f32 v14, v14, v246, v247
    s_waitcnt lgkmcnt(3)
    v_mfma_f32_16x16x32_bf16 v[208:211], v[32:35], v[72:75], v[208:211]
    ds_read_b128 v[28:31], v1 offset:42304
    v_fma_f32 v248, v248, s31, v13
    v_fma_f32 v249, v249, s31, v13
    v_cvt_pk_bf16_f32 v202, v244, v245
    v_mfma_f32_16x16x32_bf16 v[208:211], v[36:39], v[80:83], v[208:211]
    v_exp_f32 v246, v246
    v_exp_f32 v247, v247
    v_mfma_f32_16x16x32_bf16 v[216:219], v[32:35], v[76:79], v[216:219]
    v_max3_f32 v15, v15, v248, v249
    v_fma_f32 v250, v250, s31, v13
    v_fma_f32 v251, v251, s31, v13
    v_cvt_pk_bf16_f32 v203, v246, v247
    v_mfma_f32_16x16x32_bf16 v[216:219], v[36:39], v[84:87], v[216:219]
    ds_read_b128 v[32:35], v1 offset:42368
    v_exp_f32 v248, v248
    s_waitcnt lgkmcnt(3)
    v_mfma_f32_16x16x32_bf16 v[216:219], v[16:19], v[92:95], v[216:219]
    ds_read_b128 v[36:39], v1 offset:42432
    v_exp_f32 v249, v249
    v_max3_f32 v15, v15, v250, v251
    v_mfma_f32_16x16x32_bf16 v[216:219], v[20:23], v[100:103], v[216:219]
    v_fma_f32 v252, v252, s31, v13
    v_fma_f32 v253, v253, s31, v13
    v_exp_f32 v250, v250
    v_mfma_f32_16x16x32_bf16 v[208:211], v[16:19], v[88:91], v[208:211]
    v_exp_f32 v251, v251
    v_cvt_pk_bf16_f32 v204, v248, v249
    v_max3_f32 v15, v15, v252, v253
    v_mfma_f32_16x16x32_bf16 v[208:211], v[20:23], v[96:99], v[208:211]
    ds_read_b128 v[16:19], v1 offset:42496
    v_fma_f32 v254, v254, s31, v13
    v_fma_f32 v255, v255, s31, v13
    s_waitcnt lgkmcnt(3)
    v_mfma_f32_16x16x32_bf16 v[212:215], v[24:27], v[40:43], 0
    ds_read_b128 v[20:23], v1 offset:42560
    v_exp_f32 v252, v252
    v_cvt_pk_bf16_f32 v205, v250, v251
    v_mfma_f32_16x16x32_bf16 v[212:215], v[28:31], v[48:51], v[212:215]
    v_exp_f32 v253, v253
    v_max3_f32 v15, v15, v254, v255
    v_cvt_pk_bf16_f32 v206, v252, v253
    v_mfma_f32_16x16x32_bf16 v[220:223], v[24:27], v[44:47], 0
    v_exp_f32 v254, v254
    v_exp_f32 v255, v255
    v_mfma_f32_16x16x32_bf16 v[220:223], v[28:31], v[52:55], v[220:223]
    ds_read_b128 v[24:27], v1 offset:42624
    v_cvt_pk_bf16_f32 v207, v254, v255
    s_waitcnt lgkmcnt(3)
    v_mfma_f32_16x16x32_bf16 v[220:223], v[32:35], v[60:63], v[220:223]
    ds_read_b128 v[28:31], v1 offset:42688
    v_mfma_f32_16x16x32_bf16 v[220:223], v[36:39], v[68:71], v[220:223]
    v_mfma_f32_16x16x32_bf16 v[212:215], v[32:35], v[56:59], v[212:215]
    v_mfma_f32_16x16x32_bf16 v[212:215], v[36:39], v[64:67], v[212:215]
    s_barrier
    ds_read_b128 v[32:35], v1 offset:50688
    s_waitcnt lgkmcnt(3)
    v_mfma_f32_16x16x32_bf16 v[212:215], v[16:19], v[72:75], v[212:215]
    ds_read_b128 v[36:39], v1 offset:50752
    v_mfma_f32_16x16x32_bf16 v[212:215], v[20:23], v[80:83], v[212:215]
    v_mfma_f32_16x16x32_bf16 v[220:223], v[16:19], v[76:79], v[220:223]
    v_mfma_f32_16x16x32_bf16 v[220:223], v[20:23], v[84:87], v[220:223]
    ds_read_b128 v[16:19], v1 offset:50816
    s_waitcnt lgkmcnt(3)
    v_mfma_f32_16x16x32_bf16 v[220:223], v[24:27], v[92:95], v[220:223]
    ds_read_b128 v[20:23], v1 offset:50880
    v_mfma_f32_16x16x32_bf16 v[220:223], v[28:31], v[100:103], v[220:223]
    v_mfma_f32_16x16x32_bf16 v[212:215], v[24:27], v[88:91], v[212:215]
    v_mfma_f32_16x16x32_bf16 v[212:215], v[28:31], v[96:99], v[212:215]
    ds_read_b128 v[24:27], v1 offset:50944
    s_waitcnt lgkmcnt(3)
    v_mfma_f32_16x16x32_bf16 v[240:243], v[32:35], v[40:43], 0
    ds_read_b128 v[28:31], v1 offset:51008
    v_fma_f32 v208, v208, s31, v12
    v_fma_f32 v209, v209, s31, v12
    v_max3_f32 v14, v14, v208, v209
    v_mfma_f32_16x16x32_bf16 v[240:243], v[36:39], v[48:51], v[240:243]
    v_fma_f32 v210, v210, s31, v12
    v_fma_f32 v211, v211, s31, v12
    v_exp_f32 v208, v208
    v_mfma_f32_16x16x32_bf16 v[248:251], v[32:35], v[44:47], 0
    v_exp_f32 v209, v209
    v_max3_f32 v14, v14, v210, v211
    v_fma_f32 v212, v212, s31, v12
    v_mfma_f32_16x16x32_bf16 v[248:251], v[36:39], v[52:55], v[248:251]
    ds_read_b128 v[32:35], v1 offset:51072
    v_fma_f32 v213, v213, s31, v12
    v_cvt_pk_bf16_f32 v128, v208, v209
    s_waitcnt lgkmcnt(3)
    v_mfma_f32_16x16x32_bf16 v[248:251], v[16:19], v[60:63], v[248:251]
    ds_read_b128 v[36:39], v1 offset:51136
    v_exp_f32 v210, v210
    v_max3_f32 v14, v14, v212, v213
    v_mfma_f32_16x16x32_bf16 v[248:251], v[20:23], v[68:71], v[248:251]
    v_exp_f32 v211, v211
    v_fma_f32 v214, v214, s31, v12
    v_fma_f32 v215, v215, s31, v12
    v_mfma_f32_16x16x32_bf16 v[240:243], v[16:19], v[56:59], v[240:243]
    v_exp_f32 v212, v212
    v_exp_f32 v213, v213
    v_mfma_f32_16x16x32_bf16 v[240:243], v[20:23], v[64:67], v[240:243]
    ds_read_b128 v[16:19], v1 offset:59136
    v_cvt_pk_bf16_f32 v129, v210, v211
    v_max3_f32 v14, v14, v214, v215
    s_waitcnt lgkmcnt(3)
    v_mfma_f32_16x16x32_bf16 v[240:243], v[24:27], v[72:75], v[240:243]
    ds_read_b128 v[20:23], v1 offset:59200
    v_fma_f32 v216, v216, s31, v13
    v_fma_f32 v217, v217, s31, v13
    v_cvt_pk_bf16_f32 v130, v212, v213
    v_mfma_f32_16x16x32_bf16 v[240:243], v[28:31], v[80:83], v[240:243]
    v_exp_f32 v214, v214
    v_exp_f32 v215, v215
    v_mfma_f32_16x16x32_bf16 v[248:251], v[24:27], v[76:79], v[248:251]
    v_max3_f32 v15, v15, v216, v217
    v_fma_f32 v218, v218, s31, v13
    v_fma_f32 v219, v219, s31, v13
    v_cvt_pk_bf16_f32 v131, v214, v215
    v_mfma_f32_16x16x32_bf16 v[248:251], v[28:31], v[84:87], v[248:251]
    ds_read_b128 v[24:27], v1 offset:59264
    v_exp_f32 v216, v216
    s_waitcnt lgkmcnt(3)
    v_mfma_f32_16x16x32_bf16 v[248:251], v[32:35], v[92:95], v[248:251]
    ds_read_b128 v[28:31], v1 offset:59328
    v_exp_f32 v217, v217
    v_max3_f32 v15, v15, v218, v219
    v_mfma_f32_16x16x32_bf16 v[248:251], v[36:39], v[100:103], v[248:251]
    v_fma_f32 v220, v220, s31, v13
    v_fma_f32 v221, v221, s31, v13
    v_exp_f32 v218, v218
    v_mfma_f32_16x16x32_bf16 v[240:243], v[32:35], v[88:91], v[240:243]
    v_exp_f32 v219, v219
    v_cvt_pk_bf16_f32 v132, v216, v217
    v_max3_f32 v15, v15, v220, v221
    v_mfma_f32_16x16x32_bf16 v[240:243], v[36:39], v[96:99], v[240:243]
    ds_read_b128 v[32:35], v1 offset:59392
    v_fma_f32 v222, v222, s31, v13
    v_fma_f32 v223, v223, s31, v13
    s_waitcnt lgkmcnt(3)
    v_mfma_f32_16x16x32_bf16 v[244:247], v[16:19], v[40:43], 0
    ds_read_b128 v[36:39], v1 offset:59456
    v_exp_f32 v220, v220
    v_cvt_pk_bf16_f32 v133, v218, v219
    v_mfma_f32_16x16x32_bf16 v[244:247], v[20:23], v[48:51], v[244:247]
    v_exp_f32 v221, v221
    v_max3_f32 v15, v15, v222, v223
    v_cvt_pk_bf16_f32 v134, v220, v221
    v_mfma_f32_16x16x32_bf16 v[252:255], v[16:19], v[44:47], 0
    v_exp_f32 v222, v222
    v_exp_f32 v223, v223
    v_mfma_f32_16x16x32_bf16 v[252:255], v[20:23], v[52:55], v[252:255]
    ds_read_b128 v[16:19], v1 offset:59520
    v_cvt_pk_bf16_f32 v135, v222, v223
    s_waitcnt lgkmcnt(3)
    v_mfma_f32_16x16x32_bf16 v[252:255], v[24:27], v[60:63], v[252:255]
    ds_read_b128 v[20:23], v1 offset:59584
    v_mfma_f32_16x16x32_bf16 v[252:255], v[28:31], v[68:71], v[252:255]
    v_mfma_f32_16x16x32_bf16 v[244:247], v[24:27], v[56:59], v[244:247]
    v_mfma_f32_16x16x32_bf16 v[244:247], v[28:31], v[64:67], v[244:247]
    s_barrier
    v_add_u32 v1, 67584, v1
    ds_read_b128 v[24:27], v1 offset:0
    s_waitcnt lgkmcnt(3)
    v_mfma_f32_16x16x32_bf16 v[244:247], v[32:35], v[72:75], v[244:247]
    ds_read_b128 v[28:31], v1 offset:64
    v_mfma_f32_16x16x32_bf16 v[244:247], v[36:39], v[80:83], v[244:247]
    v_mfma_f32_16x16x32_bf16 v[252:255], v[32:35], v[76:79], v[252:255]
    v_mfma_f32_16x16x32_bf16 v[252:255], v[36:39], v[84:87], v[252:255]
    ds_read_b128 v[32:35], v1 offset:128
    s_waitcnt lgkmcnt(3)
    v_mfma_f32_16x16x32_bf16 v[252:255], v[16:19], v[92:95], v[252:255]
    ds_read_b128 v[36:39], v1 offset:192
    v_mfma_f32_16x16x32_bf16 v[252:255], v[20:23], v[100:103], v[252:255]
    v_mfma_f32_16x16x32_bf16 v[244:247], v[16:19], v[88:91], v[244:247]
    v_mfma_f32_16x16x32_bf16 v[244:247], v[20:23], v[96:99], v[244:247]
    ds_read_b128 v[16:19], v1 offset:256
    s_waitcnt lgkmcnt(3)
    v_mfma_f32_16x16x32_bf16 v[208:211], v[24:27], v[40:43], 0
    ds_read_b128 v[20:23], v1 offset:320
    v_fma_f32 v240, v240, s31, v12
    v_fma_f32 v241, v241, s31, v12
    v_max3_f32 v14, v14, v240, v241
    v_mfma_f32_16x16x32_bf16 v[208:211], v[28:31], v[48:51], v[208:211]
    v_fma_f32 v242, v242, s31, v12
    v_fma_f32 v243, v243, s31, v12
    v_exp_f32 v240, v240
    v_mfma_f32_16x16x32_bf16 v[216:219], v[24:27], v[44:47], 0
    v_exp_f32 v241, v241
    v_max3_f32 v14, v14, v242, v243
    v_fma_f32 v244, v244, s31, v12
    v_mfma_f32_16x16x32_bf16 v[216:219], v[28:31], v[52:55], v[216:219]
    ds_read_b128 v[24:27], v1 offset:384
    v_fma_f32 v245, v245, s31, v12
    v_cvt_pk_bf16_f32 v136, v240, v241
    s_waitcnt lgkmcnt(3)
    v_mfma_f32_16x16x32_bf16 v[216:219], v[32:35], v[60:63], v[216:219]
    ds_read_b128 v[28:31], v1 offset:448
    v_exp_f32 v242, v242
    v_max3_f32 v14, v14, v244, v245
    v_mfma_f32_16x16x32_bf16 v[216:219], v[36:39], v[68:71], v[216:219]
    v_exp_f32 v243, v243
    v_fma_f32 v246, v246, s31, v12
    v_fma_f32 v247, v247, s31, v12
    v_mfma_f32_16x16x32_bf16 v[208:211], v[32:35], v[56:59], v[208:211]
    v_exp_f32 v244, v244
    v_exp_f32 v245, v245
    v_mfma_f32_16x16x32_bf16 v[208:211], v[36:39], v[64:67], v[208:211]
    ds_read_b128 v[32:35], v1 offset:8448
    v_cvt_pk_bf16_f32 v137, v242, v243
    v_max3_f32 v14, v14, v246, v247
    s_waitcnt lgkmcnt(3)
    v_mfma_f32_16x16x32_bf16 v[208:211], v[16:19], v[72:75], v[208:211]
    ds_read_b128 v[36:39], v1 offset:8512
    v_fma_f32 v248, v248, s31, v13
    v_fma_f32 v249, v249, s31, v13
    v_cvt_pk_bf16_f32 v138, v244, v245
    v_mfma_f32_16x16x32_bf16 v[208:211], v[20:23], v[80:83], v[208:211]
    v_exp_f32 v246, v246
    v_exp_f32 v247, v247
    v_mfma_f32_16x16x32_bf16 v[216:219], v[16:19], v[76:79], v[216:219]
    v_max3_f32 v15, v15, v248, v249
    v_fma_f32 v250, v250, s31, v13
    v_fma_f32 v251, v251, s31, v13
    v_cvt_pk_bf16_f32 v139, v246, v247
    v_mfma_f32_16x16x32_bf16 v[216:219], v[20:23], v[84:87], v[216:219]
    ds_read_b128 v[16:19], v1 offset:8576
    v_exp_f32 v248, v248
    s_waitcnt lgkmcnt(3)
    v_mfma_f32_16x16x32_bf16 v[216:219], v[24:27], v[92:95], v[216:219]
    ds_read_b128 v[20:23], v1 offset:8640
    v_exp_f32 v249, v249
    v_max3_f32 v15, v15, v250, v251
    v_mfma_f32_16x16x32_bf16 v[216:219], v[28:31], v[100:103], v[216:219]
    v_fma_f32 v252, v252, s31, v13
    v_fma_f32 v253, v253, s31, v13
    v_exp_f32 v250, v250
    v_mfma_f32_16x16x32_bf16 v[208:211], v[24:27], v[88:91], v[208:211]
    v_exp_f32 v251, v251
    v_cvt_pk_bf16_f32 v140, v248, v249
    v_max3_f32 v15, v15, v252, v253
    v_mfma_f32_16x16x32_bf16 v[208:211], v[28:31], v[96:99], v[208:211]
    ds_read_b128 v[24:27], v1 offset:8704
    v_fma_f32 v254, v254, s31, v13
    v_fma_f32 v255, v255, s31, v13
    s_waitcnt lgkmcnt(3)
    v_mfma_f32_16x16x32_bf16 v[212:215], v[32:35], v[40:43], 0
    ds_read_b128 v[28:31], v1 offset:8768
    v_exp_f32 v252, v252
    v_cvt_pk_bf16_f32 v141, v250, v251
    v_mfma_f32_16x16x32_bf16 v[212:215], v[36:39], v[48:51], v[212:215]
    v_exp_f32 v253, v253
    v_max3_f32 v15, v15, v254, v255
    v_cvt_pk_bf16_f32 v142, v252, v253
    v_mfma_f32_16x16x32_bf16 v[220:223], v[32:35], v[44:47], 0
    v_exp_f32 v254, v254
    v_exp_f32 v255, v255
    v_mfma_f32_16x16x32_bf16 v[220:223], v[36:39], v[52:55], v[220:223]
    ds_read_b128 v[32:35], v1 offset:8832
    v_cvt_pk_bf16_f32 v143, v254, v255
    s_waitcnt lgkmcnt(3)
    v_mfma_f32_16x16x32_bf16 v[220:223], v[16:19], v[60:63], v[220:223]
    ds_read_b128 v[36:39], v1 offset:8896
    v_mfma_f32_16x16x32_bf16 v[220:223], v[20:23], v[68:71], v[220:223]
    v_mfma_f32_16x16x32_bf16 v[212:215], v[16:19], v[56:59], v[212:215]
    v_mfma_f32_16x16x32_bf16 v[212:215], v[20:23], v[64:67], v[212:215]
    ds_read_b128 v[16:19], v1 offset:16896
    s_waitcnt lgkmcnt(3)
    v_mfma_f32_16x16x32_bf16 v[212:215], v[24:27], v[72:75], v[212:215]
    ds_read_b128 v[20:23], v1 offset:16960
    v_mfma_f32_16x16x32_bf16 v[212:215], v[28:31], v[80:83], v[212:215]
    v_mfma_f32_16x16x32_bf16 v[220:223], v[24:27], v[76:79], v[220:223]
    v_mfma_f32_16x16x32_bf16 v[220:223], v[28:31], v[84:87], v[220:223]
    ds_read_b128 v[24:27], v1 offset:17024
    s_waitcnt lgkmcnt(3)
    v_mfma_f32_16x16x32_bf16 v[220:223], v[32:35], v[92:95], v[220:223]
    ds_read_b128 v[28:31], v1 offset:17088
    v_mfma_f32_16x16x32_bf16 v[220:223], v[36:39], v[100:103], v[220:223]
    v_mfma_f32_16x16x32_bf16 v[212:215], v[32:35], v[88:91], v[212:215]
    v_mfma_f32_16x16x32_bf16 v[212:215], v[36:39], v[96:99], v[212:215]
    ds_read_b128 v[32:35], v1 offset:17152
    s_waitcnt lgkmcnt(3)
    v_mfma_f32_16x16x32_bf16 v[240:243], v[16:19], v[40:43], 0
    ds_read_b128 v[36:39], v1 offset:17216
    v_fma_f32 v208, v208, s31, v12
    v_fma_f32 v209, v209, s31, v12
    v_max3_f32 v14, v14, v208, v209
    v_mfma_f32_16x16x32_bf16 v[240:243], v[20:23], v[48:51], v[240:243]
    v_fma_f32 v210, v210, s31, v12
    v_fma_f32 v211, v211, s31, v12
    v_exp_f32 v208, v208
    v_mfma_f32_16x16x32_bf16 v[248:251], v[16:19], v[44:47], 0
    v_exp_f32 v209, v209
    v_max3_f32 v14, v14, v210, v211
    v_fma_f32 v212, v212, s31, v12
    v_mfma_f32_16x16x32_bf16 v[248:251], v[20:23], v[52:55], v[248:251]
    ds_read_b128 v[16:19], v1 offset:17280
    v_fma_f32 v213, v213, s31, v12
    v_cvt_pk_bf16_f32 v144, v208, v209
    s_waitcnt lgkmcnt(3)
    v_mfma_f32_16x16x32_bf16 v[248:251], v[24:27], v[60:63], v[248:251]
    ds_read_b128 v[20:23], v1 offset:17344
    v_exp_f32 v210, v210
    v_max3_f32 v14, v14, v212, v213
    v_mfma_f32_16x16x32_bf16 v[248:251], v[28:31], v[68:71], v[248:251]
    v_exp_f32 v211, v211
    v_fma_f32 v214, v214, s31, v12
    v_fma_f32 v215, v215, s31, v12
    v_mfma_f32_16x16x32_bf16 v[240:243], v[24:27], v[56:59], v[240:243]
    v_exp_f32 v212, v212
    v_exp_f32 v213, v213
    v_mfma_f32_16x16x32_bf16 v[240:243], v[28:31], v[64:67], v[240:243]
    ds_read_b128 v[24:27], v1 offset:25344
    v_cvt_pk_bf16_f32 v145, v210, v211
    v_max3_f32 v14, v14, v214, v215
    s_waitcnt lgkmcnt(3)
    v_mfma_f32_16x16x32_bf16 v[240:243], v[32:35], v[72:75], v[240:243]
    ds_read_b128 v[28:31], v1 offset:25408
    v_fma_f32 v216, v216, s31, v13
    v_fma_f32 v217, v217, s31, v13
    v_cvt_pk_bf16_f32 v146, v212, v213
    v_mfma_f32_16x16x32_bf16 v[240:243], v[36:39], v[80:83], v[240:243]
    v_exp_f32 v214, v214
    v_exp_f32 v215, v215
    v_mfma_f32_16x16x32_bf16 v[248:251], v[32:35], v[76:79], v[248:251]
    v_max3_f32 v15, v15, v216, v217
    v_fma_f32 v218, v218, s31, v13
    v_fma_f32 v219, v219, s31, v13
    v_cvt_pk_bf16_f32 v147, v214, v215
    v_mfma_f32_16x16x32_bf16 v[248:251], v[36:39], v[84:87], v[248:251]
    ds_read_b128 v[32:35], v1 offset:25472
    v_exp_f32 v216, v216
    s_waitcnt lgkmcnt(3)
    v_mfma_f32_16x16x32_bf16 v[248:251], v[16:19], v[92:95], v[248:251]
    ds_read_b128 v[36:39], v1 offset:25536
    v_exp_f32 v217, v217
    v_max3_f32 v15, v15, v218, v219
    v_mfma_f32_16x16x32_bf16 v[248:251], v[20:23], v[100:103], v[248:251]
    v_fma_f32 v220, v220, s31, v13
    v_fma_f32 v221, v221, s31, v13
    v_exp_f32 v218, v218
    v_mfma_f32_16x16x32_bf16 v[240:243], v[16:19], v[88:91], v[240:243]
    v_exp_f32 v219, v219
    v_cvt_pk_bf16_f32 v148, v216, v217
    v_max3_f32 v15, v15, v220, v221
    v_mfma_f32_16x16x32_bf16 v[240:243], v[20:23], v[96:99], v[240:243]
    ds_read_b128 v[16:19], v1 offset:25600
    v_fma_f32 v222, v222, s31, v13
    v_fma_f32 v223, v223, s31, v13
    s_waitcnt lgkmcnt(3)
    v_mfma_f32_16x16x32_bf16 v[244:247], v[24:27], v[40:43], 0
    ds_read_b128 v[20:23], v1 offset:25664
    v_exp_f32 v220, v220
    v_cvt_pk_bf16_f32 v149, v218, v219
    v_mfma_f32_16x16x32_bf16 v[244:247], v[28:31], v[48:51], v[244:247]
    v_exp_f32 v221, v221
    v_max3_f32 v15, v15, v222, v223
    v_cvt_pk_bf16_f32 v150, v220, v221
    v_mfma_f32_16x16x32_bf16 v[252:255], v[24:27], v[44:47], 0
    v_exp_f32 v222, v222
    v_exp_f32 v223, v223
    v_mfma_f32_16x16x32_bf16 v[252:255], v[28:31], v[52:55], v[252:255]
    ds_read_b128 v[24:27], v1 offset:25728
    v_cvt_pk_bf16_f32 v151, v222, v223
    s_waitcnt lgkmcnt(3)
    v_mfma_f32_16x16x32_bf16 v[252:255], v[32:35], v[60:63], v[252:255]
    ds_read_b128 v[28:31], v1 offset:25792
    v_mfma_f32_16x16x32_bf16 v[252:255], v[36:39], v[68:71], v[252:255]
    v_mfma_f32_16x16x32_bf16 v[244:247], v[32:35], v[56:59], v[244:247]
    v_mfma_f32_16x16x32_bf16 v[244:247], v[36:39], v[64:67], v[244:247]
    s_barrier
    ds_read_b128 v[32:35], v1 offset:33792
    s_waitcnt lgkmcnt(3)
    v_mfma_f32_16x16x32_bf16 v[244:247], v[16:19], v[72:75], v[244:247]
    ds_read_b128 v[36:39], v1 offset:33856
    v_mfma_f32_16x16x32_bf16 v[244:247], v[20:23], v[80:83], v[244:247]
    v_mfma_f32_16x16x32_bf16 v[252:255], v[16:19], v[76:79], v[252:255]
    v_mfma_f32_16x16x32_bf16 v[252:255], v[20:23], v[84:87], v[252:255]
    ds_read_b128 v[16:19], v1 offset:33920
    s_waitcnt lgkmcnt(3)
    v_mfma_f32_16x16x32_bf16 v[252:255], v[24:27], v[92:95], v[252:255]
    ds_read_b128 v[20:23], v1 offset:33984
    v_mfma_f32_16x16x32_bf16 v[252:255], v[28:31], v[100:103], v[252:255]
    v_mfma_f32_16x16x32_bf16 v[244:247], v[24:27], v[88:91], v[244:247]
    v_mfma_f32_16x16x32_bf16 v[244:247], v[28:31], v[96:99], v[244:247]
    ds_read_b128 v[24:27], v1 offset:34048
    s_waitcnt lgkmcnt(3)
    v_mfma_f32_16x16x32_bf16 v[208:211], v[32:35], v[40:43], 0
    ds_read_b128 v[28:31], v1 offset:34112
    v_fma_f32 v240, v240, s31, v12
    v_fma_f32 v241, v241, s31, v12
    v_max3_f32 v14, v14, v240, v241
    v_mfma_f32_16x16x32_bf16 v[208:211], v[36:39], v[48:51], v[208:211]
    v_fma_f32 v242, v242, s31, v12
    v_fma_f32 v243, v243, s31, v12
    v_exp_f32 v240, v240
    v_mfma_f32_16x16x32_bf16 v[216:219], v[32:35], v[44:47], 0
    v_exp_f32 v241, v241
    v_max3_f32 v14, v14, v242, v243
    v_fma_f32 v244, v244, s31, v12
    v_mfma_f32_16x16x32_bf16 v[216:219], v[36:39], v[52:55], v[216:219]
    ds_read_b128 v[32:35], v1 offset:34176
    v_fma_f32 v245, v245, s31, v12
    v_cvt_pk_bf16_f32 v152, v240, v241
    s_waitcnt lgkmcnt(3)
    v_mfma_f32_16x16x32_bf16 v[216:219], v[16:19], v[60:63], v[216:219]
    ds_read_b128 v[36:39], v1 offset:34240
    v_exp_f32 v242, v242
    v_max3_f32 v14, v14, v244, v245
    v_mfma_f32_16x16x32_bf16 v[216:219], v[20:23], v[68:71], v[216:219]
    v_exp_f32 v243, v243
    v_fma_f32 v246, v246, s31, v12
    v_fma_f32 v247, v247, s31, v12
    v_mfma_f32_16x16x32_bf16 v[208:211], v[16:19], v[56:59], v[208:211]
    v_exp_f32 v244, v244
    v_exp_f32 v245, v245
    v_mfma_f32_16x16x32_bf16 v[208:211], v[20:23], v[64:67], v[208:211]
    ds_read_b128 v[16:19], v1 offset:42240
    v_cvt_pk_bf16_f32 v153, v242, v243
    v_max3_f32 v14, v14, v246, v247
    s_waitcnt lgkmcnt(3)
    v_mfma_f32_16x16x32_bf16 v[208:211], v[24:27], v[72:75], v[208:211]
    ds_read_b128 v[20:23], v1 offset:42304
    v_fma_f32 v248, v248, s31, v13
    v_fma_f32 v249, v249, s31, v13
    v_cvt_pk_bf16_f32 v154, v244, v245
    v_mfma_f32_16x16x32_bf16 v[208:211], v[28:31], v[80:83], v[208:211]
    v_exp_f32 v246, v246
    v_exp_f32 v247, v247
    v_mfma_f32_16x16x32_bf16 v[216:219], v[24:27], v[76:79], v[216:219]
    v_max3_f32 v15, v15, v248, v249
    v_fma_f32 v250, v250, s31, v13
    v_fma_f32 v251, v251, s31, v13
    v_cvt_pk_bf16_f32 v155, v246, v247
    v_mfma_f32_16x16x32_bf16 v[216:219], v[28:31], v[84:87], v[216:219]
    ds_read_b128 v[24:27], v1 offset:42368
    v_exp_f32 v248, v248
    s_waitcnt lgkmcnt(3)
    v_mfma_f32_16x16x32_bf16 v[216:219], v[32:35], v[92:95], v[216:219]
    ds_read_b128 v[28:31], v1 offset:42432
    v_exp_f32 v249, v249
    v_max3_f32 v15, v15, v250, v251
    v_mfma_f32_16x16x32_bf16 v[216:219], v[36:39], v[100:103], v[216:219]
    v_fma_f32 v252, v252, s31, v13
    v_fma_f32 v253, v253, s31, v13
    v_exp_f32 v250, v250
    v_mfma_f32_16x16x32_bf16 v[208:211], v[32:35], v[88:91], v[208:211]
    v_exp_f32 v251, v251
    v_cvt_pk_bf16_f32 v156, v248, v249
    v_max3_f32 v15, v15, v252, v253
    v_mfma_f32_16x16x32_bf16 v[208:211], v[36:39], v[96:99], v[208:211]
    ds_read_b128 v[32:35], v1 offset:42496
    v_fma_f32 v254, v254, s31, v13
    v_fma_f32 v255, v255, s31, v13
    s_waitcnt lgkmcnt(3)
    v_mfma_f32_16x16x32_bf16 v[212:215], v[16:19], v[40:43], 0
    ds_read_b128 v[36:39], v1 offset:42560
    v_exp_f32 v252, v252
    v_cvt_pk_bf16_f32 v157, v250, v251
    v_mfma_f32_16x16x32_bf16 v[212:215], v[20:23], v[48:51], v[212:215]
    v_exp_f32 v253, v253
    v_max3_f32 v15, v15, v254, v255
    v_cvt_pk_bf16_f32 v158, v252, v253
    v_mfma_f32_16x16x32_bf16 v[220:223], v[16:19], v[44:47], 0
    v_exp_f32 v254, v254
    v_exp_f32 v255, v255
    v_mfma_f32_16x16x32_bf16 v[220:223], v[20:23], v[52:55], v[220:223]
    ds_read_b128 v[16:19], v1 offset:42624
    v_cvt_pk_bf16_f32 v159, v254, v255
    s_waitcnt lgkmcnt(3)
    v_mfma_f32_16x16x32_bf16 v[220:223], v[24:27], v[60:63], v[220:223]
    ds_read_b128 v[20:23], v1 offset:42688
    v_mfma_f32_16x16x32_bf16 v[220:223], v[28:31], v[68:71], v[220:223]
    v_mfma_f32_16x16x32_bf16 v[212:215], v[24:27], v[56:59], v[212:215]
    v_mfma_f32_16x16x32_bf16 v[212:215], v[28:31], v[64:67], v[212:215]
    ds_read_b128 v[24:27], v1 offset:50688
    s_waitcnt lgkmcnt(3)
    v_mfma_f32_16x16x32_bf16 v[212:215], v[32:35], v[72:75], v[212:215]
    ds_read_b128 v[28:31], v1 offset:50752
    v_mfma_f32_16x16x32_bf16 v[212:215], v[36:39], v[80:83], v[212:215]
    v_mfma_f32_16x16x32_bf16 v[220:223], v[32:35], v[76:79], v[220:223]
    v_mfma_f32_16x16x32_bf16 v[220:223], v[36:39], v[84:87], v[220:223]
    ds_read_b128 v[32:35], v1 offset:50816
    s_waitcnt lgkmcnt(3)
    v_mfma_f32_16x16x32_bf16 v[220:223], v[16:19], v[92:95], v[220:223]
    ds_read_b128 v[36:39], v1 offset:50880
    v_mfma_f32_16x16x32_bf16 v[220:223], v[20:23], v[100:103], v[220:223]
    v_mfma_f32_16x16x32_bf16 v[212:215], v[16:19], v[88:91], v[212:215]
    v_mfma_f32_16x16x32_bf16 v[212:215], v[20:23], v[96:99], v[212:215]
    ds_read_b128 v[16:19], v1 offset:50944
    s_waitcnt lgkmcnt(3)
    v_mfma_f32_16x16x32_bf16 v[240:243], v[24:27], v[40:43], 0
    ds_read_b128 v[20:23], v1 offset:51008
    v_fma_f32 v208, v208, s31, v12
    v_fma_f32 v209, v209, s31, v12
    v_max3_f32 v14, v14, v208, v209
    v_mfma_f32_16x16x32_bf16 v[240:243], v[28:31], v[48:51], v[240:243]
    v_fma_f32 v210, v210, s31, v12
    v_fma_f32 v211, v211, s31, v12
    v_exp_f32 v208, v208
    v_mfma_f32_16x16x32_bf16 v[248:251], v[24:27], v[44:47], 0
    v_exp_f32 v209, v209
    v_max3_f32 v14, v14, v210, v211
    v_fma_f32 v212, v212, s31, v12
    v_mfma_f32_16x16x32_bf16 v[248:251], v[28:31], v[52:55], v[248:251]
    ds_read_b128 v[24:27], v1 offset:51072
    v_fma_f32 v213, v213, s31, v12
    v_cvt_pk_bf16_f32 v160, v208, v209
    s_waitcnt lgkmcnt(3)
    v_mfma_f32_16x16x32_bf16 v[248:251], v[32:35], v[60:63], v[248:251]
    ds_read_b128 v[28:31], v1 offset:51136
    v_exp_f32 v210, v210
    v_max3_f32 v14, v14, v212, v213
    v_mfma_f32_16x16x32_bf16 v[248:251], v[36:39], v[68:71], v[248:251]
    v_exp_f32 v211, v211
    v_fma_f32 v214, v214, s31, v12
    v_fma_f32 v215, v215, s31, v12
    v_mfma_f32_16x16x32_bf16 v[240:243], v[32:35], v[56:59], v[240:243]
    v_exp_f32 v212, v212
    v_exp_f32 v213, v213
    v_mfma_f32_16x16x32_bf16 v[240:243], v[36:39], v[64:67], v[240:243]
    ds_read_b128 v[32:35], v1 offset:59136
    v_cvt_pk_bf16_f32 v161, v210, v211
    v_max3_f32 v14, v14, v214, v215
    s_waitcnt lgkmcnt(3)
    v_mfma_f32_16x16x32_bf16 v[240:243], v[16:19], v[72:75], v[240:243]
    ds_read_b128 v[36:39], v1 offset:59200
    v_fma_f32 v216, v216, s31, v13
    v_fma_f32 v217, v217, s31, v13
    v_cvt_pk_bf16_f32 v162, v212, v213
    v_mfma_f32_16x16x32_bf16 v[240:243], v[20:23], v[80:83], v[240:243]
    v_exp_f32 v214, v214
    v_exp_f32 v215, v215
    v_mfma_f32_16x16x32_bf16 v[248:251], v[16:19], v[76:79], v[248:251]
    v_max3_f32 v15, v15, v216, v217
    v_fma_f32 v218, v218, s31, v13
    v_fma_f32 v219, v219, s31, v13
    v_cvt_pk_bf16_f32 v163, v214, v215
    v_mfma_f32_16x16x32_bf16 v[248:251], v[20:23], v[84:87], v[248:251]
    ds_read_b128 v[16:19], v1 offset:59264
    v_exp_f32 v216, v216
    s_waitcnt lgkmcnt(3)
    v_mfma_f32_16x16x32_bf16 v[248:251], v[24:27], v[92:95], v[248:251]
    ds_read_b128 v[20:23], v1 offset:59328
    v_exp_f32 v217, v217
    v_max3_f32 v15, v15, v218, v219
    v_mfma_f32_16x16x32_bf16 v[248:251], v[28:31], v[100:103], v[248:251]
    v_fma_f32 v220, v220, s31, v13
    v_fma_f32 v221, v221, s31, v13
    v_exp_f32 v218, v218
    v_mfma_f32_16x16x32_bf16 v[240:243], v[24:27], v[88:91], v[240:243]
    v_exp_f32 v219, v219
    v_cvt_pk_bf16_f32 v164, v216, v217
    v_max3_f32 v15, v15, v220, v221
    v_mfma_f32_16x16x32_bf16 v[240:243], v[28:31], v[96:99], v[240:243]
    ds_read_b128 v[24:27], v1 offset:59392
    v_fma_f32 v222, v222, s31, v13
    v_fma_f32 v223, v223, s31, v13
    s_waitcnt lgkmcnt(3)
    v_mfma_f32_16x16x32_bf16 v[244:247], v[32:35], v[40:43], 0
    ds_read_b128 v[28:31], v1 offset:59456
    v_exp_f32 v220, v220
    v_cvt_pk_bf16_f32 v165, v218, v219
    v_mfma_f32_16x16x32_bf16 v[244:247], v[36:39], v[48:51], v[244:247]
    v_exp_f32 v221, v221
    v_max3_f32 v15, v15, v222, v223
    v_cvt_pk_bf16_f32 v166, v220, v221
    v_mfma_f32_16x16x32_bf16 v[252:255], v[32:35], v[44:47], 0
    v_exp_f32 v222, v222
    v_exp_f32 v223, v223
    v_mfma_f32_16x16x32_bf16 v[252:255], v[36:39], v[52:55], v[252:255]
    ds_read_b128 v[32:35], v1 offset:59520
    v_cvt_pk_bf16_f32 v167, v222, v223
    s_waitcnt lgkmcnt(3)
    v_mfma_f32_16x16x32_bf16 v[252:255], v[16:19], v[60:63], v[252:255]
    ds_read_b128 v[36:39], v1 offset:59584
    v_mfma_f32_16x16x32_bf16 v[252:255], v[20:23], v[68:71], v[252:255]
    v_mfma_f32_16x16x32_bf16 v[244:247], v[16:19], v[56:59], v[244:247]
    v_mfma_f32_16x16x32_bf16 v[244:247], v[20:23], v[64:67], v[244:247]
    s_barrier
    v_add_u32 v1, 67584, v1
    ds_read_b128 v[16:19], v1 offset:0
    s_waitcnt lgkmcnt(3)
    v_mfma_f32_16x16x32_bf16 v[244:247], v[24:27], v[72:75], v[244:247]
    ds_read_b128 v[20:23], v1 offset:64
    v_mfma_f32_16x16x32_bf16 v[244:247], v[28:31], v[80:83], v[244:247]
    v_mfma_f32_16x16x32_bf16 v[252:255], v[24:27], v[76:79], v[252:255]
    v_mfma_f32_16x16x32_bf16 v[252:255], v[28:31], v[84:87], v[252:255]
    ds_read_b128 v[24:27], v1 offset:128
    s_waitcnt lgkmcnt(3)
    v_mfma_f32_16x16x32_bf16 v[252:255], v[32:35], v[92:95], v[252:255]
    ds_read_b128 v[28:31], v1 offset:192
    v_mfma_f32_16x16x32_bf16 v[252:255], v[36:39], v[100:103], v[252:255]
    v_mfma_f32_16x16x32_bf16 v[244:247], v[32:35], v[88:91], v[244:247]
    v_mfma_f32_16x16x32_bf16 v[244:247], v[36:39], v[96:99], v[244:247]
    ds_read_b128 v[32:35], v1 offset:256
    s_waitcnt lgkmcnt(3)
    v_mfma_f32_16x16x32_bf16 v[208:211], v[16:19], v[40:43], 0
    ds_read_b128 v[36:39], v1 offset:320
    v_fma_f32 v240, v240, s31, v12
    v_fma_f32 v241, v241, s31, v12
    v_max3_f32 v14, v14, v240, v241
    v_mfma_f32_16x16x32_bf16 v[208:211], v[20:23], v[48:51], v[208:211]
    v_fma_f32 v242, v242, s31, v12
    v_fma_f32 v243, v243, s31, v12
    v_exp_f32 v240, v240
    v_mfma_f32_16x16x32_bf16 v[216:219], v[16:19], v[44:47], 0
    v_exp_f32 v241, v241
    v_max3_f32 v14, v14, v242, v243
    v_fma_f32 v244, v244, s31, v12
    v_mfma_f32_16x16x32_bf16 v[216:219], v[20:23], v[52:55], v[216:219]
    ds_read_b128 v[16:19], v1 offset:384
    v_fma_f32 v245, v245, s31, v12
    v_cvt_pk_bf16_f32 v168, v240, v241
    s_waitcnt lgkmcnt(3)
    v_mfma_f32_16x16x32_bf16 v[216:219], v[24:27], v[60:63], v[216:219]
    ds_read_b128 v[20:23], v1 offset:448
    v_exp_f32 v242, v242
    v_max3_f32 v14, v14, v244, v245
    v_mfma_f32_16x16x32_bf16 v[216:219], v[28:31], v[68:71], v[216:219]
    v_exp_f32 v243, v243
    v_fma_f32 v246, v246, s31, v12
    v_fma_f32 v247, v247, s31, v12
    v_mfma_f32_16x16x32_bf16 v[208:211], v[24:27], v[56:59], v[208:211]
    v_exp_f32 v244, v244
    v_exp_f32 v245, v245
    v_mfma_f32_16x16x32_bf16 v[208:211], v[28:31], v[64:67], v[208:211]
    ds_read_b128 v[24:27], v1 offset:8448
    v_cvt_pk_bf16_f32 v169, v242, v243
    v_max3_f32 v14, v14, v246, v247
    s_waitcnt lgkmcnt(3)
    v_mfma_f32_16x16x32_bf16 v[208:211], v[32:35], v[72:75], v[208:211]
    ds_read_b128 v[28:31], v1 offset:8512
    v_fma_f32 v248, v248, s31, v13
    v_fma_f32 v249, v249, s31, v13
    v_cvt_pk_bf16_f32 v170, v244, v245
    v_mfma_f32_16x16x32_bf16 v[208:211], v[36:39], v[80:83], v[208:211]
    v_exp_f32 v246, v246
    v_exp_f32 v247, v247
    v_mfma_f32_16x16x32_bf16 v[216:219], v[32:35], v[76:79], v[216:219]
    v_max3_f32 v15, v15, v248, v249
    v_fma_f32 v250, v250, s31, v13
    v_fma_f32 v251, v251, s31, v13
    v_cvt_pk_bf16_f32 v171, v246, v247
    v_mfma_f32_16x16x32_bf16 v[216:219], v[36:39], v[84:87], v[216:219]
    ds_read_b128 v[32:35], v1 offset:8576
    v_exp_f32 v248, v248
    s_waitcnt lgkmcnt(3)
    v_mfma_f32_16x16x32_bf16 v[216:219], v[16:19], v[92:95], v[216:219]
    ds_read_b128 v[36:39], v1 offset:8640
    v_exp_f32 v249, v249
    v_max3_f32 v15, v15, v250, v251
    v_mfma_f32_16x16x32_bf16 v[216:219], v[20:23], v[100:103], v[216:219]
    v_fma_f32 v252, v252, s31, v13
    v_fma_f32 v253, v253, s31, v13
    v_exp_f32 v250, v250
    v_mfma_f32_16x16x32_bf16 v[208:211], v[16:19], v[88:91], v[208:211]
    v_exp_f32 v251, v251
    v_cvt_pk_bf16_f32 v172, v248, v249
    v_max3_f32 v15, v15, v252, v253
    v_mfma_f32_16x16x32_bf16 v[208:211], v[20:23], v[96:99], v[208:211]
    ds_read_b128 v[16:19], v1 offset:8704
    v_fma_f32 v254, v254, s31, v13
    v_fma_f32 v255, v255, s31, v13
    s_waitcnt lgkmcnt(3)
    v_mfma_f32_16x16x32_bf16 v[212:215], v[24:27], v[40:43], 0
    ds_read_b128 v[20:23], v1 offset:8768
    v_exp_f32 v252, v252
    v_cvt_pk_bf16_f32 v173, v250, v251
    v_mfma_f32_16x16x32_bf16 v[212:215], v[28:31], v[48:51], v[212:215]
    v_exp_f32 v253, v253
    v_max3_f32 v15, v15, v254, v255
    v_cvt_pk_bf16_f32 v174, v252, v253
    v_mfma_f32_16x16x32_bf16 v[220:223], v[24:27], v[44:47], 0
    v_exp_f32 v254, v254
    v_exp_f32 v255, v255
    v_mfma_f32_16x16x32_bf16 v[220:223], v[28:31], v[52:55], v[220:223]
    ds_read_b128 v[24:27], v1 offset:8832
    v_cvt_pk_bf16_f32 v175, v254, v255
    s_waitcnt lgkmcnt(3)
    v_mfma_f32_16x16x32_bf16 v[220:223], v[32:35], v[60:63], v[220:223]
    ds_read_b128 v[28:31], v1 offset:8896
    v_mfma_f32_16x16x32_bf16 v[220:223], v[36:39], v[68:71], v[220:223]
    v_mfma_f32_16x16x32_bf16 v[212:215], v[32:35], v[56:59], v[212:215]
    ds_read_b64_tr_b16 v[32:33], v2 offset:0
    v_mfma_f32_16x16x32_bf16 v[212:215], v[36:39], v[64:67], v[212:215]
    ds_read_b64_tr_b16 v[34:35], v2 offset:2048
    s_waitcnt lgkmcnt(4)
    v_mfma_f32_16x16x32_bf16 v[212:215], v[16:19], v[72:75], v[212:215]
    ds_read_b64_tr_b16 v[36:37], v2 offset:4096
    v_mfma_f32_16x16x32_bf16 v[212:215], v[20:23], v[80:83], v[212:215]
    ds_read_b64_tr_b16 v[38:39], v2 offset:6144
    v_mfma_f32_16x16x32_bf16 v[220:223], v[16:19], v[76:79], v[220:223]
    ds_read_b64_tr_b16 v[16:17], v3 offset:0
    v_mfma_f32_16x16x32_bf16 v[220:223], v[20:23], v[84:87], v[220:223]
    ds_read_b64_tr_b16 v[18:19], v3 offset:2048
    s_waitcnt lgkmcnt(6)
    v_mfma_f32_16x16x32_bf16 v[220:223], v[24:27], v[92:95], v[220:223]
    ds_read_b64_tr_b16 v[20:21], v3 offset:4096
    v_mfma_f32_16x16x32_bf16 v[220:223], v[28:31], v[100:103], v[220:223]
    ds_read_b64_tr_b16 v[22:23], v3 offset:6144
    v_mfma_f32_16x16x32_bf16 v[212:215], v[24:27], v[88:91], v[212:215]
    ds_read_b64_tr_b16 v[24:25], v4 offset:0
    v_mfma_f32_16x16x32_bf16 v[212:215], v[28:31], v[96:99], v[212:215]
    ds_read_b64_tr_b16 v[26:27], v4 offset:2048
    s_waitcnt lgkmcnt(6)
    v_mfma_f32_16x16x32_bf16 v[40:43], v[32:35], v[104:107], 0
    ds_read_b64_tr_b16 v[28:29], v4 offset:4096
    v_mov_b32 v88, 0x3f803f80
    v_mov_b32 v89, 0x3f803f80
    v_mfma_f32_16x16x32_bf16 v[40:43], v[36:39], v[176:179], v[40:43]
    ds_read_b64_tr_b16 v[30:31], v4 offset:6144
    v_mov_b32 v90, 0x3f803f80
    v_mov_b32 v91, 0x3f803f80
    v_mfma_f32_16x16x32_bf16 v[48:51], v[32:35], v[108:111], 0
    ds_read_b64_tr_b16 v[32:33], v5 offset:0
    v_fma_f32 v208, v208, s31, v12
    v_fma_f32 v209, v209, s31, v12
    v_mfma_f32_16x16x32_bf16 v[48:51], v[36:39], v[180:183], v[48:51]
    ds_read_b64_tr_b16 v[34:35], v5 offset:2048
    v_max3_f32 v14, v14, v208, v209
    v_fma_f32 v210, v210, s31, v12
    v_mfma_f32_16x16x32_bf16 v[92:95], v[88:91], v[104:107], 0
    v_fma_f32 v211, v211, s31, v12
    v_exp_f32 v208, v208
    v_mfma_f32_16x16x32_bf16 v[92:95], v[88:91], v[176:179], v[92:95]
    v_exp_f32 v209, v209
    s_waitcnt lgkmcnt(6)
    v_mfma_f32_16x16x32_bf16 v[44:47], v[16:19], v[104:107], 0
    ds_read_b64_tr_b16 v[36:37], v5 offset:4096
    v_max3_f32 v14, v14, v210, v211
    v_fma_f32 v212, v212, s31, v12
    v_mfma_f32_16x16x32_bf16 v[44:47], v[20:23], v[176:179], v[44:47]
    ds_read_b64_tr_b16 v[38:39], v5 offset:6144
    v_fma_f32 v213, v213, s31, v12
    v_cvt_pk_bf16_f32 v208, v208, v209
    v_mfma_f32_16x16x32_bf16 v[52:55], v[16:19], v[108:111], 0
    ds_read_b64_tr_b16 v[16:17], v2 offset:8192
    v_exp_f32 v210, v210
    v_mfma_f32_16x16x32_bf16 v[52:55], v[20:23], v[180:183], v[52:55]
    ds_read_b64_tr_b16 v[18:19], v2 offset:10240
    v_exp_f32 v211, v211
    v_mfma_f32_16x16x32_bf16 v[100:103], v[88:91], v[108:111], 0
    v_max3_f32 v14, v14, v212, v213
    v_fma_f32 v214, v214, s31, v12
    v_fma_f32 v215, v215, s31, v12
    v_mfma_f32_16x16x32_bf16 v[100:103], v[88:91], v[180:183], v[100:103]
    v_exp_f32 v212, v212
    s_waitcnt lgkmcnt(6)
    v_mfma_f32_16x16x32_bf16 v[56:59], v[24:27], v[104:107], 0
    ds_read_b64_tr_b16 v[20:21], v2 offset:12288
    v_exp_f32 v213, v213
    v_mfma_f32_16x16x32_bf16 v[56:59], v[28:31], v[176:179], v[56:59]
    ds_read_b64_tr_b16 v[22:23], v2 offset:14336
    v_cvt_pk_bf16_f32 v209, v210, v211
    v_max3_f32 v14, v14, v214, v215
    v_mfma_f32_16x16x32_bf16 v[64:67], v[24:27], v[108:111], 0
    ds_read_b64_tr_b16 v[24:25], v3 offset:8192
    v_fma_f32 v216, v216, s31, v13
    v_fma_f32 v217, v217, s31, v13
    v_mfma_f32_16x16x32_bf16 v[64:67], v[28:31], v[180:183], v[64:67]
    ds_read_b64_tr_b16 v[26:27], v3 offset:10240
    v_cvt_pk_bf16_f32 v210, v212, v213
    s_waitcnt lgkmcnt(6)
    v_mfma_f32_16x16x32_bf16 v[60:63], v[32:35], v[104:107], 0
    ds_read_b64_tr_b16 v[28:29], v3 offset:12288
    v_exp_f32 v214, v214
    v_mfma_f32_16x16x32_bf16 v[60:63], v[36:39], v[176:179], v[60:63]
    ds_read_b64_tr_b16 v[30:31], v3 offset:14336
    v_exp_f32 v215, v215
    v_mfma_f32_16x16x32_bf16 v[68:71], v[32:35], v[108:111], 0
    ds_read_b64_tr_b16 v[32:33], v4 offset:8192
    v_max3_f32 v15, v15, v216, v217
    v_fma_f32 v218, v218, s31, v13
    v_mfma_f32_16x16x32_bf16 v[68:71], v[36:39], v[180:183], v[68:71]
    ds_read_b64_tr_b16 v[34:35], v4 offset:10240
    v_fma_f32 v219, v219, s31, v13
    s_waitcnt lgkmcnt(6)
    v_mfma_f32_16x16x32_bf16 v[40:43], v[16:19], v[200:203], v[40:43]
    ds_read_b64_tr_b16 v[36:37], v4 offset:12288
    v_exp_f32 v216, v216
    v_mfma_f32_16x16x32_bf16 v[40:43], v[20:23], v[152:155], v[40:43]
    ds_read_b64_tr_b16 v[38:39], v4 offset:14336
    v_exp_f32 v217, v217
    v_mfma_f32_16x16x32_bf16 v[48:51], v[16:19], v[204:207], v[48:51]
    ds_read_b64_tr_b16 v[16:17], v5 offset:8192
    v_cvt_pk_bf16_f32 v211, v214, v215
    v_max3_f32 v15, v15, v218, v219
    v_mfma_f32_16x16x32_bf16 v[48:51], v[20:23], v[156:159], v[48:51]
    ds_read_b64_tr_b16 v[18:19], v5 offset:10240
    v_fma_f32 v220, v220, s31, v13
    v_fma_f32 v221, v221, s31, v13
    v_mfma_f32_16x16x32_bf16 v[92:95], v[88:91], v[200:203], v[92:95]
    v_exp_f32 v218, v218
    v_cvt_pk_bf16_f32 v212, v216, v217
    v_mfma_f32_16x16x32_bf16 v[92:95], v[88:91], v[152:155], v[92:95]
    v_exp_f32 v219, v219
    s_waitcnt lgkmcnt(6)
    v_mfma_f32_16x16x32_bf16 v[44:47], v[24:27], v[200:203], v[44:47]
    ds_read_b64_tr_b16 v[20:21], v5 offset:12288
    v_max3_f32 v15, v15, v220, v221
    v_fma_f32 v222, v222, s31, v13
    v_mfma_f32_16x16x32_bf16 v[44:47], v[28:31], v[152:155], v[44:47]
    ds_read_b64_tr_b16 v[22:23], v5 offset:14336
    v_fma_f32 v223, v223, s31, v13
    v_cvt_pk_bf16_f32 v213, v218, v219
    v_mfma_f32_16x16x32_bf16 v[52:55], v[24:27], v[204:207], v[52:55]
    s_barrier
    ds_read_b64_tr_b16 v[24:25], v2 offset:16896
    v_max3_f32 v15, v15, v222, v223
    v_mfma_f32_16x16x32_bf16 v[52:55], v[28:31], v[156:159], v[52:55]
    ds_read_b64_tr_b16 v[26:27], v2 offset:18944
    v_exp_f32 v220, v220
    v_mfma_f32_16x16x32_bf16 v[100:103], v[88:91], v[204:207], v[100:103]
    v_exp_f32 v221, v221
    v_mfma_f32_16x16x32_bf16 v[100:103], v[88:91], v[156:159], v[100:103]
    v_exp_f32 v222, v222
    s_waitcnt lgkmcnt(6)
    v_mfma_f32_16x16x32_bf16 v[56:59], v[32:35], v[200:203], v[56:59]
    ds_read_b64_tr_b16 v[28:29], v2 offset:20992
    v_exp_f32 v223, v223
    v_mfma_f32_16x16x32_bf16 v[56:59], v[36:39], v[152:155], v[56:59]
    ds_read_b64_tr_b16 v[30:31], v2 offset:23040
    v_cvt_pk_bf16_f32 v214, v220, v221
    v_cvt_pk_bf16_f32 v215, v222, v223
    v_mfma_f32_16x16x32_bf16 v[64:67], v[32:35], v[204:207], v[64:67]
    ds_read_b64_tr_b16 v[32:33], v3 offset:16896
    v_mfma_f32_16x16x32_bf16 v[64:67], v[36:39], v[156:159], v[64:67]
    ds_read_b64_tr_b16 v[34:35], v3 offset:18944
    s_waitcnt lgkmcnt(6)
    v_mfma_f32_16x16x32_bf16 v[60:63], v[16:19], v[200:203], v[60:63]
    ds_read_b64_tr_b16 v[36:37], v3 offset:20992
    v_mfma_f32_16x16x32_bf16 v[60:63], v[20:23], v[152:155], v[60:63]
    ds_read_b64_tr_b16 v[38:39], v3 offset:23040
    v_mfma_f32_16x16x32_bf16 v[68:71], v[16:19], v[204:207], v[68:71]
    ds_read_b64_tr_b16 v[16:17], v4 offset:16896
    v_mfma_f32_16x16x32_bf16 v[68:71], v[20:23], v[156:159], v[68:71]
    ds_read_b64_tr_b16 v[18:19], v4 offset:18944
    s_waitcnt lgkmcnt(6)
    v_mfma_f32_16x16x32_bf16 v[40:43], v[24:27], v[224:227], v[40:43]
    ds_read_b64_tr_b16 v[20:21], v4 offset:20992
    v_mfma_f32_16x16x32_bf16 v[40:43], v[28:31], v[120:123], v[40:43]
    ds_read_b64_tr_b16 v[22:23], v4 offset:23040
    v_mfma_f32_16x16x32_bf16 v[48:51], v[24:27], v[228:231], v[48:51]
    ds_read_b64_tr_b16 v[24:25], v5 offset:16896
    v_mfma_f32_16x16x32_bf16 v[48:51], v[28:31], v[124:127], v[48:51]
    ds_read_b64_tr_b16 v[26:27], v5 offset:18944
    v_mfma_f32_16x16x32_bf16 v[92:95], v[88:91], v[224:227], v[92:95]
    v_mfma_f32_16x16x32_bf16 v[92:95], v[88:91], v[120:123], v[92:95]
    s_waitcnt lgkmcnt(6)
    v_mfma_f32_16x16x32_bf16 v[44:47], v[32:35], v[224:227], v[44:47]
    ds_read_b64_tr_b16 v[28:29], v5 offset:20992
    v_mfma_f32_16x16x32_bf16 v[44:47], v[36:39], v[120:123], v[44:47]
    ds_read_b64_tr_b16 v[30:31], v5 offset:23040
    v_mfma_f32_16x16x32_bf16 v[52:55], v[32:35], v[228:231], v[52:55]
    ds_read_b64_tr_b16 v[32:33], v2 offset:25088
    v_mfma_f32_16x16x32_bf16 v[52:55], v[36:39], v[124:127], v[52:55]
    ds_read_b64_tr_b16 v[34:35], v2 offset:27136
    v_mfma_f32_16x16x32_bf16 v[100:103], v[88:91], v[228:231], v[100:103]
    v_mfma_f32_16x16x32_bf16 v[100:103], v[88:91], v[124:127], v[100:103]
    s_waitcnt lgkmcnt(6)
    v_mfma_f32_16x16x32_bf16 v[56:59], v[16:19], v[224:227], v[56:59]
    ds_read_b64_tr_b16 v[36:37], v2 offset:29184
    v_mfma_f32_16x16x32_bf16 v[56:59], v[20:23], v[120:123], v[56:59]
    ds_read_b64_tr_b16 v[38:39], v2 offset:31232
    v_mfma_f32_16x16x32_bf16 v[64:67], v[16:19], v[228:231], v[64:67]
    ds_read_b64_tr_b16 v[16:17], v3 offset:25088
    v_mfma_f32_16x16x32_bf16 v[64:67], v[20:23], v[124:127], v[64:67]
    ds_read_b64_tr_b16 v[18:19], v3 offset:27136
    s_waitcnt lgkmcnt(6)
    v_mfma_f32_16x16x32_bf16 v[60:63], v[24:27], v[224:227], v[60:63]
    ds_read_b64_tr_b16 v[20:21], v3 offset:29184
    v_mfma_f32_16x16x32_bf16 v[60:63], v[28:31], v[120:123], v[60:63]
    ds_read_b64_tr_b16 v[22:23], v3 offset:31232
    v_mfma_f32_16x16x32_bf16 v[68:71], v[24:27], v[228:231], v[68:71]
    ds_read_b64_tr_b16 v[24:25], v4 offset:25088
    v_mfma_f32_16x16x32_bf16 v[68:71], v[28:31], v[124:127], v[68:71]
    ds_read_b64_tr_b16 v[26:27], v4 offset:27136
    s_waitcnt lgkmcnt(6)
    v_mfma_f32_16x16x32_bf16 v[40:43], v[32:35], v[128:131], v[40:43]
    ds_read_b64_tr_b16 v[28:29], v4 offset:29184
    v_mfma_f32_16x16x32_bf16 v[40:43], v[36:39], v[160:163], v[40:43]
    ds_read_b64_tr_b16 v[30:31], v4 offset:31232
    v_mfma_f32_16x16x32_bf16 v[48:51], v[32:35], v[132:135], v[48:51]
    ds_read_b64_tr_b16 v[32:33], v5 offset:25088
    v_mfma_f32_16x16x32_bf16 v[48:51], v[36:39], v[164:167], v[48:51]
    ds_read_b64_tr_b16 v[34:35], v5 offset:27136
    v_mfma_f32_16x16x32_bf16 v[92:95], v[88:91], v[128:131], v[92:95]
    v_mfma_f32_16x16x32_bf16 v[92:95], v[88:91], v[160:163], v[92:95]
    s_waitcnt lgkmcnt(6)
    v_mfma_f32_16x16x32_bf16 v[44:47], v[16:19], v[128:131], v[44:47]
    ds_read_b64_tr_b16 v[36:37], v5 offset:29184
    v_mfma_f32_16x16x32_bf16 v[44:47], v[20:23], v[160:163], v[44:47]
    ds_read_b64_tr_b16 v[38:39], v5 offset:31232
    v_mfma_f32_16x16x32_bf16 v[52:55], v[16:19], v[132:135], v[52:55]
    ds_read_b64_tr_b16 v[16:17], v2 offset:33792
    v_mfma_f32_16x16x32_bf16 v[52:55], v[20:23], v[164:167], v[52:55]
    ds_read_b64_tr_b16 v[18:19], v2 offset:35840
    v_mfma_f32_16x16x32_bf16 v[100:103], v[88:91], v[132:135], v[100:103]
    v_mfma_f32_16x16x32_bf16 v[100:103], v[88:91], v[164:167], v[100:103]
    s_waitcnt lgkmcnt(6)
    v_mfma_f32_16x16x32_bf16 v[56:59], v[24:27], v[128:131], v[56:59]
    ds_read_b64_tr_b16 v[20:21], v2 offset:37888
    v_mfma_f32_16x16x32_bf16 v[56:59], v[28:31], v[160:163], v[56:59]
    ds_read_b64_tr_b16 v[22:23], v2 offset:39936
    v_mfma_f32_16x16x32_bf16 v[64:67], v[24:27], v[132:135], v[64:67]
    ds_read_b64_tr_b16 v[24:25], v3 offset:33792
    v_mfma_f32_16x16x32_bf16 v[64:67], v[28:31], v[164:167], v[64:67]
    ds_read_b64_tr_b16 v[26:27], v3 offset:35840
    s_waitcnt lgkmcnt(6)
    v_mfma_f32_16x16x32_bf16 v[60:63], v[32:35], v[128:131], v[60:63]
    ds_read_b64_tr_b16 v[28:29], v3 offset:37888
    v_mfma_f32_16x16x32_bf16 v[60:63], v[36:39], v[160:163], v[60:63]
    ds_read_b64_tr_b16 v[30:31], v3 offset:39936
    v_mfma_f32_16x16x32_bf16 v[68:71], v[32:35], v[132:135], v[68:71]
    ds_read_b64_tr_b16 v[32:33], v4 offset:33792
    v_mfma_f32_16x16x32_bf16 v[68:71], v[36:39], v[164:167], v[68:71]
    ds_read_b64_tr_b16 v[34:35], v4 offset:35840
    s_waitcnt lgkmcnt(6)
    v_mfma_f32_16x16x32_bf16 v[40:43], v[16:19], v[112:115], v[40:43]
    ds_read_b64_tr_b16 v[36:37], v4 offset:37888
    v_mfma_f32_16x16x32_bf16 v[40:43], v[20:23], v[184:187], v[40:43]
    ds_read_b64_tr_b16 v[38:39], v4 offset:39936
    v_mfma_f32_16x16x32_bf16 v[48:51], v[16:19], v[116:119], v[48:51]
    ds_read_b64_tr_b16 v[16:17], v5 offset:33792
    v_mfma_f32_16x16x32_bf16 v[48:51], v[20:23], v[188:191], v[48:51]
    ds_read_b64_tr_b16 v[18:19], v5 offset:35840
    v_mfma_f32_16x16x32_bf16 v[92:95], v[88:91], v[112:115], v[92:95]
    v_mfma_f32_16x16x32_bf16 v[92:95], v[88:91], v[184:187], v[92:95]
    s_waitcnt lgkmcnt(6)
    v_mfma_f32_16x16x32_bf16 v[44:47], v[24:27], v[112:115], v[44:47]
    ds_read_b64_tr_b16 v[20:21], v5 offset:37888
    v_mfma_f32_16x16x32_bf16 v[44:47], v[28:31], v[184:187], v[44:47]
    ds_read_b64_tr_b16 v[22:23], v5 offset:39936
    v_mfma_f32_16x16x32_bf16 v[52:55], v[24:27], v[116:119], v[52:55]
    ds_read_b64_tr_b16 v[24:25], v2 offset:41984
    v_mfma_f32_16x16x32_bf16 v[52:55], v[28:31], v[188:191], v[52:55]
    ds_read_b64_tr_b16 v[26:27], v2 offset:44032
    v_mfma_f32_16x16x32_bf16 v[100:103], v[88:91], v[116:119], v[100:103]
    v_mfma_f32_16x16x32_bf16 v[100:103], v[88:91], v[188:191], v[100:103]
    s_waitcnt lgkmcnt(6)
    v_mfma_f32_16x16x32_bf16 v[56:59], v[32:35], v[112:115], v[56:59]
    ds_read_b64_tr_b16 v[28:29], v2 offset:46080
    v_mfma_f32_16x16x32_bf16 v[56:59], v[36:39], v[184:187], v[56:59]
    ds_read_b64_tr_b16 v[30:31], v2 offset:48128
    v_mfma_f32_16x16x32_bf16 v[64:67], v[32:35], v[116:119], v[64:67]
    ds_read_b64_tr_b16 v[32:33], v3 offset:41984
    v_mfma_f32_16x16x32_bf16 v[64:67], v[36:39], v[188:191], v[64:67]
    ds_read_b64_tr_b16 v[34:35], v3 offset:44032
    s_waitcnt lgkmcnt(6)
    v_mfma_f32_16x16x32_bf16 v[60:63], v[16:19], v[112:115], v[60:63]
    ds_read_b64_tr_b16 v[36:37], v3 offset:46080
    v_mfma_f32_16x16x32_bf16 v[60:63], v[20:23], v[184:187], v[60:63]
    ds_read_b64_tr_b16 v[38:39], v3 offset:48128
    v_mfma_f32_16x16x32_bf16 v[68:71], v[16:19], v[116:119], v[68:71]
    ds_read_b64_tr_b16 v[16:17], v4 offset:41984
    v_mfma_f32_16x16x32_bf16 v[68:71], v[20:23], v[188:191], v[68:71]
    ds_read_b64_tr_b16 v[18:19], v4 offset:44032
    s_waitcnt lgkmcnt(6)
    v_mfma_f32_16x16x32_bf16 v[40:43], v[24:27], v[136:139], v[40:43]
    ds_read_b64_tr_b16 v[20:21], v4 offset:46080
    v_mfma_f32_16x16x32_bf16 v[40:43], v[28:31], v[168:171], v[40:43]
    ds_read_b64_tr_b16 v[22:23], v4 offset:48128
    v_mfma_f32_16x16x32_bf16 v[48:51], v[24:27], v[140:143], v[48:51]
    ds_read_b64_tr_b16 v[24:25], v5 offset:41984
    v_mfma_f32_16x16x32_bf16 v[48:51], v[28:31], v[172:175], v[48:51]
    ds_read_b64_tr_b16 v[26:27], v5 offset:44032
    v_mfma_f32_16x16x32_bf16 v[92:95], v[88:91], v[136:139], v[92:95]
    v_mfma_f32_16x16x32_bf16 v[92:95], v[88:91], v[168:171], v[92:95]
    s_waitcnt lgkmcnt(6)
    v_mfma_f32_16x16x32_bf16 v[44:47], v[32:35], v[136:139], v[44:47]
    ds_read_b64_tr_b16 v[28:29], v5 offset:46080
    v_mfma_f32_16x16x32_bf16 v[44:47], v[36:39], v[168:171], v[44:47]
    ds_read_b64_tr_b16 v[30:31], v5 offset:48128
    v_mfma_f32_16x16x32_bf16 v[52:55], v[32:35], v[140:143], v[52:55]
    s_barrier
    ds_read_b64_tr_b16 v[32:33], v2 offset:50688
    v_mfma_f32_16x16x32_bf16 v[52:55], v[36:39], v[172:175], v[52:55]
    ds_read_b64_tr_b16 v[34:35], v2 offset:52736
    v_mfma_f32_16x16x32_bf16 v[100:103], v[88:91], v[140:143], v[100:103]
    v_mfma_f32_16x16x32_bf16 v[100:103], v[88:91], v[172:175], v[100:103]
    s_waitcnt lgkmcnt(6)
    v_mfma_f32_16x16x32_bf16 v[56:59], v[16:19], v[136:139], v[56:59]
    ds_read_b64_tr_b16 v[36:37], v2 offset:54784
    v_mfma_f32_16x16x32_bf16 v[56:59], v[20:23], v[168:171], v[56:59]
    ds_read_b64_tr_b16 v[38:39], v2 offset:56832
    v_mfma_f32_16x16x32_bf16 v[64:67], v[16:19], v[140:143], v[64:67]
    ds_read_b64_tr_b16 v[16:17], v3 offset:50688
    v_mfma_f32_16x16x32_bf16 v[64:67], v[20:23], v[172:175], v[64:67]
    ds_read_b64_tr_b16 v[18:19], v3 offset:52736
    s_waitcnt lgkmcnt(6)
    v_mfma_f32_16x16x32_bf16 v[60:63], v[24:27], v[136:139], v[60:63]
    ds_read_b64_tr_b16 v[20:21], v3 offset:54784
    v_mfma_f32_16x16x32_bf16 v[60:63], v[28:31], v[168:171], v[60:63]
    ds_read_b64_tr_b16 v[22:23], v3 offset:56832
    v_mfma_f32_16x16x32_bf16 v[68:71], v[24:27], v[140:143], v[68:71]
    ds_read_b64_tr_b16 v[24:25], v4 offset:50688
    v_mfma_f32_16x16x32_bf16 v[68:71], v[28:31], v[172:175], v[68:71]
    ds_read_b64_tr_b16 v[26:27], v4 offset:52736
    s_waitcnt lgkmcnt(6)
    v_mfma_f32_16x16x32_bf16 v[40:43], v[32:35], v[232:235], v[40:43]
    ds_read_b64_tr_b16 v[28:29], v4 offset:54784
    v_mfma_f32_16x16x32_bf16 v[40:43], v[36:39], v[192:195], v[40:43]
    ds_read_b64_tr_b16 v[30:31], v4 offset:56832
    v_mfma_f32_16x16x32_bf16 v[48:51], v[32:35], v[236:239], v[48:51]
    ds_read_b64_tr_b16 v[32:33], v5 offset:50688
    v_mfma_f32_16x16x32_bf16 v[48:51], v[36:39], v[196:199], v[48:51]
    ds_read_b64_tr_b16 v[34:35], v5 offset:52736
    v_mfma_f32_16x16x32_bf16 v[92:95], v[88:91], v[232:235], v[92:95]
    v_mfma_f32_16x16x32_bf16 v[92:95], v[88:91], v[192:195], v[92:95]
    s_waitcnt lgkmcnt(6)
    v_mfma_f32_16x16x32_bf16 v[44:47], v[16:19], v[232:235], v[44:47]
    ds_read_b64_tr_b16 v[36:37], v5 offset:54784
    v_mfma_f32_16x16x32_bf16 v[44:47], v[20:23], v[192:195], v[44:47]
    ds_read_b64_tr_b16 v[38:39], v5 offset:56832
    v_mfma_f32_16x16x32_bf16 v[52:55], v[16:19], v[236:239], v[52:55]
    ds_read_b64_tr_b16 v[16:17], v2 offset:58880
    v_mfma_f32_16x16x32_bf16 v[52:55], v[20:23], v[196:199], v[52:55]
    ds_read_b64_tr_b16 v[18:19], v2 offset:60928
    v_mfma_f32_16x16x32_bf16 v[100:103], v[88:91], v[236:239], v[100:103]
    v_mfma_f32_16x16x32_bf16 v[100:103], v[88:91], v[196:199], v[100:103]
    s_waitcnt lgkmcnt(6)
    v_mfma_f32_16x16x32_bf16 v[56:59], v[24:27], v[232:235], v[56:59]
    ds_read_b64_tr_b16 v[20:21], v2 offset:62976
    v_mfma_f32_16x16x32_bf16 v[56:59], v[28:31], v[192:195], v[56:59]
    ds_read_b64_tr_b16 v[22:23], v2 offset:65024
    v_mfma_f32_16x16x32_bf16 v[64:67], v[24:27], v[236:239], v[64:67]
    ds_read_b64_tr_b16 v[24:25], v3 offset:58880
    v_mfma_f32_16x16x32_bf16 v[64:67], v[28:31], v[196:199], v[64:67]
    ds_read_b64_tr_b16 v[26:27], v3 offset:60928
    s_waitcnt lgkmcnt(6)
    v_mfma_f32_16x16x32_bf16 v[60:63], v[32:35], v[232:235], v[60:63]
    ds_read_b64_tr_b16 v[28:29], v3 offset:62976
    v_mfma_f32_16x16x32_bf16 v[60:63], v[36:39], v[192:195], v[60:63]
    ds_read_b64_tr_b16 v[30:31], v3 offset:65024
    v_mfma_f32_16x16x32_bf16 v[68:71], v[32:35], v[236:239], v[68:71]
    ds_read_b64_tr_b16 v[32:33], v4 offset:58880
    v_mfma_f32_16x16x32_bf16 v[68:71], v[36:39], v[196:199], v[68:71]
    ds_read_b64_tr_b16 v[34:35], v4 offset:60928
    s_waitcnt lgkmcnt(6)
    v_mfma_f32_16x16x32_bf16 v[40:43], v[16:19], v[144:147], v[40:43]
    ds_read_b64_tr_b16 v[36:37], v4 offset:62976
    v_mfma_f32_16x16x32_bf16 v[40:43], v[20:23], v[208:211], v[40:43]
    ds_read_b64_tr_b16 v[38:39], v4 offset:65024
    v_mfma_f32_16x16x32_bf16 v[48:51], v[16:19], v[148:151], v[48:51]
    ds_read_b64_tr_b16 v[16:17], v5 offset:58880
    v_mfma_f32_16x16x32_bf16 v[48:51], v[20:23], v[212:215], v[48:51]
    ds_read_b64_tr_b16 v[18:19], v5 offset:60928
    v_mfma_f32_16x16x32_bf16 v[92:95], v[88:91], v[144:147], v[92:95]
    v_mfma_f32_16x16x32_bf16 v[92:95], v[88:91], v[208:211], v[92:95]
    s_waitcnt lgkmcnt(6)
    v_mfma_f32_16x16x32_bf16 v[44:47], v[24:27], v[144:147], v[44:47]
    ds_read_b64_tr_b16 v[20:21], v5 offset:62976
    v_mfma_f32_16x16x32_bf16 v[44:47], v[28:31], v[208:211], v[44:47]
    ds_read_b64_tr_b16 v[22:23], v5 offset:65024
    v_mfma_f32_16x16x32_bf16 v[52:55], v[24:27], v[148:151], v[52:55]
    v_add_u32 v2, 67584, v2
    ds_read_b64_tr_b16 v[24:25], v2 offset:0
    v_mfma_f32_16x16x32_bf16 v[52:55], v[28:31], v[212:215], v[52:55]
    ds_read_b64_tr_b16 v[26:27], v2 offset:2048
    v_mfma_f32_16x16x32_bf16 v[100:103], v[88:91], v[148:151], v[100:103]
    v_mfma_f32_16x16x32_bf16 v[100:103], v[88:91], v[212:215], v[100:103]
    s_waitcnt lgkmcnt(6)
    v_mfma_f32_16x16x32_bf16 v[56:59], v[32:35], v[144:147], v[56:59]
    ds_read_b64_tr_b16 v[28:29], v2 offset:4096
    v_rcp_f32 v10, v92
    v_max_f32 v8, v14, v15
    v_mfma_f32_16x16x32_bf16 v[56:59], v[36:39], v[208:211], v[56:59]
    ds_read_b64_tr_b16 v[30:31], v2 offset:6144
    v_mfma_f32_16x16x32_bf16 v[64:67], v[32:35], v[148:151], v[64:67]
    ds_read_b64_tr_b16 v[32:33], v2 offset:8192
    v_rcp_f32 v11, v100
    v_mul_f32 v40, v40, v10
    v_mfma_f32_16x16x32_bf16 v[64:67], v[36:39], v[212:215], v[64:67]
    ds_read_b64_tr_b16 v[34:35], v2 offset:10240
    v_mul_f32 v41, v41, v10
    s_waitcnt lgkmcnt(6)
    v_mfma_f32_16x16x32_bf16 v[60:63], v[16:19], v[144:147], v[60:63]
    ds_read_b64_tr_b16 v[36:37], v2 offset:12288
    v_mul_f32 v42, v42, v10
    v_mul_f32 v43, v43, v10
    v_mfma_f32_16x16x32_bf16 v[60:63], v[20:23], v[208:211], v[60:63]
    ds_read_b64_tr_b16 v[38:39], v2 offset:14336
    v_cvt_pk_bf16_f32 v216, v40, v41
    v_cvt_pk_bf16_f32 v217, v42, v43
    v_mfma_f32_16x16x32_bf16 v[68:71], v[16:19], v[148:151], v[68:71]
    v_add_u32 v3, 67584, v3
    ds_read_b64_tr_b16 v[16:17], v3 offset:0
    v_mul_f32 v44, v44, v10
    v_mfma_f32_16x16x32_bf16 v[68:71], v[20:23], v[212:215], v[68:71]
    ds_read_b64_tr_b16 v[18:19], v3 offset:2048
    v_mul_f32 v45, v45, v10
    s_waitcnt lgkmcnt(6)
    v_mfma_f32_16x16x32_bf16 v[72:75], v[24:27], v[104:107], 0
    ds_read_b64_tr_b16 v[20:21], v3 offset:4096
    v_cmp_nge_f32 vcc, s35, v8
    v_mov_b32 v9, 152064
    s_andn2_b64 vcc, vcc, s[32:33]
    s_cselect_b32 s36, 1, 0
    v_mov_b32 v8, s36
    ds_write_b32 v7, v8
    v_mfma_f32_16x16x32_bf16 v[72:75], v[28:31], v[176:179], v[72:75]
    ds_read_b64_tr_b16 v[22:23], v3 offset:6144
    v_mul_f32 v46, v46, v10
    v_mfma_f32_16x16x32_bf16 v[80:83], v[24:27], v[108:111], 0
    ds_read_b64_tr_b16 v[24:25], v3 offset:8192
    v_mul_f32 v47, v47, v10
    v_mfma_f32_16x16x32_bf16 v[80:83], v[28:31], v[180:183], v[80:83]
    ds_read_b64_tr_b16 v[26:27], v3 offset:10240
    s_waitcnt lgkmcnt(7)
    v_mfma_f32_16x16x32_bf16 v[80:83], v[32:35], v[204:207], v[80:83]
    ds_read_b64_tr_b16 v[28:29], v3 offset:12288
    v_cvt_pk_bf16_f32 v218, v44, v45
    v_mfma_f32_16x16x32_bf16 v[80:83], v[36:39], v[156:159], v[80:83]
    ds_read_b64_tr_b16 v[30:31], v3 offset:14336
    v_cvt_pk_bf16_f32 v219, v46, v47
    v_mfma_f32_16x16x32_bf16 v[72:75], v[32:35], v[200:203], v[72:75]
    v_add_u32 v4, 67584, v4
    ds_read_b64_tr_b16 v[32:33], v4 offset:0
    v_mfma_f32_16x16x32_bf16 v[72:75], v[36:39], v[152:155], v[72:75]
    ds_read_b64_tr_b16 v[34:35], v4 offset:2048
    s_waitcnt lgkmcnt(6)
    v_mfma_f32_16x16x32_bf16 v[76:79], v[16:19], v[104:107], 0
    ds_read_b64_tr_b16 v[36:37], v4 offset:4096
    v_permlane16_swap_b32 v216, v218
    v_mfma_f32_16x16x32_bf16 v[76:79], v[20:23], v[176:179], v[76:79]
    ds_read_b64_tr_b16 v[38:39], v4 offset:6144
    v_permlane16_swap_b32 v217, v219
    v_mfma_f32_16x16x32_bf16 v[84:87], v[16:19], v[108:111], 0
    ds_read_b64_tr_b16 v[16:17], v4 offset:8192
    v_mul_f32 v48, v48, v11
    v_mfma_f32_16x16x32_bf16 v[84:87], v[20:23], v[180:183], v[84:87]
    ds_read_b64_tr_b16 v[18:19], v4 offset:10240
    s_waitcnt lgkmcnt(6)
    v_mfma_f32_16x16x32_bf16 v[84:87], v[24:27], v[204:207], v[84:87]
    ds_read_b64_tr_b16 v[20:21], v4 offset:12288
    v_mul_f32 v49, v49, v11
    v_mfma_f32_16x16x32_bf16 v[84:87], v[28:31], v[156:159], v[84:87]
    ds_read_b64_tr_b16 v[22:23], v4 offset:14336
    v_mul_f32 v50, v50, v11
    v_mfma_f32_16x16x32_bf16 v[76:79], v[24:27], v[200:203], v[76:79]
    v_add_u32 v5, 67584, v5
    ds_read_b64_tr_b16 v[24:25], v5 offset:0
    v_mfma_f32_16x16x32_bf16 v[76:79], v[28:31], v[152:155], v[76:79]
    ds_read_b64_tr_b16 v[26:27], v5 offset:2048
    s_waitcnt lgkmcnt(6)
    v_mfma_f32_16x16x32_bf16 v[88:91], v[32:35], v[104:107], 0
    ds_read_b64_tr_b16 v[28:29], v5 offset:4096
    buffer_store_dwordx4 v[216:219], v6, s[24:27], s16 offen offset:0 sc0 sc1
    v_mfma_f32_16x16x32_bf16 v[88:91], v[36:39], v[176:179], v[88:91]
    ds_read_b64_tr_b16 v[30:31], v5 offset:6144
    v_mul_f32 v51, v51, v11
    v_mfma_f32_16x16x32_bf16 v[96:99], v[32:35], v[108:111], 0
    ds_read_b64_tr_b16 v[32:33], v5 offset:8192
    v_cvt_pk_bf16_f32 v220, v48, v49
    v_mfma_f32_16x16x32_bf16 v[96:99], v[36:39], v[180:183], v[96:99]
    ds_read_b64_tr_b16 v[34:35], v5 offset:10240
    s_waitcnt lgkmcnt(6)
    v_mfma_f32_16x16x32_bf16 v[96:99], v[16:19], v[204:207], v[96:99]
    ds_read_b64_tr_b16 v[36:37], v5 offset:12288
    v_cvt_pk_bf16_f32 v221, v50, v51
    v_mfma_f32_16x16x32_bf16 v[96:99], v[20:23], v[156:159], v[96:99]
    ds_read_b64_tr_b16 v[38:39], v5 offset:14336
    v_mul_f32 v52, v52, v11
    v_mfma_f32_16x16x32_bf16 v[88:91], v[16:19], v[200:203], v[88:91]
    s_barrier
    ds_read_b128 v[248:251], v9
    ds_read_b64_tr_b16 v[16:17], v2 offset:16896
    v_mfma_f32_16x16x32_bf16 v[88:91], v[20:23], v[152:155], v[88:91]
    ds_read_b64_tr_b16 v[18:19], v2 offset:18944
    s_waitcnt lgkmcnt(7)
    v_mfma_f32_16x16x32_bf16 v[92:95], v[24:27], v[104:107], 0
    ds_read_b64_tr_b16 v[20:21], v2 offset:20992
    v_mul_f32 v53, v53, v11
    v_mfma_f32_16x16x32_bf16 v[92:95], v[28:31], v[176:179], v[92:95]
    ds_read_b64_tr_b16 v[22:23], v2 offset:23040
    v_mul_f32 v54, v54, v11
    v_mfma_f32_16x16x32_bf16 v[100:103], v[24:27], v[108:111], 0
    ds_read_b64_tr_b16 v[24:25], v2 offset:25088
    v_mul_f32 v55, v55, v11
    v_mfma_f32_16x16x32_bf16 v[100:103], v[28:31], v[180:183], v[100:103]
    ds_read_b64_tr_b16 v[26:27], v2 offset:27136
    s_waitcnt lgkmcnt(7)
    v_mfma_f32_16x16x32_bf16 v[100:103], v[32:35], v[204:207], v[100:103]
    ds_read_b64_tr_b16 v[28:29], v2 offset:29184
    v_cvt_pk_bf16_f32 v222, v52, v53
    v_mfma_f32_16x16x32_bf16 v[100:103], v[36:39], v[156:159], v[100:103]
    ds_read_b64_tr_b16 v[30:31], v2 offset:31232
    v_cvt_pk_bf16_f32 v223, v54, v55
    v_mfma_f32_16x16x32_bf16 v[92:95], v[32:35], v[200:203], v[92:95]
    ds_read_b64_tr_b16 v[32:33], v3 offset:16896
    v_permlane16_swap_b32 v220, v222
    v_mfma_f32_16x16x32_bf16 v[92:95], v[36:39], v[152:155], v[92:95]
    ds_read_b64_tr_b16 v[34:35], v3 offset:18944
    s_waitcnt lgkmcnt(6)
    v_mfma_f32_16x16x32_bf16 v[72:75], v[16:19], v[224:227], v[72:75]
    ds_read_b64_tr_b16 v[36:37], v3 offset:20992
    v_or3_b32 v9, v248, v249, v250
    v_or_b32 v9, v9, v251
    v_cmp_ne_u32 vcc, 0, v9
    s_cbranch_vccnz L_redo_compute_safe
    v_mfma_f32_16x16x32_bf16 v[72:75], v[20:23], v[120:123], v[72:75]
    ds_read_b64_tr_b16 v[38:39], v3 offset:23040
    v_permlane16_swap_b32 v221, v223
    v_mfma_f32_16x16x32_bf16 v[80:83], v[16:19], v[228:231], v[80:83]
    ds_read_b64_tr_b16 v[16:17], v3 offset:25088
    v_mul_f32 v56, v56, v10
    v_mfma_f32_16x16x32_bf16 v[80:83], v[20:23], v[124:127], v[80:83]
    ds_read_b64_tr_b16 v[18:19], v3 offset:27136
    s_waitcnt lgkmcnt(6)
    v_mfma_f32_16x16x32_bf16 v[80:83], v[24:27], v[132:135], v[80:83]
    ds_read_b64_tr_b16 v[20:21], v3 offset:29184
    v_mul_f32 v57, v57, v10
    v_mfma_f32_16x16x32_bf16 v[80:83], v[28:31], v[164:167], v[80:83]
    ds_read_b64_tr_b16 v[22:23], v3 offset:31232
    v_mul_f32 v58, v58, v10
    v_mfma_f32_16x16x32_bf16 v[72:75], v[24:27], v[128:131], v[72:75]
    ds_read_b64_tr_b16 v[24:25], v4 offset:16896
    v_mul_f32 v59, v59, v10
    v_mfma_f32_16x16x32_bf16 v[72:75], v[28:31], v[160:163], v[72:75]
    ds_read_b64_tr_b16 v[26:27], v4 offset:18944
    s_waitcnt lgkmcnt(6)
    v_mfma_f32_16x16x32_bf16 v[76:79], v[32:35], v[224:227], v[76:79]
    ds_read_b64_tr_b16 v[28:29], v4 offset:20992
    v_cvt_pk_bf16_f32 v240, v56, v57
    v_mfma_f32_16x16x32_bf16 v[76:79], v[36:39], v[120:123], v[76:79]
    ds_read_b64_tr_b16 v[30:31], v4 offset:23040
    v_cvt_pk_bf16_f32 v241, v58, v59
    v_mfma_f32_16x16x32_bf16 v[84:87], v[32:35], v[228:231], v[84:87]
    ds_read_b64_tr_b16 v[32:33], v4 offset:25088
    v_mul_f32 v60, v60, v10
    v_mfma_f32_16x16x32_bf16 v[84:87], v[36:39], v[124:127], v[84:87]
    ds_read_b64_tr_b16 v[34:35], v4 offset:27136
    s_waitcnt lgkmcnt(6)
    v_mfma_f32_16x16x32_bf16 v[84:87], v[16:19], v[132:135], v[84:87]
    ds_read_b64_tr_b16 v[36:37], v4 offset:29184
    v_mul_f32 v61, v61, v10
    v_mfma_f32_16x16x32_bf16 v[84:87], v[20:23], v[164:167], v[84:87]
    ds_read_b64_tr_b16 v[38:39], v4 offset:31232
    v_mul_f32 v62, v62, v10
    v_mfma_f32_16x16x32_bf16 v[76:79], v[16:19], v[128:131], v[76:79]
    ds_read_b64_tr_b16 v[16:17], v5 offset:16896
    v_mul_f32 v63, v63, v10
    v_mfma_f32_16x16x32_bf16 v[76:79], v[20:23], v[160:163], v[76:79]
    ds_read_b64_tr_b16 v[18:19], v5 offset:18944
    s_waitcnt lgkmcnt(6)
    v_mfma_f32_16x16x32_bf16 v[88:91], v[24:27], v[224:227], v[88:91]
    ds_read_b64_tr_b16 v[20:21], v5 offset:20992
    v_cvt_pk_bf16_f32 v242, v60, v61
    v_mfma_f32_16x16x32_bf16 v[88:91], v[28:31], v[120:123], v[88:91]
    ds_read_b64_tr_b16 v[22:23], v5 offset:23040
    v_cvt_pk_bf16_f32 v243, v62, v63
    v_mfma_f32_16x16x32_bf16 v[96:99], v[24:27], v[228:231], v[96:99]
    ds_read_b64_tr_b16 v[24:25], v5 offset:25088
    v_permlane16_swap_b32 v240, v242
    v_mfma_f32_16x16x32_bf16 v[96:99], v[28:31], v[124:127], v[96:99]
    ds_read_b64_tr_b16 v[26:27], v5 offset:27136
    s_waitcnt lgkmcnt(6)
    v_mfma_f32_16x16x32_bf16 v[96:99], v[32:35], v[132:135], v[96:99]
    ds_read_b64_tr_b16 v[28:29], v5 offset:29184
    v_permlane16_swap_b32 v241, v243
    v_mfma_f32_16x16x32_bf16 v[96:99], v[36:39], v[164:167], v[96:99]
    ds_read_b64_tr_b16 v[30:31], v5 offset:31232
    v_mul_f32 v64, v64, v11
    v_mfma_f32_16x16x32_bf16 v[88:91], v[32:35], v[128:131], v[88:91]
    ds_read_b64_tr_b16 v[32:33], v2 offset:33792
    v_mul_f32 v65, v65, v11
    v_mfma_f32_16x16x32_bf16 v[88:91], v[36:39], v[160:163], v[88:91]
    ds_read_b64_tr_b16 v[34:35], v2 offset:35840
    s_waitcnt lgkmcnt(6)
    v_mfma_f32_16x16x32_bf16 v[92:95], v[16:19], v[224:227], v[92:95]
    ds_read_b64_tr_b16 v[36:37], v2 offset:37888
    v_mul_f32 v66, v66, v11
    v_mfma_f32_16x16x32_bf16 v[92:95], v[20:23], v[120:123], v[92:95]
    ds_read_b64_tr_b16 v[38:39], v2 offset:39936
    v_mul_f32 v67, v67, v11
    v_mfma_f32_16x16x32_bf16 v[100:103], v[16:19], v[228:231], v[100:103]
    ds_read_b64_tr_b16 v[16:17], v2 offset:41984
    v_cvt_pk_bf16_f32 v244, v64, v65
    v_mfma_f32_16x16x32_bf16 v[100:103], v[20:23], v[124:127], v[100:103]
    ds_read_b64_tr_b16 v[18:19], v2 offset:44032
    s_waitcnt lgkmcnt(6)
    v_mfma_f32_16x16x32_bf16 v[100:103], v[24:27], v[132:135], v[100:103]
    ds_read_b64_tr_b16 v[20:21], v2 offset:46080
    v_cvt_pk_bf16_f32 v245, v66, v67
    v_mfma_f32_16x16x32_bf16 v[100:103], v[28:31], v[164:167], v[100:103]
    ds_read_b64_tr_b16 v[22:23], v2 offset:48128
    v_mul_f32 v68, v68, v11
    v_mfma_f32_16x16x32_bf16 v[92:95], v[24:27], v[128:131], v[92:95]
    ds_read_b64_tr_b16 v[24:25], v3 offset:33792
    v_mul_f32 v69, v69, v11
    v_mfma_f32_16x16x32_bf16 v[92:95], v[28:31], v[160:163], v[92:95]
    ds_read_b64_tr_b16 v[26:27], v3 offset:35840
    s_waitcnt lgkmcnt(6)
    v_mfma_f32_16x16x32_bf16 v[72:75], v[32:35], v[112:115], v[72:75]
    ds_read_b64_tr_b16 v[28:29], v3 offset:37888
    buffer_store_dwordx4 v[220:223], v6, s[24:27], s17 offen offset:0 sc0 sc1
    v_mfma_f32_16x16x32_bf16 v[72:75], v[36:39], v[184:187], v[72:75]
    ds_read_b64_tr_b16 v[30:31], v3 offset:39936
    v_mul_f32 v70, v70, v11
    v_mfma_f32_16x16x32_bf16 v[80:83], v[32:35], v[116:119], v[80:83]
    ds_read_b64_tr_b16 v[32:33], v3 offset:41984
    v_mul_f32 v71, v71, v11
    v_mfma_f32_16x16x32_bf16 v[80:83], v[36:39], v[188:191], v[80:83]
    ds_read_b64_tr_b16 v[34:35], v3 offset:44032
    s_waitcnt lgkmcnt(6)
    v_mfma_f32_16x16x32_bf16 v[80:83], v[16:19], v[140:143], v[80:83]
    ds_read_b64_tr_b16 v[36:37], v3 offset:46080
    v_cvt_pk_bf16_f32 v246, v68, v69
    v_mfma_f32_16x16x32_bf16 v[80:83], v[20:23], v[172:175], v[80:83]
    ds_read_b64_tr_b16 v[38:39], v3 offset:48128
    v_cvt_pk_bf16_f32 v247, v70, v71
    v_mfma_f32_16x16x32_bf16 v[72:75], v[16:19], v[136:139], v[72:75]
    ds_read_b64_tr_b16 v[16:17], v4 offset:33792
    v_permlane16_swap_b32 v244, v246
    v_mfma_f32_16x16x32_bf16 v[72:75], v[20:23], v[168:171], v[72:75]
    ds_read_b64_tr_b16 v[18:19], v4 offset:35840
    s_waitcnt lgkmcnt(6)
    v_mfma_f32_16x16x32_bf16 v[76:79], v[24:27], v[112:115], v[76:79]
    ds_read_b64_tr_b16 v[20:21], v4 offset:37888
    v_permlane16_swap_b32 v245, v247
    v_mfma_f32_16x16x32_bf16 v[76:79], v[28:31], v[184:187], v[76:79]
    ds_read_b64_tr_b16 v[22:23], v4 offset:39936
    v_mfma_f32_16x16x32_bf16 v[84:87], v[24:27], v[116:119], v[84:87]
    ds_read_b64_tr_b16 v[24:25], v4 offset:41984
    v_mfma_f32_16x16x32_bf16 v[84:87], v[28:31], v[188:191], v[84:87]
    ds_read_b64_tr_b16 v[26:27], v4 offset:44032
    s_waitcnt lgkmcnt(6)
    v_mfma_f32_16x16x32_bf16 v[84:87], v[32:35], v[140:143], v[84:87]
    ds_read_b64_tr_b16 v[28:29], v4 offset:46080
    v_mfma_f32_16x16x32_bf16 v[84:87], v[36:39], v[172:175], v[84:87]
    ds_read_b64_tr_b16 v[30:31], v4 offset:48128
    v_mfma_f32_16x16x32_bf16 v[76:79], v[32:35], v[136:139], v[76:79]
    ds_read_b64_tr_b16 v[32:33], v5 offset:33792
    v_mfma_f32_16x16x32_bf16 v[76:79], v[36:39], v[168:171], v[76:79]
    ds_read_b64_tr_b16 v[34:35], v5 offset:35840
    s_waitcnt lgkmcnt(6)
    v_mfma_f32_16x16x32_bf16 v[88:91], v[16:19], v[112:115], v[88:91]
    ds_read_b64_tr_b16 v[36:37], v5 offset:37888
    buffer_store_dwordx4 v[240:243], v6, s[24:27], s16 offen offset:64 sc0 sc1
    v_mfma_f32_16x16x32_bf16 v[88:91], v[20:23], v[184:187], v[88:91]
    ds_read_b64_tr_b16 v[38:39], v5 offset:39936
    v_mfma_f32_16x16x32_bf16 v[96:99], v[16:19], v[116:119], v[96:99]
    ds_read_b64_tr_b16 v[16:17], v5 offset:41984
    v_mfma_f32_16x16x32_bf16 v[96:99], v[20:23], v[188:191], v[96:99]
    ds_read_b64_tr_b16 v[18:19], v5 offset:44032
    s_waitcnt lgkmcnt(6)
    v_mfma_f32_16x16x32_bf16 v[96:99], v[24:27], v[140:143], v[96:99]
    ds_read_b64_tr_b16 v[20:21], v5 offset:46080
    v_mfma_f32_16x16x32_bf16 v[96:99], v[28:31], v[172:175], v[96:99]
    ds_read_b64_tr_b16 v[22:23], v5 offset:48128
    v_mfma_f32_16x16x32_bf16 v[88:91], v[24:27], v[136:139], v[88:91]
    s_barrier
    ds_read_b64_tr_b16 v[24:25], v2 offset:50688
    v_mfma_f32_16x16x32_bf16 v[88:91], v[28:31], v[168:171], v[88:91]
    ds_read_b64_tr_b16 v[26:27], v2 offset:52736
    s_waitcnt lgkmcnt(6)
    v_mfma_f32_16x16x32_bf16 v[92:95], v[32:35], v[112:115], v[92:95]
    ds_read_b64_tr_b16 v[28:29], v2 offset:54784
    v_mfma_f32_16x16x32_bf16 v[92:95], v[36:39], v[184:187], v[92:95]
    ds_read_b64_tr_b16 v[30:31], v2 offset:56832
    v_mfma_f32_16x16x32_bf16 v[100:103], v[32:35], v[116:119], v[100:103]
    ds_read_b64_tr_b16 v[32:33], v2 offset:58880
    v_mfma_f32_16x16x32_bf16 v[100:103], v[36:39], v[188:191], v[100:103]
    ds_read_b64_tr_b16 v[34:35], v2 offset:60928
    s_waitcnt lgkmcnt(6)
    v_mfma_f32_16x16x32_bf16 v[100:103], v[16:19], v[140:143], v[100:103]
    ds_read_b64_tr_b16 v[36:37], v2 offset:62976
    v_mfma_f32_16x16x32_bf16 v[100:103], v[20:23], v[172:175], v[100:103]
    ds_read_b64_tr_b16 v[38:39], v2 offset:65024
    v_mfma_f32_16x16x32_bf16 v[92:95], v[16:19], v[136:139], v[92:95]
    ds_read_b64_tr_b16 v[16:17], v3 offset:50688
    v_mfma_f32_16x16x32_bf16 v[92:95], v[20:23], v[168:171], v[92:95]
    ds_read_b64_tr_b16 v[18:19], v3 offset:52736
    s_waitcnt lgkmcnt(6)
    v_mfma_f32_16x16x32_bf16 v[72:75], v[24:27], v[232:235], v[72:75]
    ds_read_b64_tr_b16 v[20:21], v3 offset:54784
    v_mfma_f32_16x16x32_bf16 v[72:75], v[28:31], v[192:195], v[72:75]
    ds_read_b64_tr_b16 v[22:23], v3 offset:56832
    v_mfma_f32_16x16x32_bf16 v[80:83], v[24:27], v[236:239], v[80:83]
    ds_read_b64_tr_b16 v[24:25], v3 offset:58880
    v_mfma_f32_16x16x32_bf16 v[80:83], v[28:31], v[196:199], v[80:83]
    ds_read_b64_tr_b16 v[26:27], v3 offset:60928
    s_waitcnt lgkmcnt(6)
    v_mfma_f32_16x16x32_bf16 v[80:83], v[32:35], v[148:151], v[80:83]
    ds_read_b64_tr_b16 v[28:29], v3 offset:62976
    v_mfma_f32_16x16x32_bf16 v[80:83], v[36:39], v[212:215], v[80:83]
    ds_read_b64_tr_b16 v[30:31], v3 offset:65024
    v_mfma_f32_16x16x32_bf16 v[72:75], v[32:35], v[144:147], v[72:75]
    ds_read_b64_tr_b16 v[32:33], v4 offset:50688
    v_mfma_f32_16x16x32_bf16 v[72:75], v[36:39], v[208:211], v[72:75]
    ds_read_b64_tr_b16 v[34:35], v4 offset:52736
    s_waitcnt lgkmcnt(6)
    v_mfma_f32_16x16x32_bf16 v[76:79], v[16:19], v[232:235], v[76:79]
    ds_read_b64_tr_b16 v[36:37], v4 offset:54784
    v_mfma_f32_16x16x32_bf16 v[76:79], v[20:23], v[192:195], v[76:79]
    ds_read_b64_tr_b16 v[38:39], v4 offset:56832
    v_mfma_f32_16x16x32_bf16 v[84:87], v[16:19], v[236:239], v[84:87]
    ds_read_b64_tr_b16 v[16:17], v4 offset:58880
    v_mfma_f32_16x16x32_bf16 v[84:87], v[20:23], v[196:199], v[84:87]
    ds_read_b64_tr_b16 v[18:19], v4 offset:60928
    s_waitcnt lgkmcnt(6)
    v_mfma_f32_16x16x32_bf16 v[84:87], v[24:27], v[148:151], v[84:87]
    ds_read_b64_tr_b16 v[20:21], v4 offset:62976
    v_mfma_f32_16x16x32_bf16 v[84:87], v[28:31], v[212:215], v[84:87]
    ds_read_b64_tr_b16 v[22:23], v4 offset:65024
    v_mfma_f32_16x16x32_bf16 v[76:79], v[24:27], v[144:147], v[76:79]
    ds_read_b64_tr_b16 v[24:25], v5 offset:50688
    v_mfma_f32_16x16x32_bf16 v[76:79], v[28:31], v[208:211], v[76:79]
    ds_read_b64_tr_b16 v[26:27], v5 offset:52736
    s_waitcnt lgkmcnt(6)
    v_mfma_f32_16x16x32_bf16 v[88:91], v[32:35], v[232:235], v[88:91]
    ds_read_b64_tr_b16 v[28:29], v5 offset:54784
    buffer_store_dwordx4 v[244:247], v6, s[24:27], s17 offen offset:64 sc0 sc1
    v_mfma_f32_16x16x32_bf16 v[88:91], v[36:39], v[192:195], v[88:91]
    ds_read_b64_tr_b16 v[30:31], v5 offset:56832
    v_mul_f32 v72, v72, v10
    v_mfma_f32_16x16x32_bf16 v[96:99], v[32:35], v[236:239], v[96:99]
    ds_read_b64_tr_b16 v[32:33], v5 offset:58880
    v_mul_f32 v73, v73, v10
    v_mfma_f32_16x16x32_bf16 v[96:99], v[36:39], v[196:199], v[96:99]
    ds_read_b64_tr_b16 v[34:35], v5 offset:60928
    s_waitcnt lgkmcnt(6)
    v_mfma_f32_16x16x32_bf16 v[96:99], v[16:19], v[148:151], v[96:99]
    ds_read_b64_tr_b16 v[36:37], v5 offset:62976
    v_mul_f32 v74, v74, v10
    v_mfma_f32_16x16x32_bf16 v[96:99], v[20:23], v[212:215], v[96:99]
    ds_read_b64_tr_b16 v[38:39], v5 offset:65024
    v_mul_f32 v75, v75, v10
    v_mfma_f32_16x16x32_bf16 v[88:91], v[16:19], v[144:147], v[88:91]
    v_add_u32 v2, 67584, v2
    ds_read_b64_tr_b16 v[16:17], v2 offset:0
    v_mfma_f32_16x16x32_bf16 v[88:91], v[20:23], v[208:211], v[88:91]
    ds_read_b64_tr_b16 v[18:19], v2 offset:2048
    s_waitcnt lgkmcnt(6)
    v_mfma_f32_16x16x32_bf16 v[92:95], v[24:27], v[232:235], v[92:95]
    ds_read_b64_tr_b16 v[20:21], v2 offset:4096
    v_cvt_pk_bf16_f32 v72, v72, v73
    v_mfma_f32_16x16x32_bf16 v[92:95], v[28:31], v[192:195], v[92:95]
    ds_read_b64_tr_b16 v[22:23], v2 offset:6144
    v_cvt_pk_bf16_f32 v73, v74, v75
    v_mfma_f32_16x16x32_bf16 v[100:103], v[24:27], v[236:239], v[100:103]
    ds_read_b64_tr_b16 v[24:25], v2 offset:8192
    v_mul_f32 v76, v76, v10
    v_mfma_f32_16x16x32_bf16 v[100:103], v[28:31], v[196:199], v[100:103]
    ds_read_b64_tr_b16 v[26:27], v2 offset:10240
    s_waitcnt lgkmcnt(6)
    v_mfma_f32_16x16x32_bf16 v[100:103], v[32:35], v[148:151], v[100:103]
    ds_read_b64_tr_b16 v[28:29], v2 offset:12288
    v_mul_f32 v77, v77, v10
    v_mfma_f32_16x16x32_bf16 v[100:103], v[36:39], v[212:215], v[100:103]
    ds_read_b64_tr_b16 v[30:31], v2 offset:14336
    v_mul_f32 v78, v78, v10
    v_mfma_f32_16x16x32_bf16 v[92:95], v[32:35], v[144:147], v[92:95]
    v_add_u32 v3, 67584, v3
    ds_read_b64_tr_b16 v[32:33], v3 offset:0
    v_mfma_f32_16x16x32_bf16 v[92:95], v[36:39], v[208:211], v[92:95]
    ds_read_b64_tr_b16 v[34:35], v3 offset:2048
    s_waitcnt lgkmcnt(6)
    v_mfma_f32_16x16x32_bf16 v[40:43], v[16:19], v[104:107], 0
    ds_read_b64_tr_b16 v[36:37], v3 offset:4096
    v_mul_f32 v79, v79, v10
    v_mfma_f32_16x16x32_bf16 v[40:43], v[20:23], v[176:179], v[40:43]
    ds_read_b64_tr_b16 v[38:39], v3 offset:6144
    v_cvt_pk_bf16_f32 v74, v76, v77
    v_mfma_f32_16x16x32_bf16 v[48:51], v[16:19], v[108:111], 0
    ds_read_b64_tr_b16 v[16:17], v3 offset:8192
    v_cvt_pk_bf16_f32 v75, v78, v79
    v_mfma_f32_16x16x32_bf16 v[48:51], v[20:23], v[180:183], v[48:51]
    ds_read_b64_tr_b16 v[18:19], v3 offset:10240
    s_waitcnt lgkmcnt(6)
    v_mfma_f32_16x16x32_bf16 v[48:51], v[24:27], v[204:207], v[48:51]
    ds_read_b64_tr_b16 v[20:21], v3 offset:12288
    v_permlane16_swap_b32 v72, v74
    v_mfma_f32_16x16x32_bf16 v[48:51], v[28:31], v[156:159], v[48:51]
    ds_read_b64_tr_b16 v[22:23], v3 offset:14336
    v_permlane16_swap_b32 v73, v75
    v_mfma_f32_16x16x32_bf16 v[40:43], v[24:27], v[200:203], v[40:43]
    s_barrier
    v_subrev_u32 v2, 135168, v2
    ds_read_b64_tr_b16 v[24:25], v2 offset:0
    v_mfma_f32_16x16x32_bf16 v[40:43], v[28:31], v[152:155], v[40:43]
    ds_read_b64_tr_b16 v[26:27], v2 offset:2048
    s_waitcnt lgkmcnt(6)
    v_mfma_f32_16x16x32_bf16 v[44:47], v[32:35], v[104:107], 0
    ds_read_b64_tr_b16 v[28:29], v2 offset:4096
    v_mul_f32 v80, v80, v11
    v_mfma_f32_16x16x32_bf16 v[44:47], v[36:39], v[176:179], v[44:47]
    ds_read_b64_tr_b16 v[30:31], v2 offset:6144
    v_mul_f32 v81, v81, v11
    v_mfma_f32_16x16x32_bf16 v[52:55], v[32:35], v[108:111], 0
    ds_read_b64_tr_b16 v[32:33], v2 offset:8192
    v_mul_f32 v82, v82, v11
    v_mfma_f32_16x16x32_bf16 v[52:55], v[36:39], v[180:183], v[52:55]
    ds_read_b64_tr_b16 v[34:35], v2 offset:10240
    s_waitcnt lgkmcnt(6)
    v_mfma_f32_16x16x32_bf16 v[52:55], v[16:19], v[204:207], v[52:55]
    ds_read_b64_tr_b16 v[36:37], v2 offset:12288
    v_mul_f32 v83, v83, v11
    v_mfma_f32_16x16x32_bf16 v[52:55], v[20:23], v[156:159], v[52:55]
    ds_read_b64_tr_b16 v[38:39], v2 offset:14336
    v_cvt_pk_bf16_f32 v76, v80, v81
    v_mfma_f32_16x16x32_bf16 v[44:47], v[16:19], v[200:203], v[44:47]
    v_subrev_u32 v3, 135168, v3
    ds_read_b64_tr_b16 v[16:17], v3 offset:0
    v_mfma_f32_16x16x32_bf16 v[44:47], v[20:23], v[152:155], v[44:47]
    ds_read_b64_tr_b16 v[18:19], v3 offset:2048
    s_waitcnt lgkmcnt(6)
    v_mfma_f32_16x16x32_bf16 v[40:43], v[24:27], v[224:227], v[40:43]
    ds_read_b64_tr_b16 v[20:21], v3 offset:4096
    buffer_store_dwordx4 v[72:75], v6, s[24:27], s18 offen offset:0 sc0 sc1
    v_mfma_f32_16x16x32_bf16 v[40:43], v[28:31], v[120:123], v[40:43]
    ds_read_b64_tr_b16 v[22:23], v3 offset:6144
    v_cvt_pk_bf16_f32 v77, v82, v83
    v_mfma_f32_16x16x32_bf16 v[48:51], v[24:27], v[228:231], v[48:51]
    ds_read_b64_tr_b16 v[24:25], v3 offset:8192
    v_mul_f32 v84, v84, v11
    v_mfma_f32_16x16x32_bf16 v[48:51], v[28:31], v[124:127], v[48:51]
    ds_read_b64_tr_b16 v[26:27], v3 offset:10240
    s_waitcnt lgkmcnt(6)
    v_mfma_f32_16x16x32_bf16 v[48:51], v[32:35], v[132:135], v[48:51]
    ds_read_b64_tr_b16 v[28:29], v3 offset:12288
    v_mul_f32 v85, v85, v11
    v_mfma_f32_16x16x32_bf16 v[48:51], v[36:39], v[164:167], v[48:51]
    ds_read_b64_tr_b16 v[30:31], v3 offset:14336
    v_mul_f32 v86, v86, v11
    v_mfma_f32_16x16x32_bf16 v[40:43], v[32:35], v[128:131], v[40:43]
    ds_read_b64_tr_b16 v[32:33], v2 offset:16896
    v_mul_f32 v87, v87, v11
    v_mfma_f32_16x16x32_bf16 v[40:43], v[36:39], v[160:163], v[40:43]
    ds_read_b64_tr_b16 v[34:35], v2 offset:18944
    s_waitcnt lgkmcnt(6)
    v_mfma_f32_16x16x32_bf16 v[44:47], v[16:19], v[224:227], v[44:47]
    ds_read_b64_tr_b16 v[36:37], v2 offset:20992
    v_cvt_pk_bf16_f32 v78, v84, v85
    v_mfma_f32_16x16x32_bf16 v[44:47], v[20:23], v[120:123], v[44:47]
    ds_read_b64_tr_b16 v[38:39], v2 offset:23040
    v_cvt_pk_bf16_f32 v79, v86, v87
    v_mfma_f32_16x16x32_bf16 v[52:55], v[16:19], v[228:231], v[52:55]
    ds_read_b64_tr_b16 v[16:17], v2 offset:25088
    v_permlane16_swap_b32 v76, v78
    v_mfma_f32_16x16x32_bf16 v[52:55], v[20:23], v[124:127], v[52:55]
    ds_read_b64_tr_b16 v[18:19], v2 offset:27136
    s_waitcnt lgkmcnt(6)
    v_mfma_f32_16x16x32_bf16 v[52:55], v[24:27], v[132:135], v[52:55]
    ds_read_b64_tr_b16 v[20:21], v2 offset:29184
    v_permlane16_swap_b32 v77, v79
    v_mfma_f32_16x16x32_bf16 v[52:55], v[28:31], v[164:167], v[52:55]
    ds_read_b64_tr_b16 v[22:23], v2 offset:31232
    v_mul_f32 v88, v88, v10
    v_mfma_f32_16x16x32_bf16 v[44:47], v[24:27], v[128:131], v[44:47]
    ds_read_b64_tr_b16 v[24:25], v3 offset:16896
    v_mul_f32 v89, v89, v10
    v_mfma_f32_16x16x32_bf16 v[44:47], v[28:31], v[160:163], v[44:47]
    ds_read_b64_tr_b16 v[26:27], v3 offset:18944
    s_waitcnt lgkmcnt(6)
    v_mfma_f32_16x16x32_bf16 v[40:43], v[32:35], v[112:115], v[40:43]
    ds_read_b64_tr_b16 v[28:29], v3 offset:20992
    buffer_store_dwordx4 v[76:79], v6, s[24:27], s19 offen offset:0 sc0 sc1
    v_mfma_f32_16x16x32_bf16 v[40:43], v[36:39], v[184:187], v[40:43]
    ds_read_b64_tr_b16 v[30:31], v3 offset:23040
    v_mul_f32 v90, v90, v10
    v_mfma_f32_16x16x32_bf16 v[48:51], v[32:35], v[116:119], v[48:51]
    ds_read_b64_tr_b16 v[32:33], v3 offset:25088
    v_mul_f32 v91, v91, v10
    v_mfma_f32_16x16x32_bf16 v[48:51], v[36:39], v[188:191], v[48:51]
    ds_read_b64_tr_b16 v[34:35], v3 offset:27136
    s_waitcnt lgkmcnt(6)
    v_mfma_f32_16x16x32_bf16 v[48:51], v[16:19], v[140:143], v[48:51]
    ds_read_b64_tr_b16 v[36:37], v3 offset:29184
    v_cvt_pk_bf16_f32 v80, v88, v89
    v_mfma_f32_16x16x32_bf16 v[48:51], v[20:23], v[172:175], v[48:51]
    ds_read_b64_tr_b16 v[38:39], v3 offset:31232
    v_cvt_pk_bf16_f32 v81, v90, v91
    v_mfma_f32_16x16x32_bf16 v[40:43], v[16:19], v[136:139], v[40:43]
    s_barrier
    ds_read_b64_tr_b16 v[16:17], v2 offset:33792
    v_mfma_f32_16x16x32_bf16 v[40:43], v[20:23], v[168:171], v[40:43]
    ds_read_b64_tr_b16 v[18:19], v2 offset:35840
    s_waitcnt lgkmcnt(6)
    v_mfma_f32_16x16x32_bf16 v[44:47], v[24:27], v[112:115], v[44:47]
    ds_read_b64_tr_b16 v[20:21], v2 offset:37888
    v_mul_f32 v92, v92, v10
    v_mfma_f32_16x16x32_bf16 v[44:47], v[28:31], v[184:187], v[44:47]
    ds_read_b64_tr_b16 v[22:23], v2 offset:39936
    v_mul_f32 v93, v93, v10
    v_mfma_f32_16x16x32_bf16 v[52:55], v[24:27], v[116:119], v[52:55]
    ds_read_b64_tr_b16 v[24:25], v2 offset:41984
    v_mul_f32 v94, v94, v10
    v_mfma_f32_16x16x32_bf16 v[52:55], v[28:31], v[188:191], v[52:55]
    ds_read_b64_tr_b16 v[26:27], v2 offset:44032
    s_waitcnt lgkmcnt(6)
    v_mfma_f32_16x16x32_bf16 v[52:55], v[32:35], v[140:143], v[52:55]
    ds_read_b64_tr_b16 v[28:29], v2 offset:46080
    v_mul_f32 v95, v95, v10
    v_mfma_f32_16x16x32_bf16 v[52:55], v[36:39], v[172:175], v[52:55]
    ds_read_b64_tr_b16 v[30:31], v2 offset:48128
    v_cvt_pk_bf16_f32 v82, v92, v93
    v_mfma_f32_16x16x32_bf16 v[44:47], v[32:35], v[136:139], v[44:47]
    ds_read_b64_tr_b16 v[32:33], v3 offset:33792
    v_cvt_pk_bf16_f32 v83, v94, v95
    v_mfma_f32_16x16x32_bf16 v[44:47], v[36:39], v[168:171], v[44:47]
    ds_read_b64_tr_b16 v[34:35], v3 offset:35840
    s_waitcnt lgkmcnt(6)
    v_mfma_f32_16x16x32_bf16 v[40:43], v[16:19], v[232:235], v[40:43]
    ds_read_b64_tr_b16 v[36:37], v3 offset:37888
    v_permlane16_swap_b32 v80, v82
    v_mfma_f32_16x16x32_bf16 v[40:43], v[20:23], v[192:195], v[40:43]
    ds_read_b64_tr_b16 v[38:39], v3 offset:39936
    v_permlane16_swap_b32 v81, v83
    v_mfma_f32_16x16x32_bf16 v[48:51], v[16:19], v[236:239], v[48:51]
    ds_read_b64_tr_b16 v[16:17], v3 offset:41984
    buffer_store_dwordx4 v[80:83], v6, s[24:27], s18 offen offset:64 sc0 sc1
    v_mfma_f32_16x16x32_bf16 v[48:51], v[20:23], v[196:199], v[48:51]
    ds_read_b64_tr_b16 v[18:19], v3 offset:44032
    s_waitcnt lgkmcnt(6)
    v_mfma_f32_16x16x32_bf16 v[48:51], v[24:27], v[148:151], v[48:51]
    ds_read_b64_tr_b16 v[20:21], v3 offset:46080
    v_mul_f32 v96, v96, v11
    v_mfma_f32_16x16x32_bf16 v[48:51], v[28:31], v[212:215], v[48:51]
    ds_read_b64_tr_b16 v[22:23], v3 offset:48128
    v_mul_f32 v97, v97, v11
    v_mfma_f32_16x16x32_bf16 v[40:43], v[24:27], v[144:147], v[40:43]
    v_add_u32 v4, 67584, v4
    ds_read_b64_tr_b16 v[24:25], v4 offset:0
    v_mfma_f32_16x16x32_bf16 v[40:43], v[28:31], v[208:211], v[40:43]
    ds_read_b64_tr_b16 v[26:27], v4 offset:2048
    s_waitcnt lgkmcnt(6)
    v_mfma_f32_16x16x32_bf16 v[44:47], v[32:35], v[232:235], v[44:47]
    ds_read_b64_tr_b16 v[28:29], v4 offset:4096
    v_mul_f32 v98, v98, v11
    v_mfma_f32_16x16x32_bf16 v[44:47], v[36:39], v[192:195], v[44:47]
    ds_read_b64_tr_b16 v[30:31], v4 offset:6144
    v_mul_f32 v99, v99, v11
    v_mfma_f32_16x16x32_bf16 v[52:55], v[32:35], v[236:239], v[52:55]
    ds_read_b64_tr_b16 v[32:33], v4 offset:8192
    v_cvt_pk_bf16_f32 v84, v96, v97
    v_mfma_f32_16x16x32_bf16 v[52:55], v[36:39], v[196:199], v[52:55]
    ds_read_b64_tr_b16 v[34:35], v4 offset:10240
    s_waitcnt lgkmcnt(6)
    v_mfma_f32_16x16x32_bf16 v[52:55], v[16:19], v[148:151], v[52:55]
    ds_read_b64_tr_b16 v[36:37], v4 offset:12288
    v_cvt_pk_bf16_f32 v85, v98, v99
    v_mfma_f32_16x16x32_bf16 v[52:55], v[20:23], v[212:215], v[52:55]
    ds_read_b64_tr_b16 v[38:39], v4 offset:14336
    v_mul_f32 v100, v100, v11
    v_mfma_f32_16x16x32_bf16 v[44:47], v[16:19], v[144:147], v[44:47]
    v_add_u32 v5, 67584, v5
    ds_read_b64_tr_b16 v[16:17], v5 offset:0
    v_mfma_f32_16x16x32_bf16 v[44:47], v[20:23], v[208:211], v[44:47]
    ds_read_b64_tr_b16 v[18:19], v5 offset:2048
    s_waitcnt lgkmcnt(6)
    v_mfma_f32_16x16x32_bf16 v[56:59], v[24:27], v[104:107], 0
    ds_read_b64_tr_b16 v[20:21], v5 offset:4096
    v_mul_f32 v101, v101, v11
    v_mfma_f32_16x16x32_bf16 v[56:59], v[28:31], v[176:179], v[56:59]
    ds_read_b64_tr_b16 v[22:23], v5 offset:6144
    v_mul_f32 v102, v102, v11
    v_mfma_f32_16x16x32_bf16 v[64:67], v[24:27], v[108:111], 0
    ds_read_b64_tr_b16 v[24:25], v5 offset:8192
    v_mul_f32 v103, v103, v11
    v_mfma_f32_16x16x32_bf16 v[64:67], v[28:31], v[180:183], v[64:67]
    ds_read_b64_tr_b16 v[26:27], v5 offset:10240
    s_waitcnt lgkmcnt(6)
    v_mfma_f32_16x16x32_bf16 v[64:67], v[32:35], v[204:207], v[64:67]
    ds_read_b64_tr_b16 v[28:29], v5 offset:12288
    v_cvt_pk_bf16_f32 v86, v100, v101
    v_mfma_f32_16x16x32_bf16 v[64:67], v[36:39], v[156:159], v[64:67]
    ds_read_b64_tr_b16 v[30:31], v5 offset:14336
    v_cvt_pk_bf16_f32 v87, v102, v103
    v_mfma_f32_16x16x32_bf16 v[56:59], v[32:35], v[200:203], v[56:59]
    v_subrev_u32 v4, 135168, v4
    ds_read_b64_tr_b16 v[32:33], v4 offset:0
    v_mfma_f32_16x16x32_bf16 v[56:59], v[36:39], v[152:155], v[56:59]
    ds_read_b64_tr_b16 v[34:35], v4 offset:2048
    s_waitcnt lgkmcnt(6)
    v_mfma_f32_16x16x32_bf16 v[60:63], v[16:19], v[104:107], 0
    ds_read_b64_tr_b16 v[36:37], v4 offset:4096
    v_permlane16_swap_b32 v84, v86
    v_mfma_f32_16x16x32_bf16 v[60:63], v[20:23], v[176:179], v[60:63]
    ds_read_b64_tr_b16 v[38:39], v4 offset:6144
    v_permlane16_swap_b32 v85, v87
    v_mfma_f32_16x16x32_bf16 v[68:71], v[16:19], v[108:111], 0
    ds_read_b64_tr_b16 v[16:17], v4 offset:8192
    buffer_store_dwordx4 v[84:87], v6, s[24:27], s19 offen offset:64 sc0 sc1
    v_mfma_f32_16x16x32_bf16 v[68:71], v[20:23], v[180:183], v[68:71]
    ds_read_b64_tr_b16 v[18:19], v4 offset:10240
    s_waitcnt lgkmcnt(6)
    v_mfma_f32_16x16x32_bf16 v[68:71], v[24:27], v[204:207], v[68:71]
    ds_read_b64_tr_b16 v[20:21], v4 offset:12288
    v_mul_f32 v40, v40, v10
    v_mfma_f32_16x16x32_bf16 v[68:71], v[28:31], v[156:159], v[68:71]
    ds_read_b64_tr_b16 v[22:23], v4 offset:14336
    v_mul_f32 v41, v41, v10
    v_mfma_f32_16x16x32_bf16 v[60:63], v[24:27], v[200:203], v[60:63]
    v_subrev_u32 v5, 135168, v5
    ds_read_b64_tr_b16 v[24:25], v5 offset:0
    v_mfma_f32_16x16x32_bf16 v[60:63], v[28:31], v[152:155], v[60:63]
    ds_read_b64_tr_b16 v[26:27], v5 offset:2048
    s_waitcnt lgkmcnt(6)
    v_mfma_f32_16x16x32_bf16 v[56:59], v[32:35], v[224:227], v[56:59]
    ds_read_b64_tr_b16 v[28:29], v5 offset:4096
    v_mul_f32 v42, v42, v10
    v_mfma_f32_16x16x32_bf16 v[56:59], v[36:39], v[120:123], v[56:59]
    ds_read_b64_tr_b16 v[30:31], v5 offset:6144
    v_mul_f32 v43, v43, v10
    v_mfma_f32_16x16x32_bf16 v[64:67], v[32:35], v[228:231], v[64:67]
    ds_read_b64_tr_b16 v[32:33], v5 offset:8192
    v_cvt_pk_bf16_f32 v216, v40, v41
    v_mfma_f32_16x16x32_bf16 v[64:67], v[36:39], v[124:127], v[64:67]
    ds_read_b64_tr_b16 v[34:35], v5 offset:10240
    s_waitcnt lgkmcnt(6)
    v_mfma_f32_16x16x32_bf16 v[64:67], v[16:19], v[132:135], v[64:67]
    ds_read_b64_tr_b16 v[36:37], v5 offset:12288
    v_cvt_pk_bf16_f32 v217, v42, v43
    v_mfma_f32_16x16x32_bf16 v[64:67], v[20:23], v[164:167], v[64:67]
    ds_read_b64_tr_b16 v[38:39], v5 offset:14336
    v_mul_f32 v44, v44, v10
    v_mfma_f32_16x16x32_bf16 v[56:59], v[16:19], v[128:131], v[56:59]
    ds_read_b64_tr_b16 v[16:17], v4 offset:16896
    v_mul_f32 v45, v45, v10
    v_mfma_f32_16x16x32_bf16 v[56:59], v[20:23], v[160:163], v[56:59]
    ds_read_b64_tr_b16 v[18:19], v4 offset:18944
    s_waitcnt lgkmcnt(6)
    v_mfma_f32_16x16x32_bf16 v[60:63], v[24:27], v[224:227], v[60:63]
    ds_read_b64_tr_b16 v[20:21], v4 offset:20992
    v_mul_f32 v46, v46, v10
    v_mfma_f32_16x16x32_bf16 v[60:63], v[28:31], v[120:123], v[60:63]
    ds_read_b64_tr_b16 v[22:23], v4 offset:23040
    v_mul_f32 v47, v47, v10
    v_mfma_f32_16x16x32_bf16 v[68:71], v[24:27], v[228:231], v[68:71]
    ds_read_b64_tr_b16 v[24:25], v4 offset:25088
    v_cvt_pk_bf16_f32 v218, v44, v45
    v_mfma_f32_16x16x32_bf16 v[68:71], v[28:31], v[124:127], v[68:71]
    ds_read_b64_tr_b16 v[26:27], v4 offset:27136
    s_waitcnt lgkmcnt(6)
    v_mfma_f32_16x16x32_bf16 v[68:71], v[32:35], v[132:135], v[68:71]
    ds_read_b64_tr_b16 v[28:29], v4 offset:29184
    v_cvt_pk_bf16_f32 v219, v46, v47
    v_mfma_f32_16x16x32_bf16 v[68:71], v[36:39], v[164:167], v[68:71]
    ds_read_b64_tr_b16 v[30:31], v4 offset:31232
    v_permlane16_swap_b32 v216, v218
    v_mfma_f32_16x16x32_bf16 v[60:63], v[32:35], v[128:131], v[60:63]
    ds_read_b64_tr_b16 v[32:33], v5 offset:16896
    v_permlane16_swap_b32 v217, v219
    v_mfma_f32_16x16x32_bf16 v[60:63], v[36:39], v[160:163], v[60:63]
    ds_read_b64_tr_b16 v[34:35], v5 offset:18944
    s_waitcnt lgkmcnt(6)
    v_mfma_f32_16x16x32_bf16 v[56:59], v[16:19], v[112:115], v[56:59]
    ds_read_b64_tr_b16 v[36:37], v5 offset:20992
    buffer_store_dwordx4 v[216:219], v6, s[24:27], s20 offen offset:0 sc0 sc1
    v_mfma_f32_16x16x32_bf16 v[56:59], v[20:23], v[184:187], v[56:59]
    ds_read_b64_tr_b16 v[38:39], v5 offset:23040
    v_mul_f32 v48, v48, v11
    v_mfma_f32_16x16x32_bf16 v[64:67], v[16:19], v[116:119], v[64:67]
    ds_read_b64_tr_b16 v[16:17], v5 offset:25088
    v_mul_f32 v49, v49, v11
    v_mfma_f32_16x16x32_bf16 v[64:67], v[20:23], v[188:191], v[64:67]
    ds_read_b64_tr_b16 v[18:19], v5 offset:27136
    s_waitcnt lgkmcnt(6)
    v_mfma_f32_16x16x32_bf16 v[64:67], v[24:27], v[140:143], v[64:67]
    ds_read_b64_tr_b16 v[20:21], v5 offset:29184
    v_mul_f32 v50, v50, v11
    v_mfma_f32_16x16x32_bf16 v[64:67], v[28:31], v[172:175], v[64:67]
    ds_read_b64_tr_b16 v[22:23], v5 offset:31232
    v_mul_f32 v51, v51, v11
    v_mfma_f32_16x16x32_bf16 v[56:59], v[24:27], v[136:139], v[56:59]
    ds_read_b64_tr_b16 v[24:25], v4 offset:33792
    v_cvt_pk_bf16_f32 v220, v48, v49
    v_mfma_f32_16x16x32_bf16 v[56:59], v[28:31], v[168:171], v[56:59]
    ds_read_b64_tr_b16 v[26:27], v4 offset:35840
    s_waitcnt lgkmcnt(6)
    v_mfma_f32_16x16x32_bf16 v[60:63], v[32:35], v[112:115], v[60:63]
    ds_read_b64_tr_b16 v[28:29], v4 offset:37888
    v_cvt_pk_bf16_f32 v221, v50, v51
    v_mfma_f32_16x16x32_bf16 v[60:63], v[36:39], v[184:187], v[60:63]
    ds_read_b64_tr_b16 v[30:31], v4 offset:39936
    v_mul_f32 v52, v52, v11
    v_mfma_f32_16x16x32_bf16 v[68:71], v[32:35], v[116:119], v[68:71]
    ds_read_b64_tr_b16 v[32:33], v4 offset:41984
    v_mul_f32 v53, v53, v11
    v_mfma_f32_16x16x32_bf16 v[68:71], v[36:39], v[188:191], v[68:71]
    ds_read_b64_tr_b16 v[34:35], v4 offset:44032
    s_waitcnt lgkmcnt(6)
    v_mfma_f32_16x16x32_bf16 v[68:71], v[16:19], v[140:143], v[68:71]
    ds_read_b64_tr_b16 v[36:37], v4 offset:46080
    v_mul_f32 v54, v54, v11
    v_mfma_f32_16x16x32_bf16 v[68:71], v[20:23], v[172:175], v[68:71]
    ds_read_b64_tr_b16 v[38:39], v4 offset:48128
    v_mul_f32 v55, v55, v11
    v_mfma_f32_16x16x32_bf16 v[60:63], v[16:19], v[136:139], v[60:63]
    ds_read_b64_tr_b16 v[16:17], v5 offset:33792
    v_cvt_pk_bf16_f32 v222, v52, v53
    v_mfma_f32_16x16x32_bf16 v[60:63], v[20:23], v[168:171], v[60:63]
    ds_read_b64_tr_b16 v[18:19], v5 offset:35840
    s_waitcnt lgkmcnt(6)
    v_mfma_f32_16x16x32_bf16 v[56:59], v[24:27], v[232:235], v[56:59]
    ds_read_b64_tr_b16 v[20:21], v5 offset:37888
    v_cvt_pk_bf16_f32 v223, v54, v55
    v_mfma_f32_16x16x32_bf16 v[56:59], v[28:31], v[192:195], v[56:59]
    ds_read_b64_tr_b16 v[22:23], v5 offset:39936
    v_permlane16_swap_b32 v220, v222
    v_mfma_f32_16x16x32_bf16 v[64:67], v[24:27], v[236:239], v[64:67]
    ds_read_b64_tr_b16 v[24:25], v5 offset:41984
    v_permlane16_swap_b32 v221, v223
    v_mfma_f32_16x16x32_bf16 v[64:67], v[28:31], v[196:199], v[64:67]
    ds_read_b64_tr_b16 v[26:27], v5 offset:44032
    s_waitcnt lgkmcnt(6)
    v_mfma_f32_16x16x32_bf16 v[64:67], v[32:35], v[148:151], v[64:67]
    ds_read_b64_tr_b16 v[28:29], v5 offset:46080
    buffer_store_dwordx4 v[220:223], v6, s[24:27], s21 offen offset:0 sc0 sc1
    v_mfma_f32_16x16x32_bf16 v[64:67], v[36:39], v[212:215], v[64:67]
    ds_read_b64_tr_b16 v[30:31], v5 offset:48128
    v_mfma_f32_16x16x32_bf16 v[56:59], v[32:35], v[144:147], v[56:59]
    s_barrier
    ds_read_b64_tr_b16 v[32:33], v2 offset:50688
    v_mfma_f32_16x16x32_bf16 v[56:59], v[36:39], v[208:211], v[56:59]
    ds_read_b64_tr_b16 v[34:35], v2 offset:52736
    s_waitcnt lgkmcnt(6)
    v_mfma_f32_16x16x32_bf16 v[60:63], v[16:19], v[232:235], v[60:63]
    ds_read_b64_tr_b16 v[36:37], v2 offset:54784
    v_mfma_f32_16x16x32_bf16 v[60:63], v[20:23], v[192:195], v[60:63]
    ds_read_b64_tr_b16 v[38:39], v2 offset:56832
    v_mfma_f32_16x16x32_bf16 v[68:71], v[16:19], v[236:239], v[68:71]
    ds_read_b64_tr_b16 v[16:17], v2 offset:58880
    v_mfma_f32_16x16x32_bf16 v[68:71], v[20:23], v[196:199], v[68:71]
    ds_read_b64_tr_b16 v[18:19], v2 offset:60928
    s_waitcnt lgkmcnt(6)
    v_mfma_f32_16x16x32_bf16 v[68:71], v[24:27], v[148:151], v[68:71]
    ds_read_b64_tr_b16 v[20:21], v2 offset:62976
    v_mfma_f32_16x16x32_bf16 v[68:71], v[28:31], v[212:215], v[68:71]
    ds_read_b64_tr_b16 v[22:23], v2 offset:65024
    v_mfma_f32_16x16x32_bf16 v[60:63], v[24:27], v[144:147], v[60:63]
    ds_read_b64_tr_b16 v[24:25], v3 offset:50688
    v_mfma_f32_16x16x32_bf16 v[60:63], v[28:31], v[208:211], v[60:63]
    ds_read_b64_tr_b16 v[26:27], v3 offset:52736
    s_nop 1
    s_waitcnt lgkmcnt(6)
    v_mfma_f32_16x16x32_bf16 v[72:75], v[32:35], v[104:107], 0
    ds_read_b64_tr_b16 v[28:29], v3 offset:54784
    v_mul_f32 v56, v56, v10
    v_mfma_f32_16x16x32_bf16 v[72:75], v[36:39], v[176:179], v[72:75]
    ds_read_b64_tr_b16 v[30:31], v3 offset:56832
    v_mul_f32 v57, v57, v10
    v_mfma_f32_16x16x32_bf16 v[80:83], v[32:35], v[108:111], 0
    ds_read_b64_tr_b16 v[32:33], v3 offset:58880
    v_mul_f32 v58, v58, v10
    v_mfma_f32_16x16x32_bf16 v[80:83], v[36:39], v[180:183], v[80:83]
    ds_read_b64_tr_b16 v[34:35], v3 offset:60928
    s_waitcnt lgkmcnt(6)
    v_mfma_f32_16x16x32_bf16 v[80:83], v[16:19], v[204:207], v[80:83]
    ds_read_b64_tr_b16 v[36:37], v3 offset:62976
    v_mul_f32 v59, v59, v10
    v_mfma_f32_16x16x32_bf16 v[80:83], v[20:23], v[156:159], v[80:83]
    ds_read_b64_tr_b16 v[38:39], v3 offset:65024
    v_cvt_pk_bf16_f32 v240, v56, v57
    v_mfma_f32_16x16x32_bf16 v[72:75], v[16:19], v[200:203], v[72:75]
    v_add_u32 v2, 67584, v2
    ds_read_b64_tr_b16 v[16:17], v2 offset:0
    v_mfma_f32_16x16x32_bf16 v[72:75], v[20:23], v[152:155], v[72:75]
    ds_read_b64_tr_b16 v[18:19], v2 offset:2048
    s_waitcnt lgkmcnt(6)
    v_mfma_f32_16x16x32_bf16 v[76:79], v[24:27], v[104:107], 0
    ds_read_b64_tr_b16 v[20:21], v2 offset:4096
    v_cvt_pk_bf16_f32 v241, v58, v59
    v_mfma_f32_16x16x32_bf16 v[76:79], v[28:31], v[176:179], v[76:79]
    ds_read_b64_tr_b16 v[22:23], v2 offset:6144
    v_mul_f32 v60, v60, v10
    v_mfma_f32_16x16x32_bf16 v[84:87], v[24:27], v[108:111], 0
    ds_read_b64_tr_b16 v[24:25], v2 offset:8192
    v_mul_f32 v61, v61, v10
    v_mfma_f32_16x16x32_bf16 v[84:87], v[28:31], v[180:183], v[84:87]
    ds_read_b64_tr_b16 v[26:27], v2 offset:10240
    s_waitcnt lgkmcnt(6)
    v_mfma_f32_16x16x32_bf16 v[84:87], v[32:35], v[204:207], v[84:87]
    ds_read_b64_tr_b16 v[28:29], v2 offset:12288
    v_mul_f32 v62, v62, v10
    v_mfma_f32_16x16x32_bf16 v[84:87], v[36:39], v[156:159], v[84:87]
    ds_read_b64_tr_b16 v[30:31], v2 offset:14336
    v_mul_f32 v63, v63, v10
    v_mfma_f32_16x16x32_bf16 v[76:79], v[32:35], v[200:203], v[76:79]
    v_add_u32 v3, 67584, v3
    ds_read_b64_tr_b16 v[32:33], v3 offset:0
    v_mfma_f32_16x16x32_bf16 v[76:79], v[36:39], v[152:155], v[76:79]
    ds_read_b64_tr_b16 v[34:35], v3 offset:2048
    s_waitcnt lgkmcnt(6)
    v_mfma_f32_16x16x32_bf16 v[72:75], v[16:19], v[224:227], v[72:75]
    ds_read_b64_tr_b16 v[36:37], v3 offset:4096
    v_cvt_pk_bf16_f32 v242, v60, v61
    v_mfma_f32_16x16x32_bf16 v[72:75], v[20:23], v[120:123], v[72:75]
    ds_read_b64_tr_b16 v[38:39], v3 offset:6144
    v_cvt_pk_bf16_f32 v243, v62, v63
    v_mfma_f32_16x16x32_bf16 v[80:83], v[16:19], v[228:231], v[80:83]
    ds_read_b64_tr_b16 v[16:17], v3 offset:8192
    v_permlane16_swap_b32 v240, v242
    v_mfma_f32_16x16x32_bf16 v[80:83], v[20:23], v[124:127], v[80:83]
    ds_read_b64_tr_b16 v[18:19], v3 offset:10240
    s_waitcnt lgkmcnt(6)
    v_mfma_f32_16x16x32_bf16 v[80:83], v[24:27], v[132:135], v[80:83]
    ds_read_b64_tr_b16 v[20:21], v3 offset:12288
    v_permlane16_swap_b32 v241, v243
    v_mfma_f32_16x16x32_bf16 v[80:83], v[28:31], v[164:167], v[80:83]
    ds_read_b64_tr_b16 v[22:23], v3 offset:14336
    buffer_store_dwordx4 v[240:243], v6, s[24:27], s20 offen offset:64 sc0 sc1
    v_mfma_f32_16x16x32_bf16 v[72:75], v[24:27], v[128:131], v[72:75]
    ds_read_b64_tr_b16 v[24:25], v2 offset:16896
    v_mul_f32 v64, v64, v11
    v_mfma_f32_16x16x32_bf16 v[72:75], v[28:31], v[160:163], v[72:75]
    ds_read_b64_tr_b16 v[26:27], v2 offset:18944
    s_waitcnt lgkmcnt(6)
    v_mfma_f32_16x16x32_bf16 v[76:79], v[32:35], v[224:227], v[76:79]
    ds_read_b64_tr_b16 v[28:29], v2 offset:20992
    v_mul_f32 v65, v65, v11
    v_mfma_f32_16x16x32_bf16 v[76:79], v[36:39], v[120:123], v[76:79]
    ds_read_b64_tr_b16 v[30:31], v2 offset:23040
    v_mul_f32 v66, v66, v11
    v_mfma_f32_16x16x32_bf16 v[84:87], v[32:35], v[228:231], v[84:87]
    ds_read_b64_tr_b16 v[32:33], v2 offset:25088
    v_mul_f32 v67, v67, v11
    v_mfma_f32_16x16x32_bf16 v[84:87], v[36:39], v[124:127], v[84:87]
    ds_read_b64_tr_b16 v[34:35], v2 offset:27136
    s_waitcnt lgkmcnt(6)
    v_mfma_f32_16x16x32_bf16 v[84:87], v[16:19], v[132:135], v[84:87]
    ds_read_b64_tr_b16 v[36:37], v2 offset:29184
    v_cvt_pk_bf16_f32 v244, v64, v65
    v_mfma_f32_16x16x32_bf16 v[84:87], v[20:23], v[164:167], v[84:87]
    ds_read_b64_tr_b16 v[38:39], v2 offset:31232
    v_cvt_pk_bf16_f32 v245, v66, v67
    v_mfma_f32_16x16x32_bf16 v[76:79], v[16:19], v[128:131], v[76:79]
    ds_read_b64_tr_b16 v[16:17], v3 offset:16896
    v_mul_f32 v68, v68, v11
    v_mfma_f32_16x16x32_bf16 v[76:79], v[20:23], v[160:163], v[76:79]
    ds_read_b64_tr_b16 v[18:19], v3 offset:18944
    s_waitcnt lgkmcnt(6)
    v_mfma_f32_16x16x32_bf16 v[72:75], v[24:27], v[112:115], v[72:75]
    ds_read_b64_tr_b16 v[20:21], v3 offset:20992
    v_mul_f32 v69, v69, v11
    v_mfma_f32_16x16x32_bf16 v[72:75], v[28:31], v[184:187], v[72:75]
    ds_read_b64_tr_b16 v[22:23], v3 offset:23040
    v_mul_f32 v70, v70, v11
    v_mfma_f32_16x16x32_bf16 v[80:83], v[24:27], v[116:119], v[80:83]
    ds_read_b64_tr_b16 v[24:25], v3 offset:25088
    v_mul_f32 v71, v71, v11
    v_mfma_f32_16x16x32_bf16 v[80:83], v[28:31], v[188:191], v[80:83]
    ds_read_b64_tr_b16 v[26:27], v3 offset:27136
    s_waitcnt lgkmcnt(6)
    v_mfma_f32_16x16x32_bf16 v[80:83], v[32:35], v[140:143], v[80:83]
    ds_read_b64_tr_b16 v[28:29], v3 offset:29184
    v_cvt_pk_bf16_f32 v246, v68, v69
    v_mfma_f32_16x16x32_bf16 v[80:83], v[36:39], v[172:175], v[80:83]
    ds_read_b64_tr_b16 v[30:31], v3 offset:31232
    v_cvt_pk_bf16_f32 v247, v70, v71
    v_mfma_f32_16x16x32_bf16 v[72:75], v[32:35], v[136:139], v[72:75]
    ds_read_b64_tr_b16 v[32:33], v2 offset:33792
    v_permlane16_swap_b32 v244, v246
    v_mfma_f32_16x16x32_bf16 v[72:75], v[36:39], v[168:171], v[72:75]
    ds_read_b64_tr_b16 v[34:35], v2 offset:35840
    s_waitcnt lgkmcnt(6)
    v_mfma_f32_16x16x32_bf16 v[76:79], v[16:19], v[112:115], v[76:79]
    ds_read_b64_tr_b16 v[36:37], v2 offset:37888
    v_permlane16_swap_b32 v245, v247
    v_mfma_f32_16x16x32_bf16 v[76:79], v[20:23], v[184:187], v[76:79]
    ds_read_b64_tr_b16 v[38:39], v2 offset:39936
    buffer_store_dwordx4 v[244:247], v6, s[24:27], s21 offen offset:64 sc0 sc1
    v_mfma_f32_16x16x32_bf16 v[84:87], v[16:19], v[116:119], v[84:87]
    ds_read_b64_tr_b16 v[16:17], v2 offset:41984
    v_mfma_f32_16x16x32_bf16 v[84:87], v[20:23], v[188:191], v[84:87]
    ds_read_b64_tr_b16 v[18:19], v2 offset:44032
    s_waitcnt lgkmcnt(6)
    v_mfma_f32_16x16x32_bf16 v[84:87], v[24:27], v[140:143], v[84:87]
    ds_read_b64_tr_b16 v[20:21], v2 offset:46080
    v_mfma_f32_16x16x32_bf16 v[84:87], v[28:31], v[172:175], v[84:87]
    ds_read_b64_tr_b16 v[22:23], v2 offset:48128
    v_mfma_f32_16x16x32_bf16 v[76:79], v[24:27], v[136:139], v[76:79]
    ds_read_b64_tr_b16 v[24:25], v3 offset:33792
    v_mfma_f32_16x16x32_bf16 v[76:79], v[28:31], v[168:171], v[76:79]
    ds_read_b64_tr_b16 v[26:27], v3 offset:35840
    s_waitcnt lgkmcnt(6)
    v_mfma_f32_16x16x32_bf16 v[72:75], v[32:35], v[232:235], v[72:75]
    ds_read_b64_tr_b16 v[28:29], v3 offset:37888
    v_mfma_f32_16x16x32_bf16 v[72:75], v[36:39], v[192:195], v[72:75]
    ds_read_b64_tr_b16 v[30:31], v3 offset:39936
    v_mfma_f32_16x16x32_bf16 v[80:83], v[32:35], v[236:239], v[80:83]
    ds_read_b64_tr_b16 v[32:33], v3 offset:41984
    v_mfma_f32_16x16x32_bf16 v[80:83], v[36:39], v[196:199], v[80:83]
    ds_read_b64_tr_b16 v[34:35], v3 offset:44032
    s_waitcnt lgkmcnt(6)
    v_mfma_f32_16x16x32_bf16 v[80:83], v[16:19], v[148:151], v[80:83]
    ds_read_b64_tr_b16 v[36:37], v3 offset:46080
    v_mfma_f32_16x16x32_bf16 v[80:83], v[20:23], v[212:215], v[80:83]
    ds_read_b64_tr_b16 v[38:39], v3 offset:48128
    v_mfma_f32_16x16x32_bf16 v[72:75], v[16:19], v[144:147], v[72:75]
    ds_read_b64_tr_b16 v[16:17], v4 offset:50688
    v_mfma_f32_16x16x32_bf16 v[72:75], v[20:23], v[208:211], v[72:75]
    ds_read_b64_tr_b16 v[18:19], v4 offset:52736
    s_waitcnt lgkmcnt(6)
    v_mfma_f32_16x16x32_bf16 v[76:79], v[24:27], v[232:235], v[76:79]
    ds_read_b64_tr_b16 v[20:21], v4 offset:54784
    v_mfma_f32_16x16x32_bf16 v[76:79], v[28:31], v[192:195], v[76:79]
    ds_read_b64_tr_b16 v[22:23], v4 offset:56832
    v_mfma_f32_16x16x32_bf16 v[84:87], v[24:27], v[236:239], v[84:87]
    ds_read_b64_tr_b16 v[24:25], v4 offset:58880
    v_mfma_f32_16x16x32_bf16 v[84:87], v[28:31], v[196:199], v[84:87]
    ds_read_b64_tr_b16 v[26:27], v4 offset:60928
    s_waitcnt lgkmcnt(6)
    v_mfma_f32_16x16x32_bf16 v[84:87], v[32:35], v[148:151], v[84:87]
    ds_read_b64_tr_b16 v[28:29], v4 offset:62976
    v_mfma_f32_16x16x32_bf16 v[84:87], v[36:39], v[212:215], v[84:87]
    ds_read_b64_tr_b16 v[30:31], v4 offset:65024
    v_mfma_f32_16x16x32_bf16 v[76:79], v[32:35], v[144:147], v[76:79]
    ds_read_b64_tr_b16 v[32:33], v5 offset:50688
    v_mfma_f32_16x16x32_bf16 v[76:79], v[36:39], v[208:211], v[76:79]
    ds_read_b64_tr_b16 v[34:35], v5 offset:52736
    s_waitcnt lgkmcnt(6)
    v_mfma_f32_16x16x32_bf16 v[88:91], v[16:19], v[104:107], 0
    ds_read_b64_tr_b16 v[36:37], v5 offset:54784
    v_mul_f32 v72, v72, v10
    v_mfma_f32_16x16x32_bf16 v[88:91], v[20:23], v[176:179], v[88:91]
    ds_read_b64_tr_b16 v[38:39], v5 offset:56832
    v_mul_f32 v73, v73, v10
    v_mfma_f32_16x16x32_bf16 v[96:99], v[16:19], v[108:111], 0
    ds_read_b64_tr_b16 v[16:17], v5 offset:58880
    v_mul_f32 v74, v74, v10
    v_mfma_f32_16x16x32_bf16 v[96:99], v[20:23], v[180:183], v[96:99]
    ds_read_b64_tr_b16 v[18:19], v5 offset:60928
    s_waitcnt lgkmcnt(6)
    v_mfma_f32_16x16x32_bf16 v[96:99], v[24:27], v[204:207], v[96:99]
    ds_read_b64_tr_b16 v[20:21], v5 offset:62976
    v_mul_f32 v75, v75, v10
    v_mfma_f32_16x16x32_bf16 v[96:99], v[28:31], v[156:159], v[96:99]
    ds_read_b64_tr_b16 v[22:23], v5 offset:65024
    v_cvt_pk_bf16_f32 v72, v72, v73
    v_mfma_f32_16x16x32_bf16 v[88:91], v[24:27], v[200:203], v[88:91]
    v_add_u32 v4, 67584, v4
    ds_read_b64_tr_b16 v[24:25], v4 offset:0
    v_mfma_f32_16x16x32_bf16 v[88:91], v[28:31], v[152:155], v[88:91]
    ds_read_b64_tr_b16 v[26:27], v4 offset:2048
    s_waitcnt lgkmcnt(6)
    v_mfma_f32_16x16x32_bf16 v[92:95], v[32:35], v[104:107], 0
    ds_read_b64_tr_b16 v[28:29], v4 offset:4096
    v_cvt_pk_bf16_f32 v73, v74, v75
    v_mfma_f32_16x16x32_bf16 v[92:95], v[36:39], v[176:179], v[92:95]
    ds_read_b64_tr_b16 v[30:31], v4 offset:6144
    v_mul_f32 v76, v76, v10
    v_mfma_f32_16x16x32_bf16 v[100:103], v[32:35], v[108:111], 0
    ds_read_b64_tr_b16 v[32:33], v4 offset:8192
    v_mul_f32 v77, v77, v10
    v_mfma_f32_16x16x32_bf16 v[100:103], v[36:39], v[180:183], v[100:103]
    ds_read_b64_tr_b16 v[34:35], v4 offset:10240
    s_waitcnt lgkmcnt(6)
    v_mfma_f32_16x16x32_bf16 v[100:103], v[16:19], v[204:207], v[100:103]
    ds_read_b64_tr_b16 v[36:37], v4 offset:12288
    v_mul_f32 v78, v78, v10
    v_mfma_f32_16x16x32_bf16 v[100:103], v[20:23], v[156:159], v[100:103]
    ds_read_b64_tr_b16 v[38:39], v4 offset:14336
    v_mul_f32 v79, v79, v10
    v_mfma_f32_16x16x32_bf16 v[92:95], v[16:19], v[200:203], v[92:95]
    v_add_u32 v5, 67584, v5
    ds_read_b64_tr_b16 v[16:17], v5 offset:0
    v_mfma_f32_16x16x32_bf16 v[92:95], v[20:23], v[152:155], v[92:95]
    ds_read_b64_tr_b16 v[18:19], v5 offset:2048
    s_waitcnt lgkmcnt(6)
    v_mfma_f32_16x16x32_bf16 v[88:91], v[24:27], v[224:227], v[88:91]
    ds_read_b64_tr_b16 v[20:21], v5 offset:4096
    v_cvt_pk_bf16_f32 v74, v76, v77
    v_mfma_f32_16x16x32_bf16 v[88:91], v[28:31], v[120:123], v[88:91]
    ds_read_b64_tr_b16 v[22:23], v5 offset:6144
    v_cvt_pk_bf16_f32 v75, v78, v79
    v_mfma_f32_16x16x32_bf16 v[96:99], v[24:27], v[228:231], v[96:99]
    ds_read_b64_tr_b16 v[24:25], v5 offset:8192
    v_permlane16_swap_b32 v72, v74
    v_mfma_f32_16x16x32_bf16 v[96:99], v[28:31], v[124:127], v[96:99]
    ds_read_b64_tr_b16 v[26:27], v5 offset:10240
    s_waitcnt lgkmcnt(6)
    v_mfma_f32_16x16x32_bf16 v[96:99], v[32:35], v[132:135], v[96:99]
    ds_read_b64_tr_b16 v[28:29], v5 offset:12288
    v_permlane16_swap_b32 v73, v75
    v_mfma_f32_16x16x32_bf16 v[96:99], v[36:39], v[164:167], v[96:99]
    ds_read_b64_tr_b16 v[30:31], v5 offset:14336
    buffer_store_dwordx4 v[72:75], v6, s[24:27], s22 offen offset:0 sc0 sc1
    v_mfma_f32_16x16x32_bf16 v[88:91], v[32:35], v[128:131], v[88:91]
    ds_read_b64_tr_b16 v[32:33], v4 offset:16896
    v_mul_f32 v80, v80, v11
    v_mfma_f32_16x16x32_bf16 v[88:91], v[36:39], v[160:163], v[88:91]
    ds_read_b64_tr_b16 v[34:35], v4 offset:18944
    s_waitcnt lgkmcnt(6)
    v_mfma_f32_16x16x32_bf16 v[92:95], v[16:19], v[224:227], v[92:95]
    ds_read_b64_tr_b16 v[36:37], v4 offset:20992
    v_mul_f32 v81, v81, v11
    v_mfma_f32_16x16x32_bf16 v[92:95], v[20:23], v[120:123], v[92:95]
    ds_read_b64_tr_b16 v[38:39], v4 offset:23040
    v_mul_f32 v82, v82, v11
    v_mfma_f32_16x16x32_bf16 v[100:103], v[16:19], v[228:231], v[100:103]
    ds_read_b64_tr_b16 v[16:17], v4 offset:25088
    v_mul_f32 v83, v83, v11
    v_mfma_f32_16x16x32_bf16 v[100:103], v[20:23], v[124:127], v[100:103]
    ds_read_b64_tr_b16 v[18:19], v4 offset:27136
    s_waitcnt lgkmcnt(6)
    v_mfma_f32_16x16x32_bf16 v[100:103], v[24:27], v[132:135], v[100:103]
    ds_read_b64_tr_b16 v[20:21], v4 offset:29184
    v_cvt_pk_bf16_f32 v76, v80, v81
    v_mfma_f32_16x16x32_bf16 v[100:103], v[28:31], v[164:167], v[100:103]
    ds_read_b64_tr_b16 v[22:23], v4 offset:31232
    v_cvt_pk_bf16_f32 v77, v82, v83
    v_mfma_f32_16x16x32_bf16 v[92:95], v[24:27], v[128:131], v[92:95]
    ds_read_b64_tr_b16 v[24:25], v5 offset:16896
    v_mul_f32 v84, v84, v11
    v_mfma_f32_16x16x32_bf16 v[92:95], v[28:31], v[160:163], v[92:95]
    ds_read_b64_tr_b16 v[26:27], v5 offset:18944
    s_waitcnt lgkmcnt(6)
    v_mfma_f32_16x16x32_bf16 v[88:91], v[32:35], v[112:115], v[88:91]
    ds_read_b64_tr_b16 v[28:29], v5 offset:20992
    v_mul_f32 v85, v85, v11
    v_mfma_f32_16x16x32_bf16 v[88:91], v[36:39], v[184:187], v[88:91]
    ds_read_b64_tr_b16 v[30:31], v5 offset:23040
    v_mul_f32 v86, v86, v11
    v_mfma_f32_16x16x32_bf16 v[96:99], v[32:35], v[116:119], v[96:99]
    ds_read_b64_tr_b16 v[32:33], v5 offset:25088
    v_mul_f32 v87, v87, v11
    v_mfma_f32_16x16x32_bf16 v[96:99], v[36:39], v[188:191], v[96:99]
    ds_read_b64_tr_b16 v[34:35], v5 offset:27136
    s_waitcnt lgkmcnt(6)
    v_mfma_f32_16x16x32_bf16 v[96:99], v[16:19], v[140:143], v[96:99]
    ds_read_b64_tr_b16 v[36:37], v5 offset:29184
    v_cvt_pk_bf16_f32 v78, v84, v85
    v_mfma_f32_16x16x32_bf16 v[96:99], v[20:23], v[172:175], v[96:99]
    ds_read_b64_tr_b16 v[38:39], v5 offset:31232
    v_cvt_pk_bf16_f32 v79, v86, v87
    v_mfma_f32_16x16x32_bf16 v[88:91], v[16:19], v[136:139], v[88:91]
    ds_read_b64_tr_b16 v[16:17], v4 offset:33792
    v_permlane16_swap_b32 v76, v78
    v_mfma_f32_16x16x32_bf16 v[88:91], v[20:23], v[168:171], v[88:91]
    ds_read_b64_tr_b16 v[18:19], v4 offset:35840
    s_waitcnt lgkmcnt(6)
    v_mfma_f32_16x16x32_bf16 v[92:95], v[24:27], v[112:115], v[92:95]
    ds_read_b64_tr_b16 v[20:21], v4 offset:37888
    v_permlane16_swap_b32 v77, v79
    v_mfma_f32_16x16x32_bf16 v[92:95], v[28:31], v[184:187], v[92:95]
    ds_read_b64_tr_b16 v[22:23], v4 offset:39936
    buffer_store_dwordx4 v[76:79], v6, s[24:27], s23 offen offset:0 sc0 sc1
    v_mfma_f32_16x16x32_bf16 v[100:103], v[24:27], v[116:119], v[100:103]
    ds_read_b64_tr_b16 v[24:25], v4 offset:41984
    v_mfma_f32_16x16x32_bf16 v[100:103], v[28:31], v[188:191], v[100:103]
    ds_read_b64_tr_b16 v[26:27], v4 offset:44032
    s_waitcnt lgkmcnt(6)
    v_mfma_f32_16x16x32_bf16 v[100:103], v[32:35], v[140:143], v[100:103]
    ds_read_b64_tr_b16 v[28:29], v4 offset:46080
    v_mfma_f32_16x16x32_bf16 v[100:103], v[36:39], v[172:175], v[100:103]
    ds_read_b64_tr_b16 v[30:31], v4 offset:48128
    v_mfma_f32_16x16x32_bf16 v[92:95], v[32:35], v[136:139], v[92:95]
    ds_read_b64_tr_b16 v[32:33], v5 offset:33792
    v_mfma_f32_16x16x32_bf16 v[92:95], v[36:39], v[168:171], v[92:95]
    ds_read_b64_tr_b16 v[34:35], v5 offset:35840
    s_waitcnt lgkmcnt(6)
    v_mfma_f32_16x16x32_bf16 v[88:91], v[16:19], v[232:235], v[88:91]
    ds_read_b64_tr_b16 v[36:37], v5 offset:37888
    v_mfma_f32_16x16x32_bf16 v[88:91], v[20:23], v[192:195], v[88:91]
    ds_read_b64_tr_b16 v[38:39], v5 offset:39936
    v_mfma_f32_16x16x32_bf16 v[96:99], v[16:19], v[236:239], v[96:99]
    ds_read_b64_tr_b16 v[16:17], v5 offset:41984
    v_mfma_f32_16x16x32_bf16 v[96:99], v[20:23], v[196:199], v[96:99]
    ds_read_b64_tr_b16 v[18:19], v5 offset:44032
    s_waitcnt lgkmcnt(6)
    v_mfma_f32_16x16x32_bf16 v[96:99], v[24:27], v[148:151], v[96:99]
    ds_read_b64_tr_b16 v[20:21], v5 offset:46080
    v_mfma_f32_16x16x32_bf16 v[96:99], v[28:31], v[212:215], v[96:99]
    ds_read_b64_tr_b16 v[22:23], v5 offset:48128
    v_mfma_f32_16x16x32_bf16 v[88:91], v[24:27], v[144:147], v[88:91]
    v_mfma_f32_16x16x32_bf16 v[88:91], v[28:31], v[208:211], v[88:91]
    s_waitcnt lgkmcnt(4)
    v_mfma_f32_16x16x32_bf16 v[92:95], v[32:35], v[232:235], v[92:95]
    v_mfma_f32_16x16x32_bf16 v[92:95], v[36:39], v[192:195], v[92:95]
    v_mfma_f32_16x16x32_bf16 v[100:103], v[32:35], v[236:239], v[100:103]
    v_mfma_f32_16x16x32_bf16 v[100:103], v[36:39], v[196:199], v[100:103]
    v_mul_f32 v96, v96, v11
    s_waitcnt lgkmcnt(0)
    v_mfma_f32_16x16x32_bf16 v[100:103], v[16:19], v[148:151], v[100:103]
    v_mul_f32 v88, v88, v10
    v_mul_f32 v89, v89, v10
    v_mfma_f32_16x16x32_bf16 v[100:103], v[20:23], v[212:215], v[100:103]
    v_mul_f32 v90, v90, v10
    v_mul_f32 v91, v91, v10
    v_mfma_f32_16x16x32_bf16 v[92:95], v[16:19], v[144:147], v[92:95]
    v_cvt_pk_bf16_f32 v80, v88, v89
    v_cvt_pk_bf16_f32 v81, v90, v91
    v_mfma_f32_16x16x32_bf16 v[92:95], v[20:23], v[208:211], v[92:95]
    v_mul_f32 v97, v97, v11
    v_mul_f32 v98, v98, v11
    v_mul_f32 v99, v99, v11
    v_cvt_pk_bf16_f32 v84, v96, v97
    v_cvt_pk_bf16_f32 v85, v98, v99
    s_nop 0
    s_nop 0
    s_nop 0
    v_mul_f32 v92, v92, v10
    v_mul_f32 v93, v93, v10
    v_mul_f32 v94, v94, v10
    v_mul_f32 v95, v95, v10
    v_cvt_pk_bf16_f32 v82, v92, v93
    v_cvt_pk_bf16_f32 v83, v94, v95
    v_mul_f32 v100, v100, v11
    v_permlane16_swap_b32 v80, v82
    v_permlane16_swap_b32 v81, v83
    buffer_store_dwordx4 v[80:83], v6, s[24:27], s22 offen offset:64 sc0 sc1
    v_mul_f32 v101, v101, v11
    v_mul_f32 v102, v102, v11
    v_mul_f32 v103, v103, v11
    v_cvt_pk_bf16_f32 v86, v100, v101
    v_cvt_pk_bf16_f32 v87, v102, v103
    s_nop 0
    v_permlane16_swap_b32 v84, v86
    v_permlane16_swap_b32 v85, v87
    buffer_store_dwordx4 v[84:87], v6, s[24:27], s23 offen offset:64 sc0 sc1
    s_endpgm
L_redo_compute_safe:
    s_waitcnt vmcnt(0) lgkmcnt(0)
    s_barrier
    v_mov_b32 v8, v14
    s_nop 1
    v_permlane32_swap_b32 v8, v14
    s_nop 1
    v_max_f32 v14, v8, v14
    v_mov_b32 v8, v14
    s_nop 1
    v_permlane16_swap_b32 v8, v14
    s_nop 1
    v_max_f32 v14, v8, v14
    v_sub_f32 v12, v12, v14
    v_mov_b32 v8, v15
    s_nop 1
    v_permlane32_swap_b32 v8, v15
    s_nop 1
    v_max_f32 v15, v8, v15
    v_mov_b32 v8, v15
    s_nop 1
    v_permlane16_swap_b32 v8, v15
    s_nop 1
    v_max_f32 v15, v8, v15
    v_sub_f32 v13, v13, v15
    s_mov_b64 s[32:33], -1
    s_nop 15
    s_branch L_restart_compute_safe
L_restart_loader_safe:
    s_add_u32 m0, s36, 118272
    s_add_u32 s30, s92, 0
    buffer_load_dwordx4 v2, s[12:15], s30 offen nt lds
    s_add_u32 m0, s36, 119296
    s_add_u32 s30, s92, 4096
    buffer_load_dwordx4 v3, s[12:15], s30 offen nt lds
    s_add_u32 m0, s36, 120320
    s_add_u32 s30, s92, 8192
    buffer_load_dwordx4 v2, s[12:15], s30 offen nt lds
    s_add_u32 m0, s36, 121344
    s_add_u32 s30, s92, 12288
    buffer_load_dwordx4 v3, s[12:15], s30 offen nt lds
    s_add_u32 m0, s36, 135168
    s_add_u32 s30, s93, 0
    buffer_load_dwordx4 v2, s[16:19], s30 offen nt lds
    s_add_u32 m0, s36, 136192
    s_add_u32 s30, s93, 4096
    buffer_load_dwordx4 v3, s[16:19], s30 offen nt lds
    s_add_u32 m0, s36, 137216
    s_add_u32 s30, s93, 8192
    buffer_load_dwordx4 v2, s[16:19], s30 offen nt lds
    s_add_u32 m0, s36, 138240
    s_add_u32 s30, s93, 12288
    buffer_load_dwordx4 v3, s[16:19], s30 offen nt lds
    s_add_u32 m0, s36, 0
    s_add_u32 s30, s92, 0
    buffer_load_dwordx4 v16, s[12:15], s30 offen nt lds
    s_add_u32 m0, s36, 1024
    s_add_u32 s30, s92, 4096
    buffer_load_dwordx4 v17, s[12:15], s30 offen nt lds
    s_add_u32 m0, s36, 2048
    s_add_u32 s30, s92, 8192
    buffer_load_dwordx4 v16, s[12:15], s30 offen nt lds
    s_add_u32 m0, s36, 3072
    s_add_u32 s30, s92, 12288
    buffer_load_dwordx4 v17, s[12:15], s30 offen nt lds
    s_waitcnt vmcnt(8)
    s_barrier
    s_add_u32 m0, s36, 16896
    s_add_u32 s30, s93, 0
    buffer_load_dwordx4 v16, s[16:19], s30 offen nt lds
    s_add_u32 m0, s36, 17920
    s_add_u32 s30, s93, 4096
    buffer_load_dwordx4 v17, s[16:19], s30 offen nt lds
    s_add_u32 m0, s36, 18944
    s_add_u32 s30, s93, 8192
    buffer_load_dwordx4 v16, s[16:19], s30 offen nt lds
    s_add_u32 m0, s36, 19968
    s_add_u32 s30, s93, 12288
    buffer_load_dwordx4 v17, s[16:19], s30 offen nt lds
    s_waitcnt vmcnt(8)
    s_barrier
    s_add_u32 m0, s36, 33792
    s_add_u32 s30, s92, 0
    buffer_load_dwordx4 v18, s[12:15], s30 offen nt lds
    s_add_u32 m0, s36, 34816
    s_add_u32 s30, s92, 4096
    buffer_load_dwordx4 v19, s[12:15], s30 offen nt lds
    s_add_u32 m0, s36, 35840
    s_add_u32 s30, s92, 8192
    buffer_load_dwordx4 v18, s[12:15], s30 offen nt lds
    s_add_u32 m0, s36, 36864
    s_add_u32 s30, s92, 12288
    buffer_load_dwordx4 v19, s[12:15], s30 offen nt lds
    s_waitcnt vmcnt(8)
    s_barrier
    s_add_u32 m0, s36, 50688
    s_add_u32 s30, s93, 0
    buffer_load_dwordx4 v18, s[16:19], s30 offen nt lds
    s_add_u32 m0, s36, 51712
    s_add_u32 s30, s93, 4096
    buffer_load_dwordx4 v19, s[16:19], s30 offen nt lds
    s_add_u32 m0, s36, 52736
    s_add_u32 s30, s93, 8192
    buffer_load_dwordx4 v18, s[16:19], s30 offen nt lds
    s_add_u32 m0, s36, 53760
    s_add_u32 s30, s93, 12288
    buffer_load_dwordx4 v19, s[16:19], s30 offen nt lds
    s_waitcnt vmcnt(8)
    s_barrier
    s_add_u32 m0, s36, 67584
    s_add_u32 s30, s92, 0
    buffer_load_dwordx4 v20, s[12:15], s30 offen nt lds
    s_add_u32 m0, s36, 68608
    s_add_u32 s30, s92, 4096
    buffer_load_dwordx4 v21, s[12:15], s30 offen nt lds
    s_add_u32 m0, s36, 69632
    s_add_u32 s30, s92, 8192
    buffer_load_dwordx4 v20, s[12:15], s30 offen nt lds
    s_add_u32 m0, s36, 70656
    s_add_u32 s30, s92, 12288
    buffer_load_dwordx4 v21, s[12:15], s30 offen nt lds
    s_waitcnt vmcnt(8)
    s_barrier
    s_add_u32 m0, s36, 84480
    s_add_u32 s30, s93, 0
    buffer_load_dwordx4 v20, s[16:19], s30 offen nt lds
    s_add_u32 m0, s36, 85504
    s_add_u32 s30, s93, 4096
    buffer_load_dwordx4 v21, s[16:19], s30 offen nt lds
    s_add_u32 m0, s36, 86528
    s_add_u32 s30, s93, 8192
    buffer_load_dwordx4 v20, s[16:19], s30 offen nt lds
    s_add_u32 m0, s36, 87552
    s_add_u32 s30, s93, 12288
    buffer_load_dwordx4 v21, s[16:19], s30 offen nt lds
    s_waitcnt vmcnt(8)
    s_barrier
    s_xor_b32 s30, s94, 65536
    s_add_u32 m0, s37, 101376
    s_nop 0
    buffer_load_dwordx4 v4, s[16:19], s30 offen offset:0  lds
    s_add_u32 m0, s37, 101408
    s_nop 0
    buffer_load_dwordx4 v4, s[16:19], s30 offen offset:1024  lds
    s_add_u32 m0, s37, 101440
    s_nop 0
    buffer_load_dwordx4 v4, s[16:19], s30 offen offset:2048  lds
    s_add_u32 m0, s37, 101472
    s_nop 0
    buffer_load_dwordx4 v4, s[16:19], s30 offen offset:3072  lds
    s_waitcnt vmcnt(8)
    s_barrier
    s_xor_b32 s30, s94, 81920
    s_add_u32 m0, s37, 118272
    s_nop 0
    buffer_load_dwordx4 v4, s[16:19], s30 offen offset:0  lds
    s_add_u32 m0, s37, 118304
    s_nop 0
    buffer_load_dwordx4 v4, s[16:19], s30 offen offset:1024  lds
    s_add_u32 m0, s37, 118336
    s_nop 0
    buffer_load_dwordx4 v4, s[16:19], s30 offen offset:2048  lds
    s_add_u32 m0, s37, 118368
    s_nop 0
    buffer_load_dwordx4 v4, s[16:19], s30 offen offset:3072  lds
    s_waitcnt vmcnt(8)
    s_barrier
    s_xor_b32 s30, s94, 98304
    s_add_u32 m0, s37, 135168
    s_nop 0
    buffer_load_dwordx4 v4, s[16:19], s30 offen offset:0  lds
    s_add_u32 m0, s37, 135200
    s_nop 0
    buffer_load_dwordx4 v4, s[16:19], s30 offen offset:1024  lds
    s_add_u32 m0, s37, 135232
    s_nop 0
    buffer_load_dwordx4 v4, s[16:19], s30 offen offset:2048  lds
    s_add_u32 m0, s37, 135264
    s_nop 0
    buffer_load_dwordx4 v4, s[16:19], s30 offen offset:3072  lds
    s_waitcnt vmcnt(8)
    s_barrier
    s_xor_b32 s30, s94, 114688
    s_add_u32 m0, s37, 0
    s_nop 0
    buffer_load_dwordx4 v4, s[16:19], s30 offen offset:0  lds
    s_add_u32 m0, s37, 32
    s_nop 0
    buffer_load_dwordx4 v4, s[16:19], s30 offen offset:1024  lds
    s_add_u32 m0, s37, 64
    s_nop 0
    buffer_load_dwordx4 v4, s[16:19], s30 offen offset:2048  lds
    s_add_u32 m0, s37, 96
    s_nop 0
    buffer_load_dwordx4 v4, s[16:19], s30 offen offset:3072  lds
    s_xor_b32 s30, s94, 131072
    s_add_u32 m0, s37, 16896
    s_nop 0
    buffer_load_dwordx4 v4, s[16:19], s30 offen offset:0  lds
    s_add_u32 m0, s37, 16928
    s_nop 0
    buffer_load_dwordx4 v4, s[16:19], s30 offen offset:1024  lds
    s_add_u32 m0, s37, 16960
    s_nop 0
    buffer_load_dwordx4 v4, s[16:19], s30 offen offset:2048  lds
    s_add_u32 m0, s37, 16992
    s_nop 0
    buffer_load_dwordx4 v4, s[16:19], s30 offen offset:3072  lds
    s_waitcnt vmcnt(12)
    s_barrier
    s_xor_b32 s30, s94, 147456
    s_add_u32 m0, s37, 33792
    s_nop 0
    buffer_load_dwordx4 v4, s[16:19], s30 offen offset:0  lds
    s_add_u32 m0, s37, 33824
    s_nop 0
    buffer_load_dwordx4 v4, s[16:19], s30 offen offset:1024  lds
    s_add_u32 m0, s37, 33856
    s_nop 0
    buffer_load_dwordx4 v4, s[16:19], s30 offen offset:2048  lds
    s_add_u32 m0, s37, 33888
    s_nop 0
    buffer_load_dwordx4 v4, s[16:19], s30 offen offset:3072  lds
    s_waitcnt vmcnt(12)
    s_barrier
    s_xor_b32 s30, s94, 163840
    s_add_u32 m0, s37, 50688
    s_nop 0
    buffer_load_dwordx4 v4, s[16:19], s30 offen offset:0  lds
    s_add_u32 m0, s37, 50720
    s_nop 0
    buffer_load_dwordx4 v4, s[16:19], s30 offen offset:1024  lds
    s_add_u32 m0, s37, 50752
    s_nop 0
    buffer_load_dwordx4 v4, s[16:19], s30 offen offset:2048  lds
    s_add_u32 m0, s37, 50784
    s_nop 0
    buffer_load_dwordx4 v4, s[16:19], s30 offen offset:3072  lds
    s_xor_b32 s30, s94, 180224
    s_add_u32 m0, s37, 67584
    s_nop 0
    buffer_load_dwordx4 v4, s[16:19], s30 offen offset:0  lds
    s_add_u32 m0, s37, 67616
    s_nop 0
    buffer_load_dwordx4 v4, s[16:19], s30 offen offset:1024  lds
    s_add_u32 m0, s37, 67648
    s_nop 0
    buffer_load_dwordx4 v4, s[16:19], s30 offen offset:2048  lds
    s_add_u32 m0, s37, 67680
    s_nop 0
    buffer_load_dwordx4 v4, s[16:19], s30 offen offset:3072  lds
    s_waitcnt vmcnt(16)
    s_barrier
    s_xor_b32 s30, s94, 196608
    s_add_u32 m0, s37, 84480
    s_nop 0
    buffer_load_dwordx4 v4, s[16:19], s30 offen offset:0  lds
    s_add_u32 m0, s37, 84512
    s_nop 0
    buffer_load_dwordx4 v4, s[16:19], s30 offen offset:1024  lds
    s_add_u32 m0, s37, 84544
    s_nop 0
    buffer_load_dwordx4 v4, s[16:19], s30 offen offset:2048  lds
    s_add_u32 m0, s37, 84576
    s_nop 0
    buffer_load_dwordx4 v4, s[16:19], s30 offen offset:3072  lds
    s_waitcnt vmcnt(16)
    s_barrier
    s_xor_b32 s30, s94, 212992
    s_add_u32 m0, s37, 101376
    s_nop 0
    buffer_load_dwordx4 v4, s[16:19], s30 offen offset:0  lds
    s_add_u32 m0, s37, 101408
    s_nop 0
    buffer_load_dwordx4 v4, s[16:19], s30 offen offset:1024  lds
    s_add_u32 m0, s37, 101440
    s_nop 0
    buffer_load_dwordx4 v4, s[16:19], s30 offen offset:2048  lds
    s_add_u32 m0, s37, 101472
    s_nop 0
    buffer_load_dwordx4 v4, s[16:19], s30 offen offset:3072  lds
    s_xor_b32 s30, s94, 229376
    s_add_u32 m0, s37, 118272
    s_nop 0
    buffer_load_dwordx4 v4, s[16:19], s30 offen offset:0  lds
    s_add_u32 m0, s37, 118304
    s_nop 0
    buffer_load_dwordx4 v4, s[16:19], s30 offen offset:1024  lds
    s_add_u32 m0, s37, 118336
    s_nop 0
    buffer_load_dwordx4 v4, s[16:19], s30 offen offset:2048  lds
    s_add_u32 m0, s37, 118368
    s_nop 0
    buffer_load_dwordx4 v4, s[16:19], s30 offen offset:3072  lds
    s_waitcnt vmcnt(20)
    s_barrier
    s_xor_b32 s30, s94, 245760
    s_add_u32 m0, s37, 135168
    s_nop 0
    buffer_load_dwordx4 v4, s[16:19], s30 offen offset:0  lds
    s_add_u32 m0, s37, 135200
    s_nop 0
    buffer_load_dwordx4 v4, s[16:19], s30 offen offset:1024  lds
    s_add_u32 m0, s37, 135232
    s_nop 0
    buffer_load_dwordx4 v4, s[16:19], s30 offen offset:2048  lds
    s_add_u32 m0, s37, 135264
    s_nop 0
    buffer_load_dwordx4 v4, s[16:19], s30 offen offset:3072  lds
    s_waitcnt vmcnt(20)
    s_barrier
    s_add_u32 m0, s36, 0
    s_xor_b32 s30, s95, 0
    buffer_load_dwordx4 v24, s[20:23], s30 offen  lds
    s_add_u32 m0, s36, 1024
    s_xor_b32 s30, s95, 4096
    buffer_load_dwordx4 v24, s[20:23], s30 offen  lds
    s_add_u32 m0, s36, 2048
    s_xor_b32 s30, s95, 8192
    buffer_load_dwordx4 v24, s[20:23], s30 offen  lds
    s_add_u32 m0, s36, 3072
    s_xor_b32 s30, s95, 12288
    buffer_load_dwordx4 v24, s[20:23], s30 offen  lds
    s_add_u32 m0, s36, 16896
    s_xor_b32 s30, s95, 16384
    buffer_load_dwordx4 v24, s[20:23], s30 offen  lds
    s_add_u32 m0, s36, 17920
    s_xor_b32 s30, s95, 20480
    buffer_load_dwordx4 v24, s[20:23], s30 offen  lds
    s_add_u32 m0, s36, 18944
    s_xor_b32 s30, s95, 24576
    buffer_load_dwordx4 v24, s[20:23], s30 offen  lds
    s_add_u32 m0, s36, 19968
    s_xor_b32 s30, s95, 28672
    buffer_load_dwordx4 v24, s[20:23], s30 offen  lds
    s_waitcnt vmcnt(20)
    s_barrier
    s_add_u32 m0, s36, 33792
    s_xor_b32 s30, s95, 32768
    buffer_load_dwordx4 v24, s[20:23], s30 offen  lds
    s_add_u32 m0, s36, 34816
    s_xor_b32 s30, s95, 36864
    buffer_load_dwordx4 v24, s[20:23], s30 offen  lds
    s_add_u32 m0, s36, 35840
    s_xor_b32 s30, s95, 40960
    buffer_load_dwordx4 v24, s[20:23], s30 offen  lds
    s_add_u32 m0, s36, 36864
    s_xor_b32 s30, s95, 45056
    buffer_load_dwordx4 v24, s[20:23], s30 offen  lds
    s_waitcnt vmcnt(16)
    s_barrier
    s_add_u32 m0, s36, 50688
    s_xor_b32 s30, s95, 49152
    buffer_load_dwordx4 v24, s[20:23], s30 offen  lds
    s_add_u32 m0, s36, 51712
    s_xor_b32 s30, s95, 53248
    buffer_load_dwordx4 v24, s[20:23], s30 offen  lds
    s_add_u32 m0, s36, 52736
    s_xor_b32 s30, s95, 57344
    buffer_load_dwordx4 v24, s[20:23], s30 offen  lds
    s_add_u32 m0, s36, 53760
    s_xor_b32 s30, s95, 61440
    buffer_load_dwordx4 v24, s[20:23], s30 offen  lds
    s_add_u32 m0, s36, 67584
    s_xor_b32 s30, s95, 0
    buffer_load_dwordx4 v25, s[20:23], s30 offen  lds
    s_add_u32 m0, s36, 68608
    s_xor_b32 s30, s95, 4096
    buffer_load_dwordx4 v25, s[20:23], s30 offen  lds
    s_add_u32 m0, s36, 69632
    s_xor_b32 s30, s95, 8192
    buffer_load_dwordx4 v25, s[20:23], s30 offen  lds
    s_add_u32 m0, s36, 70656
    s_xor_b32 s30, s95, 12288
    buffer_load_dwordx4 v25, s[20:23], s30 offen  lds
    s_waitcnt vmcnt(16)
    s_barrier
    s_add_u32 m0, s36, 84480
    s_xor_b32 s30, s95, 16384
    buffer_load_dwordx4 v25, s[20:23], s30 offen  lds
    s_add_u32 m0, s36, 85504
    s_xor_b32 s30, s95, 20480
    buffer_load_dwordx4 v25, s[20:23], s30 offen  lds
    s_add_u32 m0, s36, 86528
    s_xor_b32 s30, s95, 24576
    buffer_load_dwordx4 v25, s[20:23], s30 offen  lds
    s_add_u32 m0, s36, 87552
    s_xor_b32 s30, s95, 28672
    buffer_load_dwordx4 v25, s[20:23], s30 offen  lds
    s_add_u32 m0, s36, 101376
    s_xor_b32 s30, s95, 32768
    buffer_load_dwordx4 v25, s[20:23], s30 offen  lds
    s_add_u32 m0, s36, 102400
    s_xor_b32 s30, s95, 36864
    buffer_load_dwordx4 v25, s[20:23], s30 offen  lds
    s_add_u32 m0, s36, 103424
    s_xor_b32 s30, s95, 40960
    buffer_load_dwordx4 v25, s[20:23], s30 offen  lds
    s_add_u32 m0, s36, 104448
    s_xor_b32 s30, s95, 45056
    buffer_load_dwordx4 v25, s[20:23], s30 offen  lds
    v_xor_b32 v6, 384, v7
    s_mov_b64 exec, 0xffffffff
    buffer_load_dword v40, v6, s[20:23], 0 offen
    s_mov_b64 exec, -1
    s_waitcnt vmcnt(17)
    s_barrier
    s_add_u32 m0, s36, 118272
    s_xor_b32 s30, s95, 49152
    buffer_load_dwordx4 v25, s[20:23], s30 offen  lds
    s_add_u32 m0, s36, 119296
    s_xor_b32 s30, s95, 53248
    buffer_load_dwordx4 v25, s[20:23], s30 offen  lds
    s_add_u32 m0, s36, 120320
    s_xor_b32 s30, s95, 57344
    buffer_load_dwordx4 v25, s[20:23], s30 offen  lds
    s_add_u32 m0, s36, 121344
    s_xor_b32 s30, s95, 61440
    buffer_load_dwordx4 v25, s[20:23], s30 offen  lds
    s_add_u32 m0, s36, 135168
    s_xor_b32 s30, s95, 0
    buffer_load_dwordx4 v26, s[20:23], s30 offen  lds
    s_add_u32 m0, s36, 136192
    s_xor_b32 s30, s95, 4096
    buffer_load_dwordx4 v26, s[20:23], s30 offen  lds
    s_add_u32 m0, s36, 137216
    s_xor_b32 s30, s95, 8192
    buffer_load_dwordx4 v26, s[20:23], s30 offen  lds
    s_add_u32 m0, s36, 138240
    s_xor_b32 s30, s95, 12288
    buffer_load_dwordx4 v26, s[20:23], s30 offen  lds
    s_waitcnt vmcnt(17)
    s_barrier
    s_add_u32 m0, s36, 0
    s_xor_b32 s30, s95, 16384
    buffer_load_dwordx4 v26, s[20:23], s30 offen  lds
    s_add_u32 m0, s36, 1024
    s_xor_b32 s30, s95, 20480
    buffer_load_dwordx4 v26, s[20:23], s30 offen  lds
    s_add_u32 m0, s36, 2048
    s_xor_b32 s30, s95, 24576
    buffer_load_dwordx4 v26, s[20:23], s30 offen  lds
    s_add_u32 m0, s36, 3072
    s_xor_b32 s30, s95, 28672
    buffer_load_dwordx4 v26, s[20:23], s30 offen  lds
    s_add_u32 m0, s36, 16896
    s_xor_b32 s30, s95, 32768
    buffer_load_dwordx4 v26, s[20:23], s30 offen  lds
    s_add_u32 m0, s36, 17920
    s_xor_b32 s30, s95, 36864
    buffer_load_dwordx4 v26, s[20:23], s30 offen  lds
    s_add_u32 m0, s36, 18944
    s_xor_b32 s30, s95, 40960
    buffer_load_dwordx4 v26, s[20:23], s30 offen  lds
    s_add_u32 m0, s36, 19968
    s_xor_b32 s30, s95, 45056
    buffer_load_dwordx4 v26, s[20:23], s30 offen  lds
    s_waitcnt vmcnt(17)
    s_barrier
    ds_read_b128 v[32:35], v8
    s_waitcnt lgkmcnt(0)
    v_or3_b32 v32, v32, v33, v34
    v_or_b32 v32, v32, v35
    v_cmp_ne_u32 vcc, 0, v32
    s_cbranch_vccnz L_redo_loader_safe
    s_add_u32 m0, s36, 33792
    s_xor_b32 s30, s95, 49152
    buffer_load_dwordx4 v26, s[20:23], s30 offen  lds
    s_add_u32 m0, s36, 34816
    s_xor_b32 s30, s95, 53248
    buffer_load_dwordx4 v26, s[20:23], s30 offen  lds
    s_add_u32 m0, s36, 35840
    s_xor_b32 s30, s95, 57344
    buffer_load_dwordx4 v26, s[20:23], s30 offen  lds
    s_add_u32 m0, s36, 36864
    s_xor_b32 s30, s95, 61440
    buffer_load_dwordx4 v26, s[20:23], s30 offen  lds
    s_add_u32 m0, s36, 50688
    s_xor_b32 s30, s95, 0
    buffer_load_dwordx4 v27, s[20:23], s30 offen  lds
    s_add_u32 m0, s36, 51712
    s_xor_b32 s30, s95, 4096
    buffer_load_dwordx4 v27, s[20:23], s30 offen  lds
    s_add_u32 m0, s36, 52736
    s_xor_b32 s30, s95, 8192
    buffer_load_dwordx4 v27, s[20:23], s30 offen  lds
    s_add_u32 m0, s36, 53760
    s_xor_b32 s30, s95, 12288
    buffer_load_dwordx4 v27, s[20:23], s30 offen  lds
    s_waitcnt vmcnt(16)
    s_barrier
    s_add_u32 m0, s36, 67584
    s_xor_b32 s30, s95, 16384
    buffer_load_dwordx4 v27, s[20:23], s30 offen  lds
    s_add_u32 m0, s36, 68608
    s_xor_b32 s30, s95, 20480
    buffer_load_dwordx4 v27, s[20:23], s30 offen  lds
    s_add_u32 m0, s36, 69632
    s_xor_b32 s30, s95, 24576
    buffer_load_dwordx4 v27, s[20:23], s30 offen  lds
    s_add_u32 m0, s36, 70656
    s_xor_b32 s30, s95, 28672
    buffer_load_dwordx4 v27, s[20:23], s30 offen  lds
    s_add_u32 m0, s36, 84480
    s_xor_b32 s30, s95, 32768
    buffer_load_dwordx4 v27, s[20:23], s30 offen  lds
    s_add_u32 m0, s36, 85504
    s_xor_b32 s30, s95, 36864
    buffer_load_dwordx4 v27, s[20:23], s30 offen  lds
    s_add_u32 m0, s36, 86528
    s_xor_b32 s30, s95, 40960
    buffer_load_dwordx4 v27, s[20:23], s30 offen  lds
    s_add_u32 m0, s36, 87552
    s_xor_b32 s30, s95, 45056
    buffer_load_dwordx4 v27, s[20:23], s30 offen  lds
    s_waitcnt vmcnt(16)
    s_barrier
    s_add_u32 m0, s36, 101376
    s_xor_b32 s30, s95, 49152
    buffer_load_dwordx4 v27, s[20:23], s30 offen  lds
    s_add_u32 m0, s36, 102400
    s_xor_b32 s30, s95, 53248
    buffer_load_dwordx4 v27, s[20:23], s30 offen  lds
    s_add_u32 m0, s36, 103424
    s_xor_b32 s30, s95, 57344
    buffer_load_dwordx4 v27, s[20:23], s30 offen  lds
    s_add_u32 m0, s36, 104448
    s_xor_b32 s30, s95, 61440
    buffer_load_dwordx4 v27, s[20:23], s30 offen  lds
    s_waitcnt vmcnt(16)
    s_barrier
    s_waitcnt vmcnt(0)
    s_barrier
    s_endpgm
L_redo_loader_safe:
    s_waitcnt vmcnt(0) lgkmcnt(0)
    s_barrier
    s_branch L_restart_loader_safe
.section .rodata,"a"
.p2align 6
.amdhsa_kernel standalone__gqa_softmax__near_ridge_kernel
  .amdhsa_next_free_vgpr 256
  .amdhsa_next_free_sgpr 100
  .amdhsa_accum_offset 256
  .amdhsa_group_segment_fixed_size 0
  .amdhsa_kernarg_size 48
  .amdhsa_user_sgpr_count 2
  .amdhsa_user_sgpr_kernarg_segment_ptr 1
  .amdhsa_system_sgpr_workgroup_id_x 1
.end_amdhsa_kernel
```
